```python
import torch

def _softmax(x, axis=-1):
    return torch.softmax(x, dim=axis)

def _gelu(x):
    return torch.nn.functional.gelu(x, approximate='tanh')

def _silu(x):
    return torch.nn.functional.silu(x)

def _sigmoid(x):
    return torch.sigmoid(x)

def _layernorm(x, axis=-1, eps=1e-05):
    m = x.mean(dim=axis, keepdim=True)
    v = x.var(dim=axis, keepdim=True, unbiased=False)
    return (x - m) / torch.sqrt(v + eps)

def _scatter_add(tgt, idx, src, axis=0):
    return tgt.clone().index_add_(axis, idx, src)

def _segment_sum(src, seg, n):
    out = torch.zeros((n,) + src.shape[1:], dtype=src.dtype)
    return out.index_add_(0, seg, src)

def _pad(x, pw):
    flat = tuple((v for pair in reversed(pw) for v in pair))
    return torch.nn.functional.pad(x, flat)
kernel_name = 'interleave_layers__sliding_local_dilated__mixer_gmlp__prompt'

def setup_inputs():

    _w = lambda a: (lambda t: t.to(torch.bfloat16) if t.is_floating_point() else t)(torch.as_tensor(a))

    def _A_setup():
        B, S, D = (1, 2048, 512)
        return {'x': _w((lambda *s: torch.randn(*s, dtype=torch.bfloat16) * 0.05)(B, S, D)), 'wqkv': _w((lambda *s: torch.randn(*s, dtype=torch.bfloat16) * 0.1)(D, 3 * D)), 'wo': _w((lambda *s: torch.randn(*s, dtype=torch.bfloat16) * 0.1)(D, D))}
    _A_in = _A_setup()

    def _B_setup():
        B, S, D, F = (1, 2048, 512, 1376)
        Fh = F // 2
        return {'x': _w((lambda *s: torch.randn(*s, dtype=torch.bfloat16) * 0.05)(B, S, D)), 'w_in': _w((lambda *s: torch.randn(*s, dtype=torch.bfloat16) * 0.4)(D, 2 * Fh)), 'w_sp': _w(0.01 * (lambda *s: torch.randn(*s, dtype=torch.bfloat16) * 0.4)(S, S)), 'b_sp': _w(1.0 + 0.01 * (lambda *s: torch.randn(*s, dtype=torch.bfloat16) * 0.05)(S)), 'w_out': _w((lambda *s: torch.randn(*s, dtype=torch.bfloat16) * 0.05)(Fh, D))}
    _B_in = _B_setup()
    return {'A_x': _A_in['x'], 'A_wqkv': _A_in['wqkv'], 'A_wo': _A_in['wo'], 'B_x': _B_in['x'], 'B_w_in': _B_in['w_in'], 'B_w_sp': _B_in['w_sp'], 'B_b_sp': _B_in['b_sp'], 'B_w_out': _B_in['w_out']}

def reference(A_x, A_wqkv, A_wo, B_x, B_w_in, B_w_sp, B_b_sp, B_w_out):

    def _A_ref(x, wqkv, wo):
        B, S, D = x.shape
        H = 32
        Dh = D // H
        W, dil = (8, 2)
        qkv = (lambda x, *d: x.permute(*d))((x @ wqkv).reshape(B, S, 3, H, Dh), 2, 0, 3, 1, 4)
        q, k, v = (qkv[0], qkv[1], qkv[2])
        scale = Dh ** (-0.5)
        pos = torch.arange(S)
        off = torch.arange(W) * dil
        idx = pos[:, None] - off[None, :]
        mask = idx >= 0
        idx_c = torch.where(mask, idx, 0).reshape(-1)
        kg = k[:, :, idx_c, :].reshape(B, H, S, W, Dh)
        vg = v[:, :, idx_c, :].reshape(B, H, S, W, Dh)
        logits = torch.einsum('bhsd,bhswd->bhsw', q, kg) * scale
        logits = torch.where(mask[None, None, :, :], logits, -1000000000.0)
        attn = _softmax(logits, axis=-1)
        o = torch.einsum('bhsw,bhswd->bhsd', attn, vg)
        return (lambda x, *d: x.permute(*d))(o, 0, 2, 1, 3).reshape(B, S, D) @ wo

    def _B_ref(x, w_in, w_sp, b_sp, w_out):
        B, S, D = x.shape
        F = w_in.shape[-1]
        Fh = F // 2
        z = _gelu(torch.einsum('bsd,df->bsf', x, w_in))
        z1 = z[..., :Fh].clone()
        z2 = _layernorm(z[..., Fh:], axis=-1)
        g = torch.einsum('ts,bsf->btf', w_sp, z2) + b_sp[None, :, None]
        return torch.einsum('bsf,fd->bsd', z1 * g, w_out)
    x = A_x
    x = x + _A_ref(_layernorm(x, axis=-1), A_wqkv, A_wo)
    x = x + _B_ref(_layernorm(x, axis=-1), B_w_in, B_w_sp, B_b_sp, B_w_out)
    x = x + _A_ref(_layernorm(x, axis=-1), A_wqkv, A_wo)
    x = x + _B_ref(_layernorm(x, axis=-1), B_w_in, B_w_sp, B_b_sp, B_w_out)
    return x
```

```asm
; @launch kernel=k1a_kernel grid=(256,1,1) block=(704,1,1) lds=155648
; @launch kernel=k2a_kernel grid=(256,1,1) block=(512,1,1) lds=131072
; @launch kernel=k3_kernel grid=(256,1,1) block=(640,1,1) lds=139264
; @launch kernel=k3b_kernel grid=(512,1,1) block=(256,1,1) lds=0
; @launch kernel=k4_kernel grid=(256,1,1) block=(512,1,1) lds=163840
; @launch kernel=k5a_kernel grid=(256,1,1) block=(512,1,1) lds=163840
; @launch kernel=k1b_kernel grid=(256,1,1) block=(640,1,1) lds=155648
; @launch kernel=k2b_kernel grid=(256,1,1) block=(512,1,1) lds=131072
; @launch kernel=k3_kernel grid=(256,1,1) block=(640,1,1) lds=139264
; @launch kernel=k3b_kernel grid=(512,1,1) block=(256,1,1) lds=0
; @launch kernel=k4_kernel grid=(256,1,1) block=(512,1,1) lds=163840
; @launch kernel=k5b_kernel grid=(256,1,1) block=(512,1,1) lds=163840
.amdgcn_target "amdgcn-amd-amdhsa--gfx950"
.text
.globl k1a_kernel
.p2align 8
.type k1a_kernel,@function
k1a_kernel:
  s_cmp_ge_u32 s2, 256
  s_cbranch_scc1 .Lend_k1a_kernel
  s_load_dwordx2 s[4:5], s[0:1], 0
  s_load_dwordx2 s[12:13], s[0:1], 80
  s_load_dwordx2 s[8:9], s[0:1], 8
  s_and_b32 s16, s2, 7
  s_lshl_b32 s16, s16, 2
  s_lshr_b32 s17, s2, 3
  s_and_b32 s17, s17, 3
  s_add_u32 s16, s16, s17
  s_lshr_b32 s17, s2, 5
  v_and_b32 v1, 63, v0
  v_lshrrev_b32 v4, 6, v0
  v_and_b32 v2, 15, v0
  v_readfirstlane_b32 s18, v4
  v_bfe_u32 v3, v0, 4, 2
  s_cmp_ge_u32 s18, 8
  s_cbranch_scc1 .Lloader_k1a_kernel_1
  s_and_b32 s19, s18, 1
  s_lshr_b32 s20, s18, 1
  s_lshl_b32 s22, s18, 2
  v_add_u32 v4, s22, v3
  s_lshl_b32 s23, s16, 6
  v_add_u32 v5, s23, v4
  v_lshlrev_b32 v5, 10, v5
  v_lshl_add_u32 v11, v2, 4, v5
  v_subrev_u32 v12, 0x4000, v11
  v_and_b32 v5, 15, v4
  v_xor_b32 v5, v5, v2
  v_lshlrev_b32 v5, 4, v5
  v_lshl_add_u32 v13, v4, 10, v5
  v_add_u32 v14, 0x10000, v13
  s_waitcnt lgkmcnt(0)
  s_mov_b32 s6, 0x200000
  s_mov_b32 s7, 0x00020000
  s_mov_b32 s14, 0x200000
  s_mov_b32 s15, 0x00020000
  s_mov_b32 s23, 0x8000
  s_cmp_ge_u32 s18, 4
  s_cbranch_scc1 .L_k1a_kernel_2
  buffer_load_dwordx4 v[64:67], v12, s[4:7], 0 offen offset:0
  buffer_load_dwordx4 v[68:71], v12, s[4:7], 0 offen offset:256
  buffer_load_dwordx4 v[72:75], v12, s[4:7], 0 offen offset:512
  buffer_load_dwordx4 v[76:79], v12, s[4:7], 0 offen offset:768
.L_k1a_kernel_2:
  buffer_load_dwordx4 v[32:35], v11, s[4:7], 0 offen offset:0
  buffer_load_dwordx4 v[36:39], v11, s[4:7], 0 offen offset:256
  buffer_load_dwordx4 v[40:43], v11, s[4:7], 0 offen offset:512
  buffer_load_dwordx4 v[44:47], v11, s[4:7], 0 offen offset:768
  buffer_load_dwordx4 v[48:51], v11, s[4:7], s23 offen offset:0
  buffer_load_dwordx4 v[52:55], v11, s[4:7], s23 offen offset:256
  buffer_load_dwordx4 v[56:59], v11, s[4:7], s23 offen offset:512
  buffer_load_dwordx4 v[60:63], v11, s[4:7], s23 offen offset:768
  s_barrier
  s_lshl_b32 s22, s19, 15
  v_xor_b32 v4, v3, v2
  v_and_b32 v4, 3, v4
  v_and_b32 v5, 12, v2
  v_xor_b32 v6, 0, v5
  v_or_b32 v6, v6, v4
  v_lshlrev_b32 v6, 4, v6
  v_lshl_add_u32 v6, v2, 10, v6
  v_add_u32 v16, s22, v6
  v_add_u32 v20, 0x10000, v6
  v_xor_b32 v6, 4, v5
  v_or_b32 v6, v6, v4
  v_lshlrev_b32 v6, 4, v6
  v_lshl_add_u32 v6, v2, 10, v6
  v_add_u32 v17, s22, v6
  v_add_u32 v21, 0x10000, v6
  v_xor_b32 v6, 8, v5
  v_or_b32 v6, v6, v4
  v_lshlrev_b32 v6, 4, v6
  v_lshl_add_u32 v6, v2, 10, v6
  v_add_u32 v18, s22, v6
  v_add_u32 v22, 0x10000, v6
  v_xor_b32 v6, 12, v5
  v_or_b32 v6, v6, v4
  v_lshlrev_b32 v6, 4, v6
  v_lshl_add_u32 v6, v2, 10, v6
  v_add_u32 v19, s22, v6
  v_add_u32 v23, 0x10000, v6
  v_lshrrev_b32 v4, 2, v2
  v_lshl_add_u32 v4, v3, 3, v4
  v_mul_u32_u24 v4, 384, v4
  v_and_b32 v5, 3, v2
  v_lshl_add_u32 v4, v5, 3, v4
  v_add_u32 v4, 81920, v4
  v_bfe_u32 v5, v2, 3, 1
  v_and_b32 v6, 1, v3
  v_lshl_add_u32 v5, v6, 1, v5
  s_mov_b32 s23, s20
  v_xor_b32 v6, s23, v5
  v_lshl_add_u32 v24, v6, 5, v4
  s_lshl_b32 s23, s19, 2
  s_add_u32 s23, s23, s20
  s_add_u32 s23, s23, 4
  v_xor_b32 v6, s23, v5
  v_lshl_add_u32 v25, v6, 5, v4
  s_lshl_b32 s23, s19, 2
  s_sub_u32 s23, s20, s23
  s_add_u32 s23, s23, 8
  v_xor_b32 v6, s23, v5
  v_lshl_add_u32 v26, v6, 5, v4
  s_cmp_ge_u32 s18, 4
  s_cbranch_scc1 .L_k1a_kernel_3
  s_waitcnt vmcnt(8)
  v_lshlrev_b32 v80, 16, v64
  v_and_b32 v81, 0xffff0000, v64
  v_lshlrev_b32 v82, 16, v65
  v_and_b32 v83, 0xffff0000, v65
  v_lshlrev_b32 v84, 16, v66
  v_and_b32 v85, 0xffff0000, v66
  v_lshlrev_b32 v86, 16, v67
  v_and_b32 v87, 0xffff0000, v67
  v_lshlrev_b32 v88, 16, v68
  v_and_b32 v89, 0xffff0000, v68
  v_lshlrev_b32 v90, 16, v69
  v_and_b32 v91, 0xffff0000, v69
  v_lshlrev_b32 v92, 16, v70
  v_and_b32 v93, 0xffff0000, v70
  v_lshlrev_b32 v94, 16, v71
  v_and_b32 v95, 0xffff0000, v71
  v_lshlrev_b32 v96, 16, v72
  v_and_b32 v97, 0xffff0000, v72
  v_lshlrev_b32 v98, 16, v73
  v_and_b32 v99, 0xffff0000, v73
  v_lshlrev_b32 v100, 16, v74
  v_and_b32 v101, 0xffff0000, v74
  v_lshlrev_b32 v102, 16, v75
  v_and_b32 v103, 0xffff0000, v75
  v_lshlrev_b32 v104, 16, v76
  v_and_b32 v105, 0xffff0000, v76
  v_lshlrev_b32 v106, 16, v77
  v_and_b32 v107, 0xffff0000, v77
  v_lshlrev_b32 v108, 16, v78
  v_and_b32 v109, 0xffff0000, v78
  v_lshlrev_b32 v110, 16, v79
  v_and_b32 v111, 0xffff0000, v79
  v_pk_add_f32 v[4:5], v[80:81], v[82:83]
  v_pk_mul_f32 v[6:7], v[80:81], v[80:81]
  v_pk_fma_f32 v[6:7], v[82:83], v[82:83], v[6:7]
  v_pk_add_f32 v[4:5], v[4:5], v[84:85]
  v_pk_fma_f32 v[6:7], v[84:85], v[84:85], v[6:7]
  v_pk_add_f32 v[4:5], v[4:5], v[86:87]
  v_pk_fma_f32 v[6:7], v[86:87], v[86:87], v[6:7]
  v_pk_add_f32 v[4:5], v[4:5], v[88:89]
  v_pk_fma_f32 v[6:7], v[88:89], v[88:89], v[6:7]
  v_pk_add_f32 v[4:5], v[4:5], v[90:91]
  v_pk_fma_f32 v[6:7], v[90:91], v[90:91], v[6:7]
  v_pk_add_f32 v[4:5], v[4:5], v[92:93]
  v_pk_fma_f32 v[6:7], v[92:93], v[92:93], v[6:7]
  v_pk_add_f32 v[4:5], v[4:5], v[94:95]
  v_pk_fma_f32 v[6:7], v[94:95], v[94:95], v[6:7]
  v_pk_add_f32 v[4:5], v[4:5], v[96:97]
  v_pk_fma_f32 v[6:7], v[96:97], v[96:97], v[6:7]
  v_pk_add_f32 v[4:5], v[4:5], v[98:99]
  v_pk_fma_f32 v[6:7], v[98:99], v[98:99], v[6:7]
  v_pk_add_f32 v[4:5], v[4:5], v[100:101]
  v_pk_fma_f32 v[6:7], v[100:101], v[100:101], v[6:7]
  v_pk_add_f32 v[4:5], v[4:5], v[102:103]
  v_pk_fma_f32 v[6:7], v[102:103], v[102:103], v[6:7]
  v_pk_add_f32 v[4:5], v[4:5], v[104:105]
  v_pk_fma_f32 v[6:7], v[104:105], v[104:105], v[6:7]
  v_pk_add_f32 v[4:5], v[4:5], v[106:107]
  v_pk_fma_f32 v[6:7], v[106:107], v[106:107], v[6:7]
  v_pk_add_f32 v[4:5], v[4:5], v[108:109]
  v_pk_fma_f32 v[6:7], v[108:109], v[108:109], v[6:7]
  v_pk_add_f32 v[4:5], v[4:5], v[110:111]
  v_pk_fma_f32 v[6:7], v[110:111], v[110:111], v[6:7]
  v_add_f32 v4, v4, v5
  v_add_f32 v6, v6, v7
  s_nop 1
  v_add_f32_dpp v4, v4, v4 row_ror:8 row_mask:0xf bank_mask:0xf
  v_add_f32_dpp v6, v6, v6 row_ror:8 row_mask:0xf bank_mask:0xf
  s_nop 1
  v_add_f32_dpp v4, v4, v4 row_ror:4 row_mask:0xf bank_mask:0xf
  v_add_f32_dpp v6, v6, v6 row_ror:4 row_mask:0xf bank_mask:0xf
  s_nop 1
  v_add_f32_dpp v4, v4, v4 row_ror:2 row_mask:0xf bank_mask:0xf
  v_add_f32_dpp v6, v6, v6 row_ror:2 row_mask:0xf bank_mask:0xf
  s_nop 1
  v_add_f32_dpp v4, v4, v4 row_ror:1 row_mask:0xf bank_mask:0xf
  v_add_f32_dpp v6, v6, v6 row_ror:1 row_mask:0xf bank_mask:0xf
  v_mul_f32 v4, 0x3b000000, v4
  v_mul_f32 v6, 0x3b000000, v6
  v_fma_f32 v6, -v4, v4, v6
  v_max_f32 v6, 0, v6
  v_cvt_pk_bf16_f32 v112, v4, v4
  v_lshlrev_b32 v112, 16, v112
  v_cvt_pk_bf16_f32 v30, v6, v6
  v_lshlrev_b32 v30, 16, v30
  v_add_f32 v30, 0x3727c5ac, v30
  v_cvt_pk_bf16_f32 v30, v30, v30
  v_lshlrev_b32 v30, 16, v30
  v_sqrt_f32 v15, v30
  s_nop 0
  v_cvt_pk_bf16_f32 v15, v15, v15
  v_lshlrev_b32 v15, 16, v15
  v_rcp_f32 v114, v15
  s_nop 0
  v_sub_f32 v112, 0, v112
  v_mov_b32 v113, v112
  v_mov_b32 v115, v114
  v_pk_add_f32 v[80:81], v[80:81], v[112:113]
  v_cvt_pk_bf16_f32 v64, v80, v81
  v_lshlrev_b32 v80, 16, v64
  v_and_b32 v81, 0xffff0000, v64
  v_pk_mul_f32 v[80:81], v[80:81], v[114:115]
  v_cvt_pk_bf16_f32 v64, v80, v81
  v_pk_add_f32 v[82:83], v[82:83], v[112:113]
  v_cvt_pk_bf16_f32 v65, v82, v83
  v_lshlrev_b32 v82, 16, v65
  v_and_b32 v83, 0xffff0000, v65
  v_pk_mul_f32 v[82:83], v[82:83], v[114:115]
  v_cvt_pk_bf16_f32 v65, v82, v83
  v_pk_add_f32 v[84:85], v[84:85], v[112:113]
  v_cvt_pk_bf16_f32 v66, v84, v85
  v_lshlrev_b32 v84, 16, v66
  v_and_b32 v85, 0xffff0000, v66
  v_pk_mul_f32 v[84:85], v[84:85], v[114:115]
  v_cvt_pk_bf16_f32 v66, v84, v85
  v_pk_add_f32 v[86:87], v[86:87], v[112:113]
  v_cvt_pk_bf16_f32 v67, v86, v87
  v_lshlrev_b32 v86, 16, v67
  v_and_b32 v87, 0xffff0000, v67
  v_pk_mul_f32 v[86:87], v[86:87], v[114:115]
  v_cvt_pk_bf16_f32 v67, v86, v87
  v_pk_add_f32 v[88:89], v[88:89], v[112:113]
  v_cvt_pk_bf16_f32 v68, v88, v89
  v_lshlrev_b32 v88, 16, v68
  v_and_b32 v89, 0xffff0000, v68
  v_pk_mul_f32 v[88:89], v[88:89], v[114:115]
  v_cvt_pk_bf16_f32 v68, v88, v89
  v_pk_add_f32 v[90:91], v[90:91], v[112:113]
  v_cvt_pk_bf16_f32 v69, v90, v91
  v_lshlrev_b32 v90, 16, v69
  v_and_b32 v91, 0xffff0000, v69
  v_pk_mul_f32 v[90:91], v[90:91], v[114:115]
  v_cvt_pk_bf16_f32 v69, v90, v91
  v_pk_add_f32 v[92:93], v[92:93], v[112:113]
  v_cvt_pk_bf16_f32 v70, v92, v93
  v_lshlrev_b32 v92, 16, v70
  v_and_b32 v93, 0xffff0000, v70
  v_pk_mul_f32 v[92:93], v[92:93], v[114:115]
  v_cvt_pk_bf16_f32 v70, v92, v93
  v_pk_add_f32 v[94:95], v[94:95], v[112:113]
  v_cvt_pk_bf16_f32 v71, v94, v95
  v_lshlrev_b32 v94, 16, v71
  v_and_b32 v95, 0xffff0000, v71
  v_pk_mul_f32 v[94:95], v[94:95], v[114:115]
  v_cvt_pk_bf16_f32 v71, v94, v95
  v_pk_add_f32 v[96:97], v[96:97], v[112:113]
  v_cvt_pk_bf16_f32 v72, v96, v97
  v_lshlrev_b32 v96, 16, v72
  v_and_b32 v97, 0xffff0000, v72
  v_pk_mul_f32 v[96:97], v[96:97], v[114:115]
  v_cvt_pk_bf16_f32 v72, v96, v97
  v_pk_add_f32 v[98:99], v[98:99], v[112:113]
  v_cvt_pk_bf16_f32 v73, v98, v99
  v_lshlrev_b32 v98, 16, v73
  v_and_b32 v99, 0xffff0000, v73
  v_pk_mul_f32 v[98:99], v[98:99], v[114:115]
  v_cvt_pk_bf16_f32 v73, v98, v99
  v_pk_add_f32 v[100:101], v[100:101], v[112:113]
  v_cvt_pk_bf16_f32 v74, v100, v101
  v_lshlrev_b32 v100, 16, v74
  v_and_b32 v101, 0xffff0000, v74
  v_pk_mul_f32 v[100:101], v[100:101], v[114:115]
  v_cvt_pk_bf16_f32 v74, v100, v101
  v_pk_add_f32 v[102:103], v[102:103], v[112:113]
  v_cvt_pk_bf16_f32 v75, v102, v103
  v_lshlrev_b32 v102, 16, v75
  v_and_b32 v103, 0xffff0000, v75
  v_pk_mul_f32 v[102:103], v[102:103], v[114:115]
  v_cvt_pk_bf16_f32 v75, v102, v103
  v_pk_add_f32 v[104:105], v[104:105], v[112:113]
  v_cvt_pk_bf16_f32 v76, v104, v105
  v_lshlrev_b32 v104, 16, v76
  v_and_b32 v105, 0xffff0000, v76
  v_pk_mul_f32 v[104:105], v[104:105], v[114:115]
  v_cvt_pk_bf16_f32 v76, v104, v105
  v_pk_add_f32 v[106:107], v[106:107], v[112:113]
  v_cvt_pk_bf16_f32 v77, v106, v107
  v_lshlrev_b32 v106, 16, v77
  v_and_b32 v107, 0xffff0000, v77
  v_pk_mul_f32 v[106:107], v[106:107], v[114:115]
  v_cvt_pk_bf16_f32 v77, v106, v107
  v_pk_add_f32 v[108:109], v[108:109], v[112:113]
  v_cvt_pk_bf16_f32 v78, v108, v109
  v_lshlrev_b32 v108, 16, v78
  v_and_b32 v109, 0xffff0000, v78
  v_pk_mul_f32 v[108:109], v[108:109], v[114:115]
  v_cvt_pk_bf16_f32 v78, v108, v109
  v_pk_add_f32 v[110:111], v[110:111], v[112:113]
  v_cvt_pk_bf16_f32 v79, v110, v111
  v_lshlrev_b32 v110, 16, v79
  v_and_b32 v111, 0xffff0000, v79
  v_pk_mul_f32 v[110:111], v[110:111], v[114:115]
  v_cvt_pk_bf16_f32 v79, v110, v111
  ds_write_b128 v14, v[64:67] offset:0
  ds_write_b128 v14, v[68:71] offset:256
  ds_write_b128 v14, v[72:75] offset:512
  ds_write_b128 v14, v[76:79] offset:768
.L_k1a_kernel_3:
  s_waitcnt vmcnt(4)
  v_lshlrev_b32 v80, 16, v32
  v_and_b32 v81, 0xffff0000, v32
  v_lshlrev_b32 v82, 16, v33
  v_and_b32 v83, 0xffff0000, v33
  v_lshlrev_b32 v84, 16, v34
  v_and_b32 v85, 0xffff0000, v34
  v_lshlrev_b32 v86, 16, v35
  v_and_b32 v87, 0xffff0000, v35
  v_lshlrev_b32 v88, 16, v36
  v_and_b32 v89, 0xffff0000, v36
  v_lshlrev_b32 v90, 16, v37
  v_and_b32 v91, 0xffff0000, v37
  v_lshlrev_b32 v92, 16, v38
  v_and_b32 v93, 0xffff0000, v38
  v_lshlrev_b32 v94, 16, v39
  v_and_b32 v95, 0xffff0000, v39
  v_lshlrev_b32 v96, 16, v40
  v_and_b32 v97, 0xffff0000, v40
  v_lshlrev_b32 v98, 16, v41
  v_and_b32 v99, 0xffff0000, v41
  v_lshlrev_b32 v100, 16, v42
  v_and_b32 v101, 0xffff0000, v42
  v_lshlrev_b32 v102, 16, v43
  v_and_b32 v103, 0xffff0000, v43
  v_lshlrev_b32 v104, 16, v44
  v_and_b32 v105, 0xffff0000, v44
  v_lshlrev_b32 v106, 16, v45
  v_and_b32 v107, 0xffff0000, v45
  v_lshlrev_b32 v108, 16, v46
  v_and_b32 v109, 0xffff0000, v46
  v_lshlrev_b32 v110, 16, v47
  v_and_b32 v111, 0xffff0000, v47
  v_pk_add_f32 v[4:5], v[80:81], v[82:83]
  v_pk_mul_f32 v[6:7], v[80:81], v[80:81]
  v_pk_fma_f32 v[6:7], v[82:83], v[82:83], v[6:7]
  v_pk_add_f32 v[4:5], v[4:5], v[84:85]
  v_pk_fma_f32 v[6:7], v[84:85], v[84:85], v[6:7]
  v_pk_add_f32 v[4:5], v[4:5], v[86:87]
  v_pk_fma_f32 v[6:7], v[86:87], v[86:87], v[6:7]
  v_pk_add_f32 v[4:5], v[4:5], v[88:89]
  v_pk_fma_f32 v[6:7], v[88:89], v[88:89], v[6:7]
  v_pk_add_f32 v[4:5], v[4:5], v[90:91]
  v_pk_fma_f32 v[6:7], v[90:91], v[90:91], v[6:7]
  v_pk_add_f32 v[4:5], v[4:5], v[92:93]
  v_pk_fma_f32 v[6:7], v[92:93], v[92:93], v[6:7]
  v_pk_add_f32 v[4:5], v[4:5], v[94:95]
  v_pk_fma_f32 v[6:7], v[94:95], v[94:95], v[6:7]
  v_pk_add_f32 v[4:5], v[4:5], v[96:97]
  v_pk_fma_f32 v[6:7], v[96:97], v[96:97], v[6:7]
  v_pk_add_f32 v[4:5], v[4:5], v[98:99]
  v_pk_fma_f32 v[6:7], v[98:99], v[98:99], v[6:7]
  v_pk_add_f32 v[4:5], v[4:5], v[100:101]
  v_pk_fma_f32 v[6:7], v[100:101], v[100:101], v[6:7]
  v_pk_add_f32 v[4:5], v[4:5], v[102:103]
  v_pk_fma_f32 v[6:7], v[102:103], v[102:103], v[6:7]
  v_pk_add_f32 v[4:5], v[4:5], v[104:105]
  v_pk_fma_f32 v[6:7], v[104:105], v[104:105], v[6:7]
  v_pk_add_f32 v[4:5], v[4:5], v[106:107]
  v_pk_fma_f32 v[6:7], v[106:107], v[106:107], v[6:7]
  v_pk_add_f32 v[4:5], v[4:5], v[108:109]
  v_pk_fma_f32 v[6:7], v[108:109], v[108:109], v[6:7]
  v_pk_add_f32 v[4:5], v[4:5], v[110:111]
  v_pk_fma_f32 v[6:7], v[110:111], v[110:111], v[6:7]
  v_add_f32 v4, v4, v5
  v_add_f32 v6, v6, v7
  s_nop 1
  v_add_f32_dpp v4, v4, v4 row_ror:8 row_mask:0xf bank_mask:0xf
  v_add_f32_dpp v6, v6, v6 row_ror:8 row_mask:0xf bank_mask:0xf
  s_nop 1
  v_add_f32_dpp v4, v4, v4 row_ror:4 row_mask:0xf bank_mask:0xf
  v_add_f32_dpp v6, v6, v6 row_ror:4 row_mask:0xf bank_mask:0xf
  s_nop 1
  v_add_f32_dpp v4, v4, v4 row_ror:2 row_mask:0xf bank_mask:0xf
  v_add_f32_dpp v6, v6, v6 row_ror:2 row_mask:0xf bank_mask:0xf
  s_nop 1
  v_add_f32_dpp v4, v4, v4 row_ror:1 row_mask:0xf bank_mask:0xf
  v_add_f32_dpp v6, v6, v6 row_ror:1 row_mask:0xf bank_mask:0xf
  v_mul_f32 v4, 0x3b000000, v4
  v_mul_f32 v6, 0x3b000000, v6
  v_fma_f32 v6, -v4, v4, v6
  v_max_f32 v6, 0, v6
  v_cvt_pk_bf16_f32 v112, v4, v4
  v_lshlrev_b32 v112, 16, v112
  v_cvt_pk_bf16_f32 v30, v6, v6
  v_lshlrev_b32 v30, 16, v30
  v_add_f32 v30, 0x3727c5ac, v30
  v_cvt_pk_bf16_f32 v30, v30, v30
  v_lshlrev_b32 v30, 16, v30
  v_sqrt_f32 v15, v30
  s_nop 0
  v_cvt_pk_bf16_f32 v15, v15, v15
  v_lshlrev_b32 v15, 16, v15
  v_rcp_f32 v114, v15
  s_nop 0
  v_sub_f32 v112, 0, v112
  v_mov_b32 v113, v112
  v_mov_b32 v115, v114
  v_pk_add_f32 v[80:81], v[80:81], v[112:113]
  v_cvt_pk_bf16_f32 v32, v80, v81
  v_lshlrev_b32 v80, 16, v32
  v_and_b32 v81, 0xffff0000, v32
  v_pk_mul_f32 v[80:81], v[80:81], v[114:115]
  v_cvt_pk_bf16_f32 v32, v80, v81
  v_pk_add_f32 v[82:83], v[82:83], v[112:113]
  v_cvt_pk_bf16_f32 v33, v82, v83
  v_lshlrev_b32 v82, 16, v33
  v_and_b32 v83, 0xffff0000, v33
  v_pk_mul_f32 v[82:83], v[82:83], v[114:115]
  v_cvt_pk_bf16_f32 v33, v82, v83
  v_pk_add_f32 v[84:85], v[84:85], v[112:113]
  v_cvt_pk_bf16_f32 v34, v84, v85
  v_lshlrev_b32 v84, 16, v34
  v_and_b32 v85, 0xffff0000, v34
  v_pk_mul_f32 v[84:85], v[84:85], v[114:115]
  v_cvt_pk_bf16_f32 v34, v84, v85
  v_pk_add_f32 v[86:87], v[86:87], v[112:113]
  v_cvt_pk_bf16_f32 v35, v86, v87
  v_lshlrev_b32 v86, 16, v35
  v_and_b32 v87, 0xffff0000, v35
  v_pk_mul_f32 v[86:87], v[86:87], v[114:115]
  v_cvt_pk_bf16_f32 v35, v86, v87
  v_pk_add_f32 v[88:89], v[88:89], v[112:113]
  v_cvt_pk_bf16_f32 v36, v88, v89
  v_lshlrev_b32 v88, 16, v36
  v_and_b32 v89, 0xffff0000, v36
  v_pk_mul_f32 v[88:89], v[88:89], v[114:115]
  v_cvt_pk_bf16_f32 v36, v88, v89
  v_pk_add_f32 v[90:91], v[90:91], v[112:113]
  v_cvt_pk_bf16_f32 v37, v90, v91
  v_lshlrev_b32 v90, 16, v37
  v_and_b32 v91, 0xffff0000, v37
  v_pk_mul_f32 v[90:91], v[90:91], v[114:115]
  v_cvt_pk_bf16_f32 v37, v90, v91
  v_pk_add_f32 v[92:93], v[92:93], v[112:113]
  v_cvt_pk_bf16_f32 v38, v92, v93
  v_lshlrev_b32 v92, 16, v38
  v_and_b32 v93, 0xffff0000, v38
  v_pk_mul_f32 v[92:93], v[92:93], v[114:115]
  v_cvt_pk_bf16_f32 v38, v92, v93
  v_pk_add_f32 v[94:95], v[94:95], v[112:113]
  v_cvt_pk_bf16_f32 v39, v94, v95
  v_lshlrev_b32 v94, 16, v39
  v_and_b32 v95, 0xffff0000, v39
  v_pk_mul_f32 v[94:95], v[94:95], v[114:115]
  v_cvt_pk_bf16_f32 v39, v94, v95
  v_pk_add_f32 v[96:97], v[96:97], v[112:113]
  v_cvt_pk_bf16_f32 v40, v96, v97
  v_lshlrev_b32 v96, 16, v40
  v_and_b32 v97, 0xffff0000, v40
  v_pk_mul_f32 v[96:97], v[96:97], v[114:115]
  v_cvt_pk_bf16_f32 v40, v96, v97
  v_pk_add_f32 v[98:99], v[98:99], v[112:113]
  v_cvt_pk_bf16_f32 v41, v98, v99
  v_lshlrev_b32 v98, 16, v41
  v_and_b32 v99, 0xffff0000, v41
  v_pk_mul_f32 v[98:99], v[98:99], v[114:115]
  v_cvt_pk_bf16_f32 v41, v98, v99
  v_pk_add_f32 v[100:101], v[100:101], v[112:113]
  v_cvt_pk_bf16_f32 v42, v100, v101
  v_lshlrev_b32 v100, 16, v42
  v_and_b32 v101, 0xffff0000, v42
  v_pk_mul_f32 v[100:101], v[100:101], v[114:115]
  v_cvt_pk_bf16_f32 v42, v100, v101
  v_pk_add_f32 v[102:103], v[102:103], v[112:113]
  v_cvt_pk_bf16_f32 v43, v102, v103
  v_lshlrev_b32 v102, 16, v43
  v_and_b32 v103, 0xffff0000, v43
  v_pk_mul_f32 v[102:103], v[102:103], v[114:115]
  v_cvt_pk_bf16_f32 v43, v102, v103
  v_pk_add_f32 v[104:105], v[104:105], v[112:113]
  v_cvt_pk_bf16_f32 v44, v104, v105
  v_lshlrev_b32 v104, 16, v44
  v_and_b32 v105, 0xffff0000, v44
  v_pk_mul_f32 v[104:105], v[104:105], v[114:115]
  v_cvt_pk_bf16_f32 v44, v104, v105
  v_pk_add_f32 v[106:107], v[106:107], v[112:113]
  v_cvt_pk_bf16_f32 v45, v106, v107
  v_lshlrev_b32 v106, 16, v45
  v_and_b32 v107, 0xffff0000, v45
  v_pk_mul_f32 v[106:107], v[106:107], v[114:115]
  v_cvt_pk_bf16_f32 v45, v106, v107
  v_pk_add_f32 v[108:109], v[108:109], v[112:113]
  v_cvt_pk_bf16_f32 v46, v108, v109
  v_lshlrev_b32 v108, 16, v46
  v_and_b32 v109, 0xffff0000, v46
  v_pk_mul_f32 v[108:109], v[108:109], v[114:115]
  v_cvt_pk_bf16_f32 v46, v108, v109
  v_pk_add_f32 v[110:111], v[110:111], v[112:113]
  v_cvt_pk_bf16_f32 v47, v110, v111
  v_lshlrev_b32 v110, 16, v47
  v_and_b32 v111, 0xffff0000, v47
  v_pk_mul_f32 v[110:111], v[110:111], v[114:115]
  v_cvt_pk_bf16_f32 v47, v110, v111
  ds_write_b128 v13, v[32:35] offset:0
  ds_write_b128 v13, v[36:39] offset:256
  ds_write_b128 v13, v[40:43] offset:512
  ds_write_b128 v13, v[44:47] offset:768
  s_waitcnt vmcnt(0)
  v_lshlrev_b32 v80, 16, v48
  v_and_b32 v81, 0xffff0000, v48
  v_lshlrev_b32 v82, 16, v49
  v_and_b32 v83, 0xffff0000, v49
  v_lshlrev_b32 v84, 16, v50
  v_and_b32 v85, 0xffff0000, v50
  v_lshlrev_b32 v86, 16, v51
  v_and_b32 v87, 0xffff0000, v51
  v_lshlrev_b32 v88, 16, v52
  v_and_b32 v89, 0xffff0000, v52
  v_lshlrev_b32 v90, 16, v53
  v_and_b32 v91, 0xffff0000, v53
  v_lshlrev_b32 v92, 16, v54
  v_and_b32 v93, 0xffff0000, v54
  v_lshlrev_b32 v94, 16, v55
  v_and_b32 v95, 0xffff0000, v55
  v_lshlrev_b32 v96, 16, v56
  v_and_b32 v97, 0xffff0000, v56
  v_lshlrev_b32 v98, 16, v57
  v_and_b32 v99, 0xffff0000, v57
  v_lshlrev_b32 v100, 16, v58
  v_and_b32 v101, 0xffff0000, v58
  v_lshlrev_b32 v102, 16, v59
  v_and_b32 v103, 0xffff0000, v59
  v_lshlrev_b32 v104, 16, v60
  v_and_b32 v105, 0xffff0000, v60
  v_lshlrev_b32 v106, 16, v61
  v_and_b32 v107, 0xffff0000, v61
  v_lshlrev_b32 v108, 16, v62
  v_and_b32 v109, 0xffff0000, v62
  v_lshlrev_b32 v110, 16, v63
  v_and_b32 v111, 0xffff0000, v63
  v_pk_add_f32 v[4:5], v[80:81], v[82:83]
  v_pk_mul_f32 v[6:7], v[80:81], v[80:81]
  v_pk_fma_f32 v[6:7], v[82:83], v[82:83], v[6:7]
  v_pk_add_f32 v[4:5], v[4:5], v[84:85]
  v_pk_fma_f32 v[6:7], v[84:85], v[84:85], v[6:7]
  v_pk_add_f32 v[4:5], v[4:5], v[86:87]
  v_pk_fma_f32 v[6:7], v[86:87], v[86:87], v[6:7]
  v_pk_add_f32 v[4:5], v[4:5], v[88:89]
  v_pk_fma_f32 v[6:7], v[88:89], v[88:89], v[6:7]
  v_pk_add_f32 v[4:5], v[4:5], v[90:91]
  v_pk_fma_f32 v[6:7], v[90:91], v[90:91], v[6:7]
  v_pk_add_f32 v[4:5], v[4:5], v[92:93]
  v_pk_fma_f32 v[6:7], v[92:93], v[92:93], v[6:7]
  v_pk_add_f32 v[4:5], v[4:5], v[94:95]
  v_pk_fma_f32 v[6:7], v[94:95], v[94:95], v[6:7]
  v_pk_add_f32 v[4:5], v[4:5], v[96:97]
  v_pk_fma_f32 v[6:7], v[96:97], v[96:97], v[6:7]
  v_pk_add_f32 v[4:5], v[4:5], v[98:99]
  v_pk_fma_f32 v[6:7], v[98:99], v[98:99], v[6:7]
  v_pk_add_f32 v[4:5], v[4:5], v[100:101]
  v_pk_fma_f32 v[6:7], v[100:101], v[100:101], v[6:7]
  v_pk_add_f32 v[4:5], v[4:5], v[102:103]
  v_pk_fma_f32 v[6:7], v[102:103], v[102:103], v[6:7]
  v_pk_add_f32 v[4:5], v[4:5], v[104:105]
  v_pk_fma_f32 v[6:7], v[104:105], v[104:105], v[6:7]
  v_pk_add_f32 v[4:5], v[4:5], v[106:107]
  v_pk_fma_f32 v[6:7], v[106:107], v[106:107], v[6:7]
  v_pk_add_f32 v[4:5], v[4:5], v[108:109]
  v_pk_fma_f32 v[6:7], v[108:109], v[108:109], v[6:7]
  v_pk_add_f32 v[4:5], v[4:5], v[110:111]
  v_pk_fma_f32 v[6:7], v[110:111], v[110:111], v[6:7]
  v_add_f32 v4, v4, v5
  v_add_f32 v6, v6, v7
  s_nop 1
  v_add_f32_dpp v4, v4, v4 row_ror:8 row_mask:0xf bank_mask:0xf
  v_add_f32_dpp v6, v6, v6 row_ror:8 row_mask:0xf bank_mask:0xf
  s_nop 1
  v_add_f32_dpp v4, v4, v4 row_ror:4 row_mask:0xf bank_mask:0xf
  v_add_f32_dpp v6, v6, v6 row_ror:4 row_mask:0xf bank_mask:0xf
  s_nop 1
  v_add_f32_dpp v4, v4, v4 row_ror:2 row_mask:0xf bank_mask:0xf
  v_add_f32_dpp v6, v6, v6 row_ror:2 row_mask:0xf bank_mask:0xf
  s_nop 1
  v_add_f32_dpp v4, v4, v4 row_ror:1 row_mask:0xf bank_mask:0xf
  v_add_f32_dpp v6, v6, v6 row_ror:1 row_mask:0xf bank_mask:0xf
  v_mul_f32 v4, 0x3b000000, v4
  v_mul_f32 v6, 0x3b000000, v6
  v_fma_f32 v6, -v4, v4, v6
  v_max_f32 v6, 0, v6
  v_cvt_pk_bf16_f32 v112, v4, v4
  v_lshlrev_b32 v112, 16, v112
  v_cvt_pk_bf16_f32 v30, v6, v6
  v_lshlrev_b32 v30, 16, v30
  v_add_f32 v30, 0x3727c5ac, v30
  v_cvt_pk_bf16_f32 v30, v30, v30
  v_lshlrev_b32 v30, 16, v30
  v_sqrt_f32 v15, v30
  s_nop 0
  v_cvt_pk_bf16_f32 v15, v15, v15
  v_lshlrev_b32 v15, 16, v15
  v_rcp_f32 v114, v15
  s_nop 0
  v_sub_f32 v112, 0, v112
  v_mov_b32 v113, v112
  v_mov_b32 v115, v114
  v_pk_add_f32 v[80:81], v[80:81], v[112:113]
  v_cvt_pk_bf16_f32 v48, v80, v81
  v_lshlrev_b32 v80, 16, v48
  v_and_b32 v81, 0xffff0000, v48
  v_pk_mul_f32 v[80:81], v[80:81], v[114:115]
  v_cvt_pk_bf16_f32 v48, v80, v81
  v_pk_add_f32 v[82:83], v[82:83], v[112:113]
  v_cvt_pk_bf16_f32 v49, v82, v83
  v_lshlrev_b32 v82, 16, v49
  v_and_b32 v83, 0xffff0000, v49
  v_pk_mul_f32 v[82:83], v[82:83], v[114:115]
  v_cvt_pk_bf16_f32 v49, v82, v83
  v_pk_add_f32 v[84:85], v[84:85], v[112:113]
  v_cvt_pk_bf16_f32 v50, v84, v85
  v_lshlrev_b32 v84, 16, v50
  v_and_b32 v85, 0xffff0000, v50
  v_pk_mul_f32 v[84:85], v[84:85], v[114:115]
  v_cvt_pk_bf16_f32 v50, v84, v85
  v_pk_add_f32 v[86:87], v[86:87], v[112:113]
  v_cvt_pk_bf16_f32 v51, v86, v87
  v_lshlrev_b32 v86, 16, v51
  v_and_b32 v87, 0xffff0000, v51
  v_pk_mul_f32 v[86:87], v[86:87], v[114:115]
  v_cvt_pk_bf16_f32 v51, v86, v87
  v_pk_add_f32 v[88:89], v[88:89], v[112:113]
  v_cvt_pk_bf16_f32 v52, v88, v89
  v_lshlrev_b32 v88, 16, v52
  v_and_b32 v89, 0xffff0000, v52
  v_pk_mul_f32 v[88:89], v[88:89], v[114:115]
  v_cvt_pk_bf16_f32 v52, v88, v89
  v_pk_add_f32 v[90:91], v[90:91], v[112:113]
  v_cvt_pk_bf16_f32 v53, v90, v91
  v_lshlrev_b32 v90, 16, v53
  v_and_b32 v91, 0xffff0000, v53
  v_pk_mul_f32 v[90:91], v[90:91], v[114:115]
  v_cvt_pk_bf16_f32 v53, v90, v91
  v_pk_add_f32 v[92:93], v[92:93], v[112:113]
  v_cvt_pk_bf16_f32 v54, v92, v93
  v_lshlrev_b32 v92, 16, v54
  v_and_b32 v93, 0xffff0000, v54
  v_pk_mul_f32 v[92:93], v[92:93], v[114:115]
  v_cvt_pk_bf16_f32 v54, v92, v93
  v_pk_add_f32 v[94:95], v[94:95], v[112:113]
  v_cvt_pk_bf16_f32 v55, v94, v95
  v_lshlrev_b32 v94, 16, v55
  v_and_b32 v95, 0xffff0000, v55
  v_pk_mul_f32 v[94:95], v[94:95], v[114:115]
  v_cvt_pk_bf16_f32 v55, v94, v95
  v_pk_add_f32 v[96:97], v[96:97], v[112:113]
  v_cvt_pk_bf16_f32 v56, v96, v97
  v_lshlrev_b32 v96, 16, v56
  v_and_b32 v97, 0xffff0000, v56
  v_pk_mul_f32 v[96:97], v[96:97], v[114:115]
  v_cvt_pk_bf16_f32 v56, v96, v97
  v_pk_add_f32 v[98:99], v[98:99], v[112:113]
  v_cvt_pk_bf16_f32 v57, v98, v99
  v_lshlrev_b32 v98, 16, v57
  v_and_b32 v99, 0xffff0000, v57
  v_pk_mul_f32 v[98:99], v[98:99], v[114:115]
  v_cvt_pk_bf16_f32 v57, v98, v99
  v_pk_add_f32 v[100:101], v[100:101], v[112:113]
  v_cvt_pk_bf16_f32 v58, v100, v101
  v_lshlrev_b32 v100, 16, v58
  v_and_b32 v101, 0xffff0000, v58
  v_pk_mul_f32 v[100:101], v[100:101], v[114:115]
  v_cvt_pk_bf16_f32 v58, v100, v101
  v_pk_add_f32 v[102:103], v[102:103], v[112:113]
  v_cvt_pk_bf16_f32 v59, v102, v103
  v_lshlrev_b32 v102, 16, v59
  v_and_b32 v103, 0xffff0000, v59
  v_pk_mul_f32 v[102:103], v[102:103], v[114:115]
  v_cvt_pk_bf16_f32 v59, v102, v103
  v_pk_add_f32 v[104:105], v[104:105], v[112:113]
  v_cvt_pk_bf16_f32 v60, v104, v105
  v_lshlrev_b32 v104, 16, v60
  v_and_b32 v105, 0xffff0000, v60
  v_pk_mul_f32 v[104:105], v[104:105], v[114:115]
  v_cvt_pk_bf16_f32 v60, v104, v105
  v_pk_add_f32 v[106:107], v[106:107], v[112:113]
  v_cvt_pk_bf16_f32 v61, v106, v107
  v_lshlrev_b32 v106, 16, v61
  v_and_b32 v107, 0xffff0000, v61
  v_pk_mul_f32 v[106:107], v[106:107], v[114:115]
  v_cvt_pk_bf16_f32 v61, v106, v107
  v_pk_add_f32 v[108:109], v[108:109], v[112:113]
  v_cvt_pk_bf16_f32 v62, v108, v109
  v_lshlrev_b32 v108, 16, v62
  v_and_b32 v109, 0xffff0000, v62
  v_pk_mul_f32 v[108:109], v[108:109], v[114:115]
  v_cvt_pk_bf16_f32 v62, v108, v109
  v_pk_add_f32 v[110:111], v[110:111], v[112:113]
  v_cvt_pk_bf16_f32 v63, v110, v111
  v_lshlrev_b32 v110, 16, v63
  v_and_b32 v111, 0xffff0000, v63
  v_pk_mul_f32 v[110:111], v[110:111], v[114:115]
  v_cvt_pk_bf16_f32 v63, v110, v111
  ds_write_b128 v13, v[48:51] offset:32768
  ds_write_b128 v13, v[52:55] offset:33024
  ds_write_b128 v13, v[56:59] offset:33280
  ds_write_b128 v13, v[60:63] offset:33536
  s_waitcnt lgkmcnt(0)
  s_barrier
  v_mov_b32 v80, 0
  v_mov_b32 v81, 0
  v_mov_b32 v82, 0
  v_mov_b32 v83, 0
  v_mov_b32 v84, 0
  v_mov_b32 v85, 0
  v_mov_b32 v86, 0
  v_mov_b32 v87, 0
  v_mov_b32 v88, 0
  v_mov_b32 v89, 0
  v_mov_b32 v90, 0
  v_mov_b32 v91, 0
  v_mov_b32 v92, 0
  v_mov_b32 v93, 0
  v_mov_b32 v94, 0
  v_mov_b32 v95, 0
  v_mov_b32 v96, 0
  v_mov_b32 v97, 0
  v_mov_b32 v98, 0
  v_mov_b32 v99, 0
  v_mov_b32 v100, 0
  v_mov_b32 v101, 0
  v_mov_b32 v102, 0
  v_mov_b32 v103, 0
  v_mov_b32 v104, 0
  v_mov_b32 v105, 0
  v_mov_b32 v106, 0
  v_mov_b32 v107, 0
  ds_read_b128 v[32:35], v16 offset:0
  ds_read_b64_tr_b16 v[44:45], v24 offset:0
  ds_read_b64_tr_b16 v[46:47], v24 offset:1536
  ds_read_b128 v[36:39], v16 offset:16384
  ds_read_b64_tr_b16 v[48:49], v25 offset:0
  ds_read_b64_tr_b16 v[50:51], v25 offset:1536
  ds_read_b128 v[40:43], v20 offset:0
  ds_read_b64_tr_b16 v[52:53], v26 offset:0
  ds_read_b64_tr_b16 v[54:55], v26 offset:1536
  s_waitcnt lgkmcnt(0)
  v_mfma_f32_16x16x32_bf16 v[80:83], v[44:47], v[32:35], v[80:83]
  ds_read_b128 v[56:59], v17 offset:0
  v_mfma_f32_16x16x32_bf16 v[92:95], v[44:47], v[36:39], v[92:95]
  ds_read_b64_tr_b16 v[68:69], v24 offset:12288
  ds_read_b64_tr_b16 v[70:71], v24 offset:13824
  v_mfma_f32_16x16x32_bf16 v[84:87], v[48:51], v[32:35], v[84:87]
  ds_read_b128 v[60:63], v17 offset:16384
  v_mfma_f32_16x16x32_bf16 v[96:99], v[48:51], v[36:39], v[96:99]
  ds_read_b64_tr_b16 v[72:73], v25 offset:12288
  ds_read_b64_tr_b16 v[74:75], v25 offset:13824
  v_mfma_f32_16x16x32_bf16 v[104:107], v[48:51], v[40:43], v[104:107]
  ds_read_b128 v[64:67], v21 offset:0
  v_mfma_f32_16x16x32_bf16 v[88:91], v[52:55], v[32:35], v[88:91]
  ds_read_b64_tr_b16 v[76:77], v26 offset:12288
  ds_read_b64_tr_b16 v[78:79], v26 offset:13824
  v_mfma_f32_16x16x32_bf16 v[100:103], v[52:55], v[36:39], v[100:103]
  s_waitcnt lgkmcnt(0)
  s_barrier
  v_mfma_f32_16x16x32_bf16 v[80:83], v[68:71], v[56:59], v[80:83]
  ds_read_b128 v[32:35], v18 offset:0
  v_mfma_f32_16x16x32_bf16 v[92:95], v[68:71], v[60:63], v[92:95]
  ds_read_b64_tr_b16 v[44:45], v24 offset:24576
  ds_read_b64_tr_b16 v[46:47], v24 offset:26112
  v_mfma_f32_16x16x32_bf16 v[84:87], v[72:75], v[56:59], v[84:87]
  ds_read_b128 v[36:39], v18 offset:16384
  v_mfma_f32_16x16x32_bf16 v[96:99], v[72:75], v[60:63], v[96:99]
  ds_read_b64_tr_b16 v[48:49], v25 offset:24576
  ds_read_b64_tr_b16 v[50:51], v25 offset:26112
  v_mfma_f32_16x16x32_bf16 v[104:107], v[72:75], v[64:67], v[104:107]
  ds_read_b128 v[40:43], v22 offset:0
  v_mfma_f32_16x16x32_bf16 v[88:91], v[76:79], v[56:59], v[88:91]
  ds_read_b64_tr_b16 v[52:53], v26 offset:24576
  ds_read_b64_tr_b16 v[54:55], v26 offset:26112
  v_mfma_f32_16x16x32_bf16 v[100:103], v[76:79], v[60:63], v[100:103]
  s_waitcnt lgkmcnt(0)
  v_mfma_f32_16x16x32_bf16 v[80:83], v[44:47], v[32:35], v[80:83]
  ds_read_b128 v[56:59], v19 offset:0
  v_mfma_f32_16x16x32_bf16 v[92:95], v[44:47], v[36:39], v[92:95]
  ds_read_b64_tr_b16 v[68:69], v24 offset:36864
  ds_read_b64_tr_b16 v[70:71], v24 offset:38400
  v_mfma_f32_16x16x32_bf16 v[84:87], v[48:51], v[32:35], v[84:87]
  ds_read_b128 v[60:63], v19 offset:16384
  v_mfma_f32_16x16x32_bf16 v[96:99], v[48:51], v[36:39], v[96:99]
  ds_read_b64_tr_b16 v[72:73], v25 offset:36864
  ds_read_b64_tr_b16 v[74:75], v25 offset:38400
  v_mfma_f32_16x16x32_bf16 v[104:107], v[48:51], v[40:43], v[104:107]
  ds_read_b128 v[64:67], v23 offset:0
  v_mfma_f32_16x16x32_bf16 v[88:91], v[52:55], v[32:35], v[88:91]
  ds_read_b64_tr_b16 v[76:77], v26 offset:36864
  ds_read_b64_tr_b16 v[78:79], v26 offset:38400
  v_mfma_f32_16x16x32_bf16 v[100:103], v[52:55], v[36:39], v[100:103]
  s_waitcnt lgkmcnt(0)
  s_barrier
  v_mfma_f32_16x16x32_bf16 v[80:83], v[68:71], v[56:59], v[80:83]
  ds_read_b128 v[32:35], v16 offset:256
  v_mfma_f32_16x16x32_bf16 v[92:95], v[68:71], v[60:63], v[92:95]
  ds_read_b64_tr_b16 v[44:45], v24 offset:49152
  ds_read_b64_tr_b16 v[46:47], v24 offset:50688
  v_mfma_f32_16x16x32_bf16 v[84:87], v[72:75], v[56:59], v[84:87]
  ds_read_b128 v[36:39], v16 offset:16640
  v_mfma_f32_16x16x32_bf16 v[96:99], v[72:75], v[60:63], v[96:99]
  ds_read_b64_tr_b16 v[48:49], v25 offset:49152
  ds_read_b64_tr_b16 v[50:51], v25 offset:50688
  v_mfma_f32_16x16x32_bf16 v[104:107], v[72:75], v[64:67], v[104:107]
  ds_read_b128 v[40:43], v20 offset:256
  v_mfma_f32_16x16x32_bf16 v[88:91], v[76:79], v[56:59], v[88:91]
  ds_read_b64_tr_b16 v[52:53], v26 offset:49152
  ds_read_b64_tr_b16 v[54:55], v26 offset:50688
  v_mfma_f32_16x16x32_bf16 v[100:103], v[76:79], v[60:63], v[100:103]
  s_waitcnt lgkmcnt(0)
  v_mfma_f32_16x16x32_bf16 v[80:83], v[44:47], v[32:35], v[80:83]
  ds_read_b128 v[56:59], v17 offset:256
  v_mfma_f32_16x16x32_bf16 v[92:95], v[44:47], v[36:39], v[92:95]
  ds_read_b64_tr_b16 v[68:69], v24 offset:61440
  ds_read_b64_tr_b16 v[70:71], v24 offset:62976
  v_mfma_f32_16x16x32_bf16 v[84:87], v[48:51], v[32:35], v[84:87]
  ds_read_b128 v[60:63], v17 offset:16640
  v_mfma_f32_16x16x32_bf16 v[96:99], v[48:51], v[36:39], v[96:99]
  ds_read_b64_tr_b16 v[72:73], v25 offset:61440
  ds_read_b64_tr_b16 v[74:75], v25 offset:62976
  v_mfma_f32_16x16x32_bf16 v[104:107], v[48:51], v[40:43], v[104:107]
  ds_read_b128 v[64:67], v21 offset:256
  v_mfma_f32_16x16x32_bf16 v[88:91], v[52:55], v[32:35], v[88:91]
  ds_read_b64_tr_b16 v[76:77], v26 offset:61440
  ds_read_b64_tr_b16 v[78:79], v26 offset:62976
  v_mfma_f32_16x16x32_bf16 v[100:103], v[52:55], v[36:39], v[100:103]
  s_waitcnt lgkmcnt(0)
  s_barrier
  v_mfma_f32_16x16x32_bf16 v[80:83], v[68:71], v[56:59], v[80:83]
  ds_read_b128 v[32:35], v18 offset:256
  v_mfma_f32_16x16x32_bf16 v[92:95], v[68:71], v[60:63], v[92:95]
  ds_read_b64_tr_b16 v[44:45], v24 offset:0
  ds_read_b64_tr_b16 v[46:47], v24 offset:1536
  v_mfma_f32_16x16x32_bf16 v[84:87], v[72:75], v[56:59], v[84:87]
  ds_read_b128 v[36:39], v18 offset:16640
  v_mfma_f32_16x16x32_bf16 v[96:99], v[72:75], v[60:63], v[96:99]
  ds_read_b64_tr_b16 v[48:49], v25 offset:0
  ds_read_b64_tr_b16 v[50:51], v25 offset:1536
  v_mfma_f32_16x16x32_bf16 v[104:107], v[72:75], v[64:67], v[104:107]
  ds_read_b128 v[40:43], v22 offset:256
  v_mfma_f32_16x16x32_bf16 v[88:91], v[76:79], v[56:59], v[88:91]
  ds_read_b64_tr_b16 v[52:53], v26 offset:0
  ds_read_b64_tr_b16 v[54:55], v26 offset:1536
  v_mfma_f32_16x16x32_bf16 v[100:103], v[76:79], v[60:63], v[100:103]
  s_waitcnt lgkmcnt(0)
  v_mfma_f32_16x16x32_bf16 v[80:83], v[44:47], v[32:35], v[80:83]
  ds_read_b128 v[56:59], v19 offset:256
  v_mfma_f32_16x16x32_bf16 v[92:95], v[44:47], v[36:39], v[92:95]
  ds_read_b64_tr_b16 v[68:69], v24 offset:12288
  ds_read_b64_tr_b16 v[70:71], v24 offset:13824
  v_mfma_f32_16x16x32_bf16 v[84:87], v[48:51], v[32:35], v[84:87]
  ds_read_b128 v[60:63], v19 offset:16640
  v_mfma_f32_16x16x32_bf16 v[96:99], v[48:51], v[36:39], v[96:99]
  ds_read_b64_tr_b16 v[72:73], v25 offset:12288
  ds_read_b64_tr_b16 v[74:75], v25 offset:13824
  v_mfma_f32_16x16x32_bf16 v[104:107], v[48:51], v[40:43], v[104:107]
  ds_read_b128 v[64:67], v23 offset:256
  v_mfma_f32_16x16x32_bf16 v[88:91], v[52:55], v[32:35], v[88:91]
  ds_read_b64_tr_b16 v[76:77], v26 offset:12288
  ds_read_b64_tr_b16 v[78:79], v26 offset:13824
  v_mfma_f32_16x16x32_bf16 v[100:103], v[52:55], v[36:39], v[100:103]
  s_waitcnt lgkmcnt(0)
  s_barrier
  v_mfma_f32_16x16x32_bf16 v[80:83], v[68:71], v[56:59], v[80:83]
  ds_read_b128 v[32:35], v16 offset:512
  v_mfma_f32_16x16x32_bf16 v[92:95], v[68:71], v[60:63], v[92:95]
  ds_read_b64_tr_b16 v[44:45], v24 offset:24576
  ds_read_b64_tr_b16 v[46:47], v24 offset:26112
  v_mfma_f32_16x16x32_bf16 v[84:87], v[72:75], v[56:59], v[84:87]
  ds_read_b128 v[36:39], v16 offset:16896
  v_mfma_f32_16x16x32_bf16 v[96:99], v[72:75], v[60:63], v[96:99]
  ds_read_b64_tr_b16 v[48:49], v25 offset:24576
  ds_read_b64_tr_b16 v[50:51], v25 offset:26112
  v_mfma_f32_16x16x32_bf16 v[104:107], v[72:75], v[64:67], v[104:107]
  ds_read_b128 v[40:43], v20 offset:512
  v_mfma_f32_16x16x32_bf16 v[88:91], v[76:79], v[56:59], v[88:91]
  ds_read_b64_tr_b16 v[52:53], v26 offset:24576
  ds_read_b64_tr_b16 v[54:55], v26 offset:26112
  v_mfma_f32_16x16x32_bf16 v[100:103], v[76:79], v[60:63], v[100:103]
  s_waitcnt lgkmcnt(0)
  v_mfma_f32_16x16x32_bf16 v[80:83], v[44:47], v[32:35], v[80:83]
  ds_read_b128 v[56:59], v17 offset:512
  v_mfma_f32_16x16x32_bf16 v[92:95], v[44:47], v[36:39], v[92:95]
  ds_read_b64_tr_b16 v[68:69], v24 offset:36864
  ds_read_b64_tr_b16 v[70:71], v24 offset:38400
  v_mfma_f32_16x16x32_bf16 v[84:87], v[48:51], v[32:35], v[84:87]
  ds_read_b128 v[60:63], v17 offset:16896
  v_mfma_f32_16x16x32_bf16 v[96:99], v[48:51], v[36:39], v[96:99]
  ds_read_b64_tr_b16 v[72:73], v25 offset:36864
  ds_read_b64_tr_b16 v[74:75], v25 offset:38400
  v_mfma_f32_16x16x32_bf16 v[104:107], v[48:51], v[40:43], v[104:107]
  ds_read_b128 v[64:67], v21 offset:512
  v_mfma_f32_16x16x32_bf16 v[88:91], v[52:55], v[32:35], v[88:91]
  ds_read_b64_tr_b16 v[76:77], v26 offset:36864
  ds_read_b64_tr_b16 v[78:79], v26 offset:38400
  v_mfma_f32_16x16x32_bf16 v[100:103], v[52:55], v[36:39], v[100:103]
  s_waitcnt lgkmcnt(0)
  s_barrier
  v_mfma_f32_16x16x32_bf16 v[80:83], v[68:71], v[56:59], v[80:83]
  ds_read_b128 v[32:35], v18 offset:512
  v_mfma_f32_16x16x32_bf16 v[92:95], v[68:71], v[60:63], v[92:95]
  ds_read_b64_tr_b16 v[44:45], v24 offset:49152
  ds_read_b64_tr_b16 v[46:47], v24 offset:50688
  v_mfma_f32_16x16x32_bf16 v[84:87], v[72:75], v[56:59], v[84:87]
  ds_read_b128 v[36:39], v18 offset:16896
  v_mfma_f32_16x16x32_bf16 v[96:99], v[72:75], v[60:63], v[96:99]
  ds_read_b64_tr_b16 v[48:49], v25 offset:49152
  ds_read_b64_tr_b16 v[50:51], v25 offset:50688
  v_mfma_f32_16x16x32_bf16 v[104:107], v[72:75], v[64:67], v[104:107]
  ds_read_b128 v[40:43], v22 offset:512
  v_mfma_f32_16x16x32_bf16 v[88:91], v[76:79], v[56:59], v[88:91]
  ds_read_b64_tr_b16 v[52:53], v26 offset:49152
  ds_read_b64_tr_b16 v[54:55], v26 offset:50688
  v_mfma_f32_16x16x32_bf16 v[100:103], v[76:79], v[60:63], v[100:103]
  s_waitcnt lgkmcnt(0)
  v_mfma_f32_16x16x32_bf16 v[80:83], v[44:47], v[32:35], v[80:83]
  ds_read_b128 v[56:59], v19 offset:512
  v_mfma_f32_16x16x32_bf16 v[92:95], v[44:47], v[36:39], v[92:95]
  ds_read_b64_tr_b16 v[68:69], v24 offset:61440
  ds_read_b64_tr_b16 v[70:71], v24 offset:62976
  v_mfma_f32_16x16x32_bf16 v[84:87], v[48:51], v[32:35], v[84:87]
  ds_read_b128 v[60:63], v19 offset:16896
  v_mfma_f32_16x16x32_bf16 v[96:99], v[48:51], v[36:39], v[96:99]
  ds_read_b64_tr_b16 v[72:73], v25 offset:61440
  ds_read_b64_tr_b16 v[74:75], v25 offset:62976
  v_mfma_f32_16x16x32_bf16 v[104:107], v[48:51], v[40:43], v[104:107]
  ds_read_b128 v[64:67], v23 offset:512
  v_mfma_f32_16x16x32_bf16 v[88:91], v[52:55], v[32:35], v[88:91]
  ds_read_b64_tr_b16 v[76:77], v26 offset:61440
  ds_read_b64_tr_b16 v[78:79], v26 offset:62976
  v_mfma_f32_16x16x32_bf16 v[100:103], v[52:55], v[36:39], v[100:103]
  s_waitcnt lgkmcnt(0)
  s_barrier
  v_mfma_f32_16x16x32_bf16 v[80:83], v[68:71], v[56:59], v[80:83]
  ds_read_b128 v[32:35], v16 offset:768
  v_mfma_f32_16x16x32_bf16 v[92:95], v[68:71], v[60:63], v[92:95]
  ds_read_b64_tr_b16 v[44:45], v24 offset:0
  ds_read_b64_tr_b16 v[46:47], v24 offset:1536
  v_mfma_f32_16x16x32_bf16 v[84:87], v[72:75], v[56:59], v[84:87]
  ds_read_b128 v[36:39], v16 offset:17152
  v_mfma_f32_16x16x32_bf16 v[96:99], v[72:75], v[60:63], v[96:99]
  ds_read_b64_tr_b16 v[48:49], v25 offset:0
  ds_read_b64_tr_b16 v[50:51], v25 offset:1536
  v_mfma_f32_16x16x32_bf16 v[104:107], v[72:75], v[64:67], v[104:107]
  ds_read_b128 v[40:43], v20 offset:768
  v_mfma_f32_16x16x32_bf16 v[88:91], v[76:79], v[56:59], v[88:91]
  ds_read_b64_tr_b16 v[52:53], v26 offset:0
  ds_read_b64_tr_b16 v[54:55], v26 offset:1536
  v_mfma_f32_16x16x32_bf16 v[100:103], v[76:79], v[60:63], v[100:103]
  s_waitcnt lgkmcnt(0)
  v_mfma_f32_16x16x32_bf16 v[80:83], v[44:47], v[32:35], v[80:83]
  ds_read_b128 v[56:59], v17 offset:768
  v_mfma_f32_16x16x32_bf16 v[92:95], v[44:47], v[36:39], v[92:95]
  ds_read_b64_tr_b16 v[68:69], v24 offset:12288
  ds_read_b64_tr_b16 v[70:71], v24 offset:13824
  v_mfma_f32_16x16x32_bf16 v[84:87], v[48:51], v[32:35], v[84:87]
  ds_read_b128 v[60:63], v17 offset:17152
  v_mfma_f32_16x16x32_bf16 v[96:99], v[48:51], v[36:39], v[96:99]
  ds_read_b64_tr_b16 v[72:73], v25 offset:12288
  ds_read_b64_tr_b16 v[74:75], v25 offset:13824
  v_mfma_f32_16x16x32_bf16 v[104:107], v[48:51], v[40:43], v[104:107]
  ds_read_b128 v[64:67], v21 offset:768
  v_mfma_f32_16x16x32_bf16 v[88:91], v[52:55], v[32:35], v[88:91]
  ds_read_b64_tr_b16 v[76:77], v26 offset:12288
  ds_read_b64_tr_b16 v[78:79], v26 offset:13824
  v_mfma_f32_16x16x32_bf16 v[100:103], v[52:55], v[36:39], v[100:103]
  s_waitcnt lgkmcnt(0)
  s_barrier
  v_mfma_f32_16x16x32_bf16 v[80:83], v[68:71], v[56:59], v[80:83]
  ds_read_b128 v[32:35], v18 offset:768
  v_mfma_f32_16x16x32_bf16 v[92:95], v[68:71], v[60:63], v[92:95]
  ds_read_b64_tr_b16 v[44:45], v24 offset:24576
  ds_read_b64_tr_b16 v[46:47], v24 offset:26112
  v_mfma_f32_16x16x32_bf16 v[84:87], v[72:75], v[56:59], v[84:87]
  ds_read_b128 v[36:39], v18 offset:17152
  v_mfma_f32_16x16x32_bf16 v[96:99], v[72:75], v[60:63], v[96:99]
  ds_read_b64_tr_b16 v[48:49], v25 offset:24576
  ds_read_b64_tr_b16 v[50:51], v25 offset:26112
  v_mfma_f32_16x16x32_bf16 v[104:107], v[72:75], v[64:67], v[104:107]
  ds_read_b128 v[40:43], v22 offset:768
  v_mfma_f32_16x16x32_bf16 v[88:91], v[76:79], v[56:59], v[88:91]
  ds_read_b64_tr_b16 v[52:53], v26 offset:24576
  ds_read_b64_tr_b16 v[54:55], v26 offset:26112
  v_mfma_f32_16x16x32_bf16 v[100:103], v[76:79], v[60:63], v[100:103]
  s_waitcnt lgkmcnt(0)
  v_mfma_f32_16x16x32_bf16 v[80:83], v[44:47], v[32:35], v[80:83]
  ds_read_b128 v[56:59], v19 offset:768
  v_mfma_f32_16x16x32_bf16 v[92:95], v[44:47], v[36:39], v[92:95]
  ds_read_b64_tr_b16 v[68:69], v24 offset:36864
  ds_read_b64_tr_b16 v[70:71], v24 offset:38400
  v_mfma_f32_16x16x32_bf16 v[84:87], v[48:51], v[32:35], v[84:87]
  ds_read_b128 v[60:63], v19 offset:17152
  v_mfma_f32_16x16x32_bf16 v[96:99], v[48:51], v[36:39], v[96:99]
  ds_read_b64_tr_b16 v[72:73], v25 offset:36864
  ds_read_b64_tr_b16 v[74:75], v25 offset:38400
  v_mfma_f32_16x16x32_bf16 v[104:107], v[48:51], v[40:43], v[104:107]
  ds_read_b128 v[64:67], v23 offset:768
  v_mfma_f32_16x16x32_bf16 v[88:91], v[52:55], v[32:35], v[88:91]
  ds_read_b64_tr_b16 v[76:77], v26 offset:36864
  ds_read_b64_tr_b16 v[78:79], v26 offset:38400
  v_mfma_f32_16x16x32_bf16 v[100:103], v[52:55], v[36:39], v[100:103]
  s_waitcnt lgkmcnt(0)
  v_mfma_f32_16x16x32_bf16 v[80:83], v[68:71], v[56:59], v[80:83]
  v_mfma_f32_16x16x32_bf16 v[92:95], v[68:71], v[60:63], v[92:95]
  v_mfma_f32_16x16x32_bf16 v[84:87], v[72:75], v[56:59], v[84:87]
  v_mfma_f32_16x16x32_bf16 v[96:99], v[72:75], v[60:63], v[96:99]
  v_mfma_f32_16x16x32_bf16 v[104:107], v[72:75], v[64:67], v[104:107]
  v_mfma_f32_16x16x32_bf16 v[88:91], v[76:79], v[56:59], v[88:91]
  v_mfma_f32_16x16x32_bf16 v[100:103], v[76:79], v[60:63], v[100:103]
  s_nop 9
  s_barrier
  s_mul_i32 s22, s19, 12800
  s_mul_i32 s23, s20, 96
  v_mul_u32_u24 v7, 400, v2
  v_lshl_add_u32 v7, v3, 3, v7
  v_add_u32 v7, s23, v7
  s_add_u32 s22, s22, 6400
  v_add_u32 v4, s22, v7
  s_lshl_b32 s23, s19, 5
  v_add_u32 v5, s23, v4
  v_add_u32 v5, 32, v5
  v_subrev_u32 v6, s23, v4
  v_add_u32 v6, 64, v6
  v_add_u32 v7, s23, v7
  v_add_u32 v7, 32, v7
  v_cvt_pk_bf16_f32 v32, v80, v81
  v_cvt_pk_bf16_f32 v33, v82, v83
  ds_write_b64 v4, v[32:33] offset:0
  v_cvt_pk_bf16_f32 v34, v84, v85
  v_cvt_pk_bf16_f32 v35, v86, v87
  ds_write_b64 v5, v[34:35] offset:0
  v_cvt_pk_bf16_f32 v36, v88, v89
  v_cvt_pk_bf16_f32 v37, v90, v91
  ds_write_b64 v6, v[36:37] offset:0
  v_cvt_pk_bf16_f32 v38, v92, v93
  v_cvt_pk_bf16_f32 v39, v94, v95
  ds_write_b64 v4, v[38:39] offset:6400
  v_cvt_pk_bf16_f32 v40, v96, v97
  v_cvt_pk_bf16_f32 v41, v98, v99
  ds_write_b64 v5, v[40:41] offset:6400
  v_cvt_pk_bf16_f32 v42, v100, v101
  v_cvt_pk_bf16_f32 v43, v102, v103
  ds_write_b64 v6, v[42:43] offset:6400
  v_cvt_pk_bf16_f32 v44, v104, v105
  v_cvt_pk_bf16_f32 v45, v106, v107
  ds_write_b64 v7, v[44:45]
  s_waitcnt lgkmcnt(0)
  s_barrier
  s_cmp_ge_u32 s18, 4
  s_cbranch_scc1 .Lend_k1a_kernel
  s_mul_i32 s22, s18, 96
  v_mul_u32_u24 v4, 400, v1
  v_add_u32 v4, s22, v4
  ds_read_b128 v[32:35], v4 offset:6400
  ds_read_b128 v[36:39], v4 offset:6416
  ds_read_b128 v[40:43], v4 offset:6432
  ds_read_b128 v[44:47], v4 offset:6448
  ds_read_b128 v[48:51], v4 offset:5632
  ds_read_b128 v[52:55], v4 offset:5648
  ds_read_b128 v[56:59], v4 offset:4832
  ds_read_b128 v[60:63], v4 offset:4848
  ds_read_b128 v[64:67], v4 offset:4032
  ds_read_b128 v[68:71], v4 offset:4048
  ds_read_b128 v[72:75], v4 offset:3232
  ds_read_b128 v[76:79], v4 offset:3248
  ds_read_b128 v[80:83], v4 offset:2432
  ds_read_b128 v[84:87], v4 offset:2448
  ds_read_b128 v[88:91], v4 offset:1632
  ds_read_b128 v[92:95], v4 offset:1648
  ds_read_b128 v[96:99], v4 offset:832
  ds_read_b128 v[100:103], v4 offset:848
  s_lshl_b32 s22, s16, 6
  v_add_u32 v5, s22, v1
  v_mov_b32 v6, 0xce6e6b28
  v_mov_b32 v8, 0
  v_mov_b32 v9, 0
  v_mov_b32 v10, 0
  v_mov_b32 v11, 0
  v_mov_b32 v12, 0
  v_mov_b32 v13, 0
  v_mov_b32 v14, 0
  v_mov_b32 v15, 0
  s_waitcnt lgkmcnt(14)
  v_dot2_f32_bf16 v8, v32, v40, v8
  v_dot2_f32_bf16 v8, v33, v41, v8
  v_dot2_f32_bf16 v8, v34, v42, v8
  v_dot2_f32_bf16 v8, v35, v43, v8
  v_dot2_f32_bf16 v8, v36, v44, v8
  v_dot2_f32_bf16 v8, v37, v45, v8
  v_dot2_f32_bf16 v8, v38, v46, v8
  v_dot2_f32_bf16 v8, v39, v47, v8
  s_waitcnt lgkmcnt(12)
  v_dot2_f32_bf16 v9, v32, v48, v9
  v_dot2_f32_bf16 v9, v33, v49, v9
  v_dot2_f32_bf16 v9, v34, v50, v9
  v_dot2_f32_bf16 v9, v35, v51, v9
  v_dot2_f32_bf16 v9, v36, v52, v9
  v_dot2_f32_bf16 v9, v37, v53, v9
  v_dot2_f32_bf16 v9, v38, v54, v9
  v_dot2_f32_bf16 v9, v39, v55, v9
  s_waitcnt lgkmcnt(10)
  v_dot2_f32_bf16 v10, v32, v56, v10
  v_dot2_f32_bf16 v10, v33, v57, v10
  v_dot2_f32_bf16 v10, v34, v58, v10
  v_dot2_f32_bf16 v10, v35, v59, v10
  v_dot2_f32_bf16 v10, v36, v60, v10
  v_dot2_f32_bf16 v10, v37, v61, v10
  v_dot2_f32_bf16 v10, v38, v62, v10
  v_dot2_f32_bf16 v10, v39, v63, v10
  s_waitcnt lgkmcnt(8)
  v_dot2_f32_bf16 v11, v32, v64, v11
  v_dot2_f32_bf16 v11, v33, v65, v11
  v_dot2_f32_bf16 v11, v34, v66, v11
  v_dot2_f32_bf16 v11, v35, v67, v11
  v_dot2_f32_bf16 v11, v36, v68, v11
  v_dot2_f32_bf16 v11, v37, v69, v11
  v_dot2_f32_bf16 v11, v38, v70, v11
  v_dot2_f32_bf16 v11, v39, v71, v11
  s_waitcnt lgkmcnt(6)
  v_dot2_f32_bf16 v12, v32, v72, v12
  v_dot2_f32_bf16 v12, v33, v73, v12
  v_dot2_f32_bf16 v12, v34, v74, v12
  v_dot2_f32_bf16 v12, v35, v75, v12
  v_dot2_f32_bf16 v12, v36, v76, v12
  v_dot2_f32_bf16 v12, v37, v77, v12
  v_dot2_f32_bf16 v12, v38, v78, v12
  v_dot2_f32_bf16 v12, v39, v79, v12
  s_waitcnt lgkmcnt(4)
  v_dot2_f32_bf16 v13, v32, v80, v13
  v_dot2_f32_bf16 v13, v33, v81, v13
  v_dot2_f32_bf16 v13, v34, v82, v13
  v_dot2_f32_bf16 v13, v35, v83, v13
  v_dot2_f32_bf16 v13, v36, v84, v13
  v_dot2_f32_bf16 v13, v37, v85, v13
  v_dot2_f32_bf16 v13, v38, v86, v13
  v_dot2_f32_bf16 v13, v39, v87, v13
  s_waitcnt lgkmcnt(2)
  v_dot2_f32_bf16 v14, v32, v88, v14
  v_dot2_f32_bf16 v14, v33, v89, v14
  v_dot2_f32_bf16 v14, v34, v90, v14
  v_dot2_f32_bf16 v14, v35, v91, v14
  v_dot2_f32_bf16 v14, v36, v92, v14
  v_dot2_f32_bf16 v14, v37, v93, v14
  v_dot2_f32_bf16 v14, v38, v94, v14
  v_dot2_f32_bf16 v14, v39, v95, v14
  s_waitcnt lgkmcnt(0)
  v_dot2_f32_bf16 v15, v32, v96, v15
  v_dot2_f32_bf16 v15, v33, v97, v15
  v_dot2_f32_bf16 v15, v34, v98, v15
  v_dot2_f32_bf16 v15, v35, v99, v15
  v_dot2_f32_bf16 v15, v36, v100, v15
  v_dot2_f32_bf16 v15, v37, v101, v15
  v_dot2_f32_bf16 v15, v38, v102, v15
  v_dot2_f32_bf16 v15, v39, v103, v15
  ds_read_b128 v[40:43], v4 offset:6464
  ds_read_b128 v[44:47], v4 offset:6480
  ds_read_b128 v[48:51], v4 offset:5664
  ds_read_b128 v[52:55], v4 offset:5680
  ds_read_b128 v[56:59], v4 offset:4864
  ds_read_b128 v[60:63], v4 offset:4880
  ds_read_b128 v[64:67], v4 offset:4064
  ds_read_b128 v[68:71], v4 offset:4080
  ds_read_b128 v[72:75], v4 offset:3264
  ds_read_b128 v[76:79], v4 offset:3280
  ds_read_b128 v[80:83], v4 offset:2464
  ds_read_b128 v[84:87], v4 offset:2480
  ds_read_b128 v[88:91], v4 offset:1664
  ds_read_b128 v[92:95], v4 offset:1680
  ds_read_b128 v[96:99], v4 offset:864
  ds_read_b128 v[100:103], v4 offset:880
  v_cvt_pk_bf16_f32 v8, v8, v8
  v_lshlrev_b32 v8, 16, v8
  v_mul_f32 v8, 0.25, v8
  v_cvt_pk_bf16_f32 v9, v9, v9
  v_lshlrev_b32 v9, 16, v9
  v_mul_f32 v9, 0.25, v9
  v_cmp_le_u32 vcc, 2, v5
  s_nop 1
  v_cndmask_b32 v9, v6, v9, vcc
  v_cvt_pk_bf16_f32 v10, v10, v10
  v_lshlrev_b32 v10, 16, v10
  v_mul_f32 v10, 0.25, v10
  v_cmp_le_u32 vcc, 4, v5
  s_nop 1
  v_cndmask_b32 v10, v6, v10, vcc
  v_cvt_pk_bf16_f32 v11, v11, v11
  v_lshlrev_b32 v11, 16, v11
  v_mul_f32 v11, 0.25, v11
  v_cmp_le_u32 vcc, 6, v5
  s_nop 1
  v_cndmask_b32 v11, v6, v11, vcc
  v_cvt_pk_bf16_f32 v12, v12, v12
  v_lshlrev_b32 v12, 16, v12
  v_mul_f32 v12, 0.25, v12
  v_cmp_le_u32 vcc, 8, v5
  s_nop 1
  v_cndmask_b32 v12, v6, v12, vcc
  v_cvt_pk_bf16_f32 v13, v13, v13
  v_lshlrev_b32 v13, 16, v13
  v_mul_f32 v13, 0.25, v13
  v_cmp_le_u32 vcc, 10, v5
  s_nop 1
  v_cndmask_b32 v13, v6, v13, vcc
  v_cvt_pk_bf16_f32 v14, v14, v14
  v_lshlrev_b32 v14, 16, v14
  v_mul_f32 v14, 0.25, v14
  v_cmp_le_u32 vcc, 12, v5
  s_nop 1
  v_cndmask_b32 v14, v6, v14, vcc
  v_cvt_pk_bf16_f32 v15, v15, v15
  v_lshlrev_b32 v15, 16, v15
  v_mul_f32 v15, 0.25, v15
  v_cmp_le_u32 vcc, 14, v5
  s_nop 1
  v_cndmask_b32 v15, v6, v15, vcc
  v_max3_f32 v7, v8, v9, v10
  v_max3_f32 v7, v7, v11, v12
  v_max3_f32 v7, v7, v13, v14
  v_max_f32 v7, v7, v15
  v_sub_f32 v8, v8, v7
  v_mul_f32 v8, 0x3fb8aa3b, v8
  v_exp_f32 v8, v8
  v_sub_f32 v9, v9, v7
  v_mul_f32 v9, 0x3fb8aa3b, v9
  v_exp_f32 v9, v9
  v_sub_f32 v10, v10, v7
  v_mul_f32 v10, 0x3fb8aa3b, v10
  v_exp_f32 v10, v10
  v_sub_f32 v11, v11, v7
  v_mul_f32 v11, 0x3fb8aa3b, v11
  v_exp_f32 v11, v11
  v_sub_f32 v12, v12, v7
  v_mul_f32 v12, 0x3fb8aa3b, v12
  v_exp_f32 v12, v12
  v_sub_f32 v13, v13, v7
  v_mul_f32 v13, 0x3fb8aa3b, v13
  v_exp_f32 v13, v13
  v_sub_f32 v14, v14, v7
  v_mul_f32 v14, 0x3fb8aa3b, v14
  v_exp_f32 v14, v14
  v_sub_f32 v15, v15, v7
  v_mul_f32 v15, 0x3fb8aa3b, v15
  v_exp_f32 v15, v15
  s_nop 0
  v_add_f32 v7, v8, v9
  v_add_f32 v7, v7, v10
  v_add_f32 v7, v7, v11
  v_add_f32 v7, v7, v12
  v_add_f32 v7, v7, v13
  v_add_f32 v7, v7, v14
  v_add_f32 v7, v7, v15
  v_rcp_f32 v7, v7
  s_nop 0
  v_mul_f32 v8, v8, v7
  v_mul_f32 v9, v9, v7
  v_mul_f32 v10, v10, v7
  v_mul_f32 v11, v11, v7
  v_mul_f32 v12, v12, v7
  v_mul_f32 v13, v13, v7
  v_mul_f32 v14, v14, v7
  v_mul_f32 v15, v15, v7
  v_cvt_pk_bf16_f32 v16, v8, v9
  v_cvt_pk_bf16_f32 v17, v10, v11
  v_cvt_pk_bf16_f32 v18, v12, v13
  v_cvt_pk_bf16_f32 v19, v14, v15
  s_mov_b32 s22, 0x05040100
  s_mov_b32 s23, 0x07060302
  v_mov_b32 v104, 0
  v_mov_b32 v105, 0
  v_mov_b32 v106, 0
  v_mov_b32 v107, 0
  v_mov_b32 v108, 0
  v_mov_b32 v109, 0
  v_mov_b32 v110, 0
  v_mov_b32 v111, 0
  v_mov_b32 v112, 0
  v_mov_b32 v113, 0
  v_mov_b32 v114, 0
  v_mov_b32 v115, 0
  v_mov_b32 v116, 0
  v_mov_b32 v117, 0
  v_mov_b32 v118, 0
  v_mov_b32 v119, 0
  s_waitcnt lgkmcnt(12)
  v_perm_b32 v20, v48, v40, s22
  v_perm_b32 v21, v48, v40, s23
  v_dot2_f32_bf16 v104, v20, v16, v104
  v_dot2_f32_bf16 v105, v21, v16, v105
  v_perm_b32 v22, v49, v41, s22
  v_perm_b32 v23, v49, v41, s23
  v_dot2_f32_bf16 v106, v22, v16, v106
  v_dot2_f32_bf16 v107, v23, v16, v107
  v_perm_b32 v20, v50, v42, s22
  v_perm_b32 v21, v50, v42, s23
  v_dot2_f32_bf16 v108, v20, v16, v108
  v_dot2_f32_bf16 v109, v21, v16, v109
  v_perm_b32 v22, v51, v43, s22
  v_perm_b32 v23, v51, v43, s23
  v_dot2_f32_bf16 v110, v22, v16, v110
  v_dot2_f32_bf16 v111, v23, v16, v111
  v_perm_b32 v20, v52, v44, s22
  v_perm_b32 v21, v52, v44, s23
  v_dot2_f32_bf16 v112, v20, v16, v112
  v_dot2_f32_bf16 v113, v21, v16, v113
  v_perm_b32 v22, v53, v45, s22
  v_perm_b32 v23, v53, v45, s23
  v_dot2_f32_bf16 v114, v22, v16, v114
  v_dot2_f32_bf16 v115, v23, v16, v115
  v_perm_b32 v20, v54, v46, s22
  v_perm_b32 v21, v54, v46, s23
  v_dot2_f32_bf16 v116, v20, v16, v116
  v_dot2_f32_bf16 v117, v21, v16, v117
  v_perm_b32 v22, v55, v47, s22
  v_perm_b32 v23, v55, v47, s23
  v_dot2_f32_bf16 v118, v22, v16, v118
  v_dot2_f32_bf16 v119, v23, v16, v119
  s_waitcnt lgkmcnt(8)
  v_perm_b32 v20, v64, v56, s22
  v_perm_b32 v21, v64, v56, s23
  v_dot2_f32_bf16 v104, v20, v17, v104
  v_dot2_f32_bf16 v105, v21, v17, v105
  v_perm_b32 v22, v65, v57, s22
  v_perm_b32 v23, v65, v57, s23
  v_dot2_f32_bf16 v106, v22, v17, v106
  v_dot2_f32_bf16 v107, v23, v17, v107
  v_perm_b32 v20, v66, v58, s22
  v_perm_b32 v21, v66, v58, s23
  v_dot2_f32_bf16 v108, v20, v17, v108
  v_dot2_f32_bf16 v109, v21, v17, v109
  v_perm_b32 v22, v67, v59, s22
  v_perm_b32 v23, v67, v59, s23
  v_dot2_f32_bf16 v110, v22, v17, v110
  v_dot2_f32_bf16 v111, v23, v17, v111
  v_perm_b32 v20, v68, v60, s22
  v_perm_b32 v21, v68, v60, s23
  v_dot2_f32_bf16 v112, v20, v17, v112
  v_dot2_f32_bf16 v113, v21, v17, v113
  v_perm_b32 v22, v69, v61, s22
  v_perm_b32 v23, v69, v61, s23
  v_dot2_f32_bf16 v114, v22, v17, v114
  v_dot2_f32_bf16 v115, v23, v17, v115
  v_perm_b32 v20, v70, v62, s22
  v_perm_b32 v21, v70, v62, s23
  v_dot2_f32_bf16 v116, v20, v17, v116
  v_dot2_f32_bf16 v117, v21, v17, v117
  v_perm_b32 v22, v71, v63, s22
  v_perm_b32 v23, v71, v63, s23
  v_dot2_f32_bf16 v118, v22, v17, v118
  v_dot2_f32_bf16 v119, v23, v17, v119
  s_waitcnt lgkmcnt(4)
  v_perm_b32 v20, v80, v72, s22
  v_perm_b32 v21, v80, v72, s23
  v_dot2_f32_bf16 v104, v20, v18, v104
  v_dot2_f32_bf16 v105, v21, v18, v105
  v_perm_b32 v22, v81, v73, s22
  v_perm_b32 v23, v81, v73, s23
  v_dot2_f32_bf16 v106, v22, v18, v106
  v_dot2_f32_bf16 v107, v23, v18, v107
  v_perm_b32 v20, v82, v74, s22
  v_perm_b32 v21, v82, v74, s23
  v_dot2_f32_bf16 v108, v20, v18, v108
  v_dot2_f32_bf16 v109, v21, v18, v109
  v_perm_b32 v22, v83, v75, s22
  v_perm_b32 v23, v83, v75, s23
  v_dot2_f32_bf16 v110, v22, v18, v110
  v_dot2_f32_bf16 v111, v23, v18, v111
  v_perm_b32 v20, v84, v76, s22
  v_perm_b32 v21, v84, v76, s23
  v_dot2_f32_bf16 v112, v20, v18, v112
  v_dot2_f32_bf16 v113, v21, v18, v113
  v_perm_b32 v22, v85, v77, s22
  v_perm_b32 v23, v85, v77, s23
  v_dot2_f32_bf16 v114, v22, v18, v114
  v_dot2_f32_bf16 v115, v23, v18, v115
  v_perm_b32 v20, v86, v78, s22
  v_perm_b32 v21, v86, v78, s23
  v_dot2_f32_bf16 v116, v20, v18, v116
  v_dot2_f32_bf16 v117, v21, v18, v117
  v_perm_b32 v22, v87, v79, s22
  v_perm_b32 v23, v87, v79, s23
  v_dot2_f32_bf16 v118, v22, v18, v118
  v_dot2_f32_bf16 v119, v23, v18, v119
  s_waitcnt lgkmcnt(0)
  v_perm_b32 v20, v96, v88, s22
  v_perm_b32 v21, v96, v88, s23
  v_dot2_f32_bf16 v104, v20, v19, v104
  v_dot2_f32_bf16 v105, v21, v19, v105
  v_perm_b32 v22, v97, v89, s22
  v_perm_b32 v23, v97, v89, s23
  v_dot2_f32_bf16 v106, v22, v19, v106
  v_dot2_f32_bf16 v107, v23, v19, v107
  v_perm_b32 v20, v98, v90, s22
  v_perm_b32 v21, v98, v90, s23
  v_dot2_f32_bf16 v108, v20, v19, v108
  v_dot2_f32_bf16 v109, v21, v19, v109
  v_perm_b32 v22, v99, v91, s22
  v_perm_b32 v23, v99, v91, s23
  v_dot2_f32_bf16 v110, v22, v19, v110
  v_dot2_f32_bf16 v111, v23, v19, v111
  v_perm_b32 v20, v100, v92, s22
  v_perm_b32 v21, v100, v92, s23
  v_dot2_f32_bf16 v112, v20, v19, v112
  v_dot2_f32_bf16 v113, v21, v19, v113
  v_perm_b32 v22, v101, v93, s22
  v_perm_b32 v23, v101, v93, s23
  v_dot2_f32_bf16 v114, v22, v19, v114
  v_dot2_f32_bf16 v115, v23, v19, v115
  v_perm_b32 v20, v102, v94, s22
  v_perm_b32 v21, v102, v94, s23
  v_dot2_f32_bf16 v116, v20, v19, v116
  v_dot2_f32_bf16 v117, v21, v19, v117
  v_perm_b32 v22, v103, v95, s22
  v_perm_b32 v23, v103, v95, s23
  v_dot2_f32_bf16 v118, v22, v19, v118
  v_dot2_f32_bf16 v119, v23, v19, v119
  s_nop 2
  v_cvt_pk_bf16_f32 v24, v104, v105
  v_cvt_pk_bf16_f32 v25, v106, v107
  v_cvt_pk_bf16_f32 v26, v108, v109
  v_cvt_pk_bf16_f32 v27, v110, v111
  v_cvt_pk_bf16_f32 v28, v112, v113
  v_cvt_pk_bf16_f32 v29, v114, v115
  v_cvt_pk_bf16_f32 v30, v116, v117
  v_cvt_pk_bf16_f32 v31, v118, v119
  s_lshl_b32 s22, s17, 2
  s_add_u32 s22, s22, s18
  s_lshl_b32 s22, s22, 5
  v_lshlrev_b32 v5, 10, v5
  v_add_u32 v5, s22, v5
  buffer_store_dwordx4 v[24:27], v5, s[12:15], 0 offen
  buffer_store_dwordx4 v[28:31], v5, s[12:15], 0 offen offset:16
  s_branch .Lend_k1a_kernel
.Lloader_k1a_kernel_1:
  s_cmp_lt_u32 s18, 10
  s_cbranch_scc1 .L_k1a_kernel_4
  s_load_dwordx2 s[28:29], s[0:1], 16
  s_load_dwordx2 s[32:33], s[0:1], 32
  s_load_dwordx2 s[36:37], s[0:1], 40
  s_load_dwordx2 s[40:41], s[0:1], 56
  s_lshl_b32 s22, s2, 10
  v_lshlrev_b32 v4, 4, v1
  v_add_u32 v4, s22, v4
  s_waitcnt lgkmcnt(0)
  s_mov_b32 s30, 0x80000
  s_mov_b32 s31, 0x00020000
  s_mov_b32 s34, 0x158000
  s_mov_b32 s35, 0x00020000
  s_mov_b32 s38, 0x800000
  s_mov_b32 s39, 0x00020000
  s_mov_b32 s42, 0xac000
  s_mov_b32 s43, 0x00020000
  s_mov_b32 s23, 0
  buffer_load_dwordx4 v[8:11], v4, s[28:31], s23 offen
  s_mov_b32 s23, 262144
  buffer_load_dwordx4 v[12:15], v4, s[28:31], s23 offen
  s_mov_b32 s23, 0
  buffer_load_dwordx4 v[16:19], v4, s[32:35], s23 offen
  s_mov_b32 s23, 262144
  buffer_load_dwordx4 v[20:23], v4, s[32:35], s23 offen
  s_mov_b32 s23, 524288
  buffer_load_dwordx4 v[24:27], v4, s[32:35], s23 offen
  s_mov_b32 s23, 786432
  buffer_load_dwordx4 v[28:31], v4, s[32:35], s23 offen
  s_mov_b32 s23, 1048576
  buffer_load_dwordx4 v[32:35], v4, s[32:35], s23 offen
  s_mov_b32 s23, 1310720
  buffer_load_dwordx4 v[36:39], v4, s[32:35], s23 offen
  s_mov_b32 s23, 0
  buffer_load_dwordx4 v[40:43], v4, s[36:39], s23 offen
  s_mov_b32 s23, 262144
  buffer_load_dwordx4 v[44:47], v4, s[36:39], s23 offen
  s_mov_b32 s23, 524288
  buffer_load_dwordx4 v[48:51], v4, s[36:39], s23 offen
  s_mov_b32 s23, 786432
  buffer_load_dwordx4 v[52:55], v4, s[36:39], s23 offen
  s_mov_b32 s23, 1048576
  buffer_load_dwordx4 v[56:59], v4, s[36:39], s23 offen
  s_mov_b32 s23, 1310720
  buffer_load_dwordx4 v[60:63], v4, s[36:39], s23 offen
  s_mov_b32 s23, 1572864
  buffer_load_dwordx4 v[64:67], v4, s[36:39], s23 offen
  s_mov_b32 s23, 1835008
  buffer_load_dwordx4 v[68:71], v4, s[36:39], s23 offen
  s_mov_b32 s23, 2097152
  buffer_load_dwordx4 v[8:11], v4, s[36:39], s23 offen
  s_mov_b32 s23, 2359296
  buffer_load_dwordx4 v[12:15], v4, s[36:39], s23 offen
  s_mov_b32 s23, 2621440
  buffer_load_dwordx4 v[16:19], v4, s[36:39], s23 offen
  s_mov_b32 s23, 2883584
  buffer_load_dwordx4 v[20:23], v4, s[36:39], s23 offen
  s_mov_b32 s23, 3145728
  buffer_load_dwordx4 v[24:27], v4, s[36:39], s23 offen
  s_mov_b32 s23, 3407872
  buffer_load_dwordx4 v[28:31], v4, s[36:39], s23 offen
  s_mov_b32 s23, 3670016
  buffer_load_dwordx4 v[32:35], v4, s[36:39], s23 offen
  s_mov_b32 s23, 3932160
  buffer_load_dwordx4 v[36:39], v4, s[36:39], s23 offen
  s_mov_b32 s23, 4194304
  buffer_load_dwordx4 v[40:43], v4, s[36:39], s23 offen
  s_mov_b32 s23, 4456448
  buffer_load_dwordx4 v[44:47], v4, s[36:39], s23 offen
  s_mov_b32 s23, 4718592
  buffer_load_dwordx4 v[48:51], v4, s[36:39], s23 offen
  s_mov_b32 s23, 4980736
  buffer_load_dwordx4 v[52:55], v4, s[36:39], s23 offen
  s_mov_b32 s23, 5242880
  buffer_load_dwordx4 v[56:59], v4, s[36:39], s23 offen
  s_mov_b32 s23, 5505024
  buffer_load_dwordx4 v[60:63], v4, s[36:39], s23 offen
  s_mov_b32 s23, 5767168
  buffer_load_dwordx4 v[64:67], v4, s[36:39], s23 offen
  s_mov_b32 s23, 6029312
  buffer_load_dwordx4 v[68:71], v4, s[36:39], s23 offen
  s_mov_b32 s23, 6291456
  buffer_load_dwordx4 v[8:11], v4, s[36:39], s23 offen
  s_mov_b32 s23, 6553600
  buffer_load_dwordx4 v[12:15], v4, s[36:39], s23 offen
  s_mov_b32 s23, 6815744
  buffer_load_dwordx4 v[16:19], v4, s[36:39], s23 offen
  s_mov_b32 s23, 7077888
  buffer_load_dwordx4 v[20:23], v4, s[36:39], s23 offen
  s_mov_b32 s23, 7340032
  buffer_load_dwordx4 v[24:27], v4, s[36:39], s23 offen
  s_mov_b32 s23, 7602176
  buffer_load_dwordx4 v[28:31], v4, s[36:39], s23 offen
  s_mov_b32 s23, 7864320
  buffer_load_dwordx4 v[32:35], v4, s[36:39], s23 offen
  s_mov_b32 s23, 8126464
  buffer_load_dwordx4 v[36:39], v4, s[36:39], s23 offen
  s_mov_b32 s23, 0
  buffer_load_dwordx4 v[40:43], v4, s[40:43], s23 offen
  s_mov_b32 s23, 262144
  buffer_load_dwordx4 v[44:47], v4, s[40:43], s23 offen
  s_mov_b32 s23, 524288
  buffer_load_dwordx4 v[48:51], v4, s[40:43], s23 offen
  s_getpc_b64 s[44:45]
.L_k1a_kernel_5:
  s_mov_b32 s46, .Ltext_end-.L_k1a_kernel_5
  s_mov_b32 s47, 0x00020000
  s_lshr_b32 s22, s2, 3
  s_lshl_b32 s22, s22, 10
  v_lshlrev_b32 v4, 4, v1
  v_add_u32 v4, s22, v4
  s_mov_b32 s23, 0
  buffer_load_dwordx4 v[8:11], v4, s[44:47], s23 offen
  s_mov_b32 s23, 32768
  buffer_load_dwordx4 v[12:15], v4, s[44:47], s23 offen
  s_mov_b32 s23, 65536
  buffer_load_dwordx4 v[16:19], v4, s[44:47], s23 offen
  s_mov_b32 s23, 98304
  buffer_load_dwordx4 v[20:23], v4, s[44:47], s23 offen
  s_mov_b32 s23, 131072
  buffer_load_dwordx4 v[24:27], v4, s[44:47], s23 offen
  s_branch .Lend_k1a_kernel
.L_k1a_kernel_4:
  s_sub_u32 s18, s18, 8
  s_mul_i32 s22, s18, 768
  s_mov_b32 s23, 43691
  s_lshl_b32 s21, s17, 7
  s_mov_b32 s24, 3072
  v_add_u32 v32, s22, v1
  v_mul_lo_u32 v33, v32, s23
  v_lshrrev_b32 v33, 20, v33
  v_mul_u32_u24 v34, 24, v33
  v_sub_u32 v34, v32, v34
  v_bfe_u32 v36, v33, 1, 1
  v_bfe_u32 v35, v33, 3, 1
  v_lshl_add_u32 v36, v35, 1, v36
  v_lshlrev_b32 v36, 1, v36
  v_xor_b32 v34, v34, v36
  v_lshrrev_b32 v35, 3, v34
  v_and_b32 v34, 7, v34
  v_lshlrev_b32 v34, 4, v34
  v_lshl_add_u32 v32, v35, 10, v34
  v_add_u32 v32, s21, v32
  v_mul_lo_u32 v33, v33, s24
  v_add_u32 v8, v33, v32
  v_add_u32 v32, s22, v1
  v_add_u32 v32, 64, v32
  v_mul_lo_u32 v33, v32, s23
  v_lshrrev_b32 v33, 20, v33
  v_mul_u32_u24 v34, 24, v33
  v_sub_u32 v34, v32, v34
  v_bfe_u32 v36, v33, 1, 1
  v_bfe_u32 v35, v33, 3, 1
  v_lshl_add_u32 v36, v35, 1, v36
  v_lshlrev_b32 v36, 1, v36
  v_xor_b32 v34, v34, v36
  v_lshrrev_b32 v35, 3, v34
  v_and_b32 v34, 7, v34
  v_lshlrev_b32 v34, 4, v34
  v_lshl_add_u32 v32, v35, 10, v34
  v_add_u32 v32, s21, v32
  v_mul_lo_u32 v33, v33, s24
  v_add_u32 v9, v33, v32
  v_add_u32 v32, s22, v1
  v_add_u32 v32, 128, v32
  v_mul_lo_u32 v33, v32, s23
  v_lshrrev_b32 v33, 20, v33
  v_mul_u32_u24 v34, 24, v33
  v_sub_u32 v34, v32, v34
  v_bfe_u32 v36, v33, 1, 1
  v_bfe_u32 v35, v33, 3, 1
  v_lshl_add_u32 v36, v35, 1, v36
  v_lshlrev_b32 v36, 1, v36
  v_xor_b32 v34, v34, v36
  v_lshrrev_b32 v35, 3, v34
  v_and_b32 v34, 7, v34
  v_lshlrev_b32 v34, 4, v34
  v_lshl_add_u32 v32, v35, 10, v34
  v_add_u32 v32, s21, v32
  v_mul_lo_u32 v33, v33, s24
  v_add_u32 v10, v33, v32
  v_add_u32 v32, s22, v1
  v_add_u32 v32, 192, v32
  v_mul_lo_u32 v33, v32, s23
  v_lshrrev_b32 v33, 20, v33
  v_mul_u32_u24 v34, 24, v33
  v_sub_u32 v34, v32, v34
  v_bfe_u32 v36, v33, 1, 1
  v_bfe_u32 v35, v33, 3, 1
  v_lshl_add_u32 v36, v35, 1, v36
  v_lshlrev_b32 v36, 1, v36
  v_xor_b32 v34, v34, v36
  v_lshrrev_b32 v35, 3, v34
  v_and_b32 v34, 7, v34
  v_lshlrev_b32 v34, 4, v34
  v_lshl_add_u32 v32, v35, 10, v34
  v_add_u32 v32, s21, v32
  v_mul_lo_u32 v33, v33, s24
  v_add_u32 v11, v33, v32
  v_add_u32 v32, s22, v1
  v_add_u32 v32, 256, v32
  v_mul_lo_u32 v33, v32, s23
  v_lshrrev_b32 v33, 20, v33
  v_mul_u32_u24 v34, 24, v33
  v_sub_u32 v34, v32, v34
  v_bfe_u32 v36, v33, 1, 1
  v_bfe_u32 v35, v33, 3, 1
  v_lshl_add_u32 v36, v35, 1, v36
  v_lshlrev_b32 v36, 1, v36
  v_xor_b32 v34, v34, v36
  v_lshrrev_b32 v35, 3, v34
  v_and_b32 v34, 7, v34
  v_lshlrev_b32 v34, 4, v34
  v_lshl_add_u32 v32, v35, 10, v34
  v_add_u32 v32, s21, v32
  v_mul_lo_u32 v33, v33, s24
  v_add_u32 v12, v33, v32
  v_add_u32 v32, s22, v1
  v_add_u32 v32, 320, v32
  v_mul_lo_u32 v33, v32, s23
  v_lshrrev_b32 v33, 20, v33
  v_mul_u32_u24 v34, 24, v33
  v_sub_u32 v34, v32, v34
  v_bfe_u32 v36, v33, 1, 1
  v_bfe_u32 v35, v33, 3, 1
  v_lshl_add_u32 v36, v35, 1, v36
  v_lshlrev_b32 v36, 1, v36
  v_xor_b32 v34, v34, v36
  v_lshrrev_b32 v35, 3, v34
  v_and_b32 v34, 7, v34
  v_lshlrev_b32 v34, 4, v34
  v_lshl_add_u32 v32, v35, 10, v34
  v_add_u32 v32, s21, v32
  v_mul_lo_u32 v33, v33, s24
  v_add_u32 v13, v33, v32
  v_add_u32 v32, s22, v1
  v_add_u32 v32, 384, v32
  v_mul_lo_u32 v33, v32, s23
  v_lshrrev_b32 v33, 20, v33
  v_mul_u32_u24 v34, 24, v33
  v_sub_u32 v34, v32, v34
  v_bfe_u32 v36, v33, 1, 1
  v_bfe_u32 v35, v33, 3, 1
  v_lshl_add_u32 v36, v35, 1, v36
  v_lshlrev_b32 v36, 1, v36
  v_xor_b32 v34, v34, v36
  v_lshrrev_b32 v35, 3, v34
  v_and_b32 v34, 7, v34
  v_lshlrev_b32 v34, 4, v34
  v_lshl_add_u32 v32, v35, 10, v34
  v_add_u32 v32, s21, v32
  v_mul_lo_u32 v33, v33, s24
  v_add_u32 v14, v33, v32
  v_add_u32 v32, s22, v1
  v_add_u32 v32, 448, v32
  v_mul_lo_u32 v33, v32, s23
  v_lshrrev_b32 v33, 20, v33
  v_mul_u32_u24 v34, 24, v33
  v_sub_u32 v34, v32, v34
  v_bfe_u32 v36, v33, 1, 1
  v_bfe_u32 v35, v33, 3, 1
  v_lshl_add_u32 v36, v35, 1, v36
  v_lshlrev_b32 v36, 1, v36
  v_xor_b32 v34, v34, v36
  v_lshrrev_b32 v35, 3, v34
  v_and_b32 v34, 7, v34
  v_lshlrev_b32 v34, 4, v34
  v_lshl_add_u32 v32, v35, 10, v34
  v_add_u32 v32, s21, v32
  v_mul_lo_u32 v33, v33, s24
  v_add_u32 v15, v33, v32
  v_add_u32 v32, s22, v1
  v_add_u32 v32, 512, v32
  v_mul_lo_u32 v33, v32, s23
  v_lshrrev_b32 v33, 20, v33
  v_mul_u32_u24 v34, 24, v33
  v_sub_u32 v34, v32, v34
  v_bfe_u32 v36, v33, 1, 1
  v_bfe_u32 v35, v33, 3, 1
  v_lshl_add_u32 v36, v35, 1, v36
  v_lshlrev_b32 v36, 1, v36
  v_xor_b32 v34, v34, v36
  v_lshrrev_b32 v35, 3, v34
  v_and_b32 v34, 7, v34
  v_lshlrev_b32 v34, 4, v34
  v_lshl_add_u32 v32, v35, 10, v34
  v_add_u32 v32, s21, v32
  v_mul_lo_u32 v33, v33, s24
  v_add_u32 v16, v33, v32
  v_add_u32 v32, s22, v1
  v_add_u32 v32, 576, v32
  v_mul_lo_u32 v33, v32, s23
  v_lshrrev_b32 v33, 20, v33
  v_mul_u32_u24 v34, 24, v33
  v_sub_u32 v34, v32, v34
  v_bfe_u32 v36, v33, 1, 1
  v_bfe_u32 v35, v33, 3, 1
  v_lshl_add_u32 v36, v35, 1, v36
  v_lshlrev_b32 v36, 1, v36
  v_xor_b32 v34, v34, v36
  v_lshrrev_b32 v35, 3, v34
  v_and_b32 v34, 7, v34
  v_lshlrev_b32 v34, 4, v34
  v_lshl_add_u32 v32, v35, 10, v34
  v_add_u32 v32, s21, v32
  v_mul_lo_u32 v33, v33, s24
  v_add_u32 v17, v33, v32
  v_add_u32 v32, s22, v1
  v_add_u32 v32, 640, v32
  v_mul_lo_u32 v33, v32, s23
  v_lshrrev_b32 v33, 20, v33
  v_mul_u32_u24 v34, 24, v33
  v_sub_u32 v34, v32, v34
  v_bfe_u32 v36, v33, 1, 1
  v_bfe_u32 v35, v33, 3, 1
  v_lshl_add_u32 v36, v35, 1, v36
  v_lshlrev_b32 v36, 1, v36
  v_xor_b32 v34, v34, v36
  v_lshrrev_b32 v35, 3, v34
  v_and_b32 v34, 7, v34
  v_lshlrev_b32 v34, 4, v34
  v_lshl_add_u32 v32, v35, 10, v34
  v_add_u32 v32, s21, v32
  v_mul_lo_u32 v33, v33, s24
  v_add_u32 v18, v33, v32
  v_add_u32 v32, s22, v1
  v_add_u32 v32, 704, v32
  v_mul_lo_u32 v33, v32, s23
  v_lshrrev_b32 v33, 20, v33
  v_mul_u32_u24 v34, 24, v33
  v_sub_u32 v34, v32, v34
  v_bfe_u32 v36, v33, 1, 1
  v_bfe_u32 v35, v33, 3, 1
  v_lshl_add_u32 v36, v35, 1, v36
  v_lshlrev_b32 v36, 1, v36
  v_xor_b32 v34, v34, v36
  v_lshrrev_b32 v35, 3, v34
  v_and_b32 v34, 7, v34
  v_lshlrev_b32 v34, 4, v34
  v_lshl_add_u32 v32, v35, 10, v34
  v_add_u32 v32, s21, v32
  v_mul_lo_u32 v33, v33, s24
  v_add_u32 v19, v33, v32
  s_mul_i32 s21, s18, 12288
  s_add_u32 s21, s21, 81920
  s_waitcnt lgkmcnt(0)
  s_mov_b32 s10, 0x180000
  s_mov_b32 s11, 0x00020000
  s_barrier
  s_mov_b32 s22, 0
  s_add_u32 m0, s21, 0
  s_nop 0
  buffer_load_dwordx4 v8, s[8:11], s22 offen lds
  s_add_u32 m0, s21, 1024
  s_nop 0
  buffer_load_dwordx4 v9, s[8:11], s22 offen lds
  s_add_u32 m0, s21, 2048
  s_nop 0
  buffer_load_dwordx4 v10, s[8:11], s22 offen lds
  s_add_u32 m0, s21, 3072
  s_nop 0
  buffer_load_dwordx4 v11, s[8:11], s22 offen lds
  s_add_u32 m0, s21, 4096
  s_nop 0
  buffer_load_dwordx4 v12, s[8:11], s22 offen lds
  s_add_u32 m0, s21, 5120
  s_nop 0
  buffer_load_dwordx4 v13, s[8:11], s22 offen lds
  s_add_u32 m0, s21, 6144
  s_nop 0
  buffer_load_dwordx4 v14, s[8:11], s22 offen lds
  s_add_u32 m0, s21, 7168
  s_nop 0
  buffer_load_dwordx4 v15, s[8:11], s22 offen lds
  s_add_u32 m0, s21, 8192
  s_nop 0
  buffer_load_dwordx4 v16, s[8:11], s22 offen lds
  s_add_u32 m0, s21, 9216
  s_nop 0
  buffer_load_dwordx4 v17, s[8:11], s22 offen lds
  s_add_u32 m0, s21, 10240
  s_nop 0
  buffer_load_dwordx4 v18, s[8:11], s22 offen lds
  s_add_u32 m0, s21, 11264
  s_nop 0
  buffer_load_dwordx4 v19, s[8:11], s22 offen lds
  s_mov_b32 s22, 196608
  s_add_u32 m0, s21, 24576
  s_nop 0
  buffer_load_dwordx4 v8, s[8:11], s22 offen lds
  s_add_u32 m0, s21, 25600
  s_nop 0
  buffer_load_dwordx4 v9, s[8:11], s22 offen lds
  s_add_u32 m0, s21, 26624
  s_nop 0
  buffer_load_dwordx4 v10, s[8:11], s22 offen lds
  s_add_u32 m0, s21, 27648
  s_nop 0
  buffer_load_dwordx4 v11, s[8:11], s22 offen lds
  s_add_u32 m0, s21, 28672
  s_nop 0
  buffer_load_dwordx4 v12, s[8:11], s22 offen lds
  s_add_u32 m0, s21, 29696
  s_nop 0
  buffer_load_dwordx4 v13, s[8:11], s22 offen lds
  s_add_u32 m0, s21, 30720
  s_nop 0
  buffer_load_dwordx4 v14, s[8:11], s22 offen lds
  s_add_u32 m0, s21, 31744
  s_nop 0
  buffer_load_dwordx4 v15, s[8:11], s22 offen lds
  s_add_u32 m0, s21, 32768
  s_nop 0
  buffer_load_dwordx4 v16, s[8:11], s22 offen lds
  s_add_u32 m0, s21, 33792
  s_nop 0
  buffer_load_dwordx4 v17, s[8:11], s22 offen lds
  s_add_u32 m0, s21, 34816
  s_nop 0
  buffer_load_dwordx4 v18, s[8:11], s22 offen lds
  s_add_u32 m0, s21, 35840
  s_nop 0
  buffer_load_dwordx4 v19, s[8:11], s22 offen lds
  s_mov_b32 s22, 393216
  s_add_u32 m0, s21, 49152
  s_nop 0
  buffer_load_dwordx4 v8, s[8:11], s22 offen lds
  s_add_u32 m0, s21, 50176
  s_nop 0
  buffer_load_dwordx4 v9, s[8:11], s22 offen lds
  s_add_u32 m0, s21, 51200
  s_nop 0
  buffer_load_dwordx4 v10, s[8:11], s22 offen lds
  s_add_u32 m0, s21, 52224
  s_nop 0
  buffer_load_dwordx4 v11, s[8:11], s22 offen lds
  s_add_u32 m0, s21, 53248
  s_nop 0
  buffer_load_dwordx4 v12, s[8:11], s22 offen lds
  s_add_u32 m0, s21, 54272
  s_nop 0
  buffer_load_dwordx4 v13, s[8:11], s22 offen lds
  s_add_u32 m0, s21, 55296
  s_nop 0
  buffer_load_dwordx4 v14, s[8:11], s22 offen lds
  s_add_u32 m0, s21, 56320
  s_nop 0
  buffer_load_dwordx4 v15, s[8:11], s22 offen lds
  s_add_u32 m0, s21, 57344
  s_nop 0
  buffer_load_dwordx4 v16, s[8:11], s22 offen lds
  s_add_u32 m0, s21, 58368
  s_nop 0
  buffer_load_dwordx4 v17, s[8:11], s22 offen lds
  s_add_u32 m0, s21, 59392
  s_nop 0
  buffer_load_dwordx4 v18, s[8:11], s22 offen lds
  s_add_u32 m0, s21, 60416
  s_nop 0
  buffer_load_dwordx4 v19, s[8:11], s22 offen lds
  s_waitcnt vmcnt(24)
  s_barrier
  s_waitcnt vmcnt(12)
  s_barrier
  s_mov_b32 s22, 589824
  s_add_u32 m0, s21, 0
  s_nop 0
  buffer_load_dwordx4 v8, s[8:11], s22 offen lds
  s_add_u32 m0, s21, 1024
  s_nop 0
  buffer_load_dwordx4 v9, s[8:11], s22 offen lds
  s_add_u32 m0, s21, 2048
  s_nop 0
  buffer_load_dwordx4 v10, s[8:11], s22 offen lds
  s_add_u32 m0, s21, 3072
  s_nop 0
  buffer_load_dwordx4 v11, s[8:11], s22 offen lds
  s_add_u32 m0, s21, 4096
  s_nop 0
  buffer_load_dwordx4 v12, s[8:11], s22 offen lds
  s_add_u32 m0, s21, 5120
  s_nop 0
  buffer_load_dwordx4 v13, s[8:11], s22 offen lds
  s_add_u32 m0, s21, 6144
  s_nop 0
  buffer_load_dwordx4 v14, s[8:11], s22 offen lds
  s_add_u32 m0, s21, 7168
  s_nop 0
  buffer_load_dwordx4 v15, s[8:11], s22 offen lds
  s_add_u32 m0, s21, 8192
  s_nop 0
  buffer_load_dwordx4 v16, s[8:11], s22 offen lds
  s_add_u32 m0, s21, 9216
  s_nop 0
  buffer_load_dwordx4 v17, s[8:11], s22 offen lds
  s_add_u32 m0, s21, 10240
  s_nop 0
  buffer_load_dwordx4 v18, s[8:11], s22 offen lds
  s_add_u32 m0, s21, 11264
  s_nop 0
  buffer_load_dwordx4 v19, s[8:11], s22 offen lds
  s_waitcnt vmcnt(12)
  s_barrier
  s_mov_b32 s22, 786432
  s_add_u32 m0, s21, 24576
  s_nop 0
  buffer_load_dwordx4 v8, s[8:11], s22 offen lds
  s_add_u32 m0, s21, 25600
  s_nop 0
  buffer_load_dwordx4 v9, s[8:11], s22 offen lds
  s_add_u32 m0, s21, 26624
  s_nop 0
  buffer_load_dwordx4 v10, s[8:11], s22 offen lds
  s_add_u32 m0, s21, 27648
  s_nop 0
  buffer_load_dwordx4 v11, s[8:11], s22 offen lds
  s_add_u32 m0, s21, 28672
  s_nop 0
  buffer_load_dwordx4 v12, s[8:11], s22 offen lds
  s_add_u32 m0, s21, 29696
  s_nop 0
  buffer_load_dwordx4 v13, s[8:11], s22 offen lds
  s_add_u32 m0, s21, 30720
  s_nop 0
  buffer_load_dwordx4 v14, s[8:11], s22 offen lds
  s_add_u32 m0, s21, 31744
  s_nop 0
  buffer_load_dwordx4 v15, s[8:11], s22 offen lds
  s_add_u32 m0, s21, 32768
  s_nop 0
  buffer_load_dwordx4 v16, s[8:11], s22 offen lds
  s_add_u32 m0, s21, 33792
  s_nop 0
  buffer_load_dwordx4 v17, s[8:11], s22 offen lds
  s_add_u32 m0, s21, 34816
  s_nop 0
  buffer_load_dwordx4 v18, s[8:11], s22 offen lds
  s_add_u32 m0, s21, 35840
  s_nop 0
  buffer_load_dwordx4 v19, s[8:11], s22 offen lds
  s_waitcnt vmcnt(12)
  s_barrier
  s_mov_b32 s22, 983040
  s_add_u32 m0, s21, 49152
  s_nop 0
  buffer_load_dwordx4 v8, s[8:11], s22 offen lds
  s_add_u32 m0, s21, 50176
  s_nop 0
  buffer_load_dwordx4 v9, s[8:11], s22 offen lds
  s_add_u32 m0, s21, 51200
  s_nop 0
  buffer_load_dwordx4 v10, s[8:11], s22 offen lds
  s_add_u32 m0, s21, 52224
  s_nop 0
  buffer_load_dwordx4 v11, s[8:11], s22 offen lds
  s_add_u32 m0, s21, 53248
  s_nop 0
  buffer_load_dwordx4 v12, s[8:11], s22 offen lds
  s_add_u32 m0, s21, 54272
  s_nop 0
  buffer_load_dwordx4 v13, s[8:11], s22 offen lds
  s_add_u32 m0, s21, 55296
  s_nop 0
  buffer_load_dwordx4 v14, s[8:11], s22 offen lds
  s_add_u32 m0, s21, 56320
  s_nop 0
  buffer_load_dwordx4 v15, s[8:11], s22 offen lds
  s_add_u32 m0, s21, 57344
  s_nop 0
  buffer_load_dwordx4 v16, s[8:11], s22 offen lds
  s_add_u32 m0, s21, 58368
  s_nop 0
  buffer_load_dwordx4 v17, s[8:11], s22 offen lds
  s_add_u32 m0, s21, 59392
  s_nop 0
  buffer_load_dwordx4 v18, s[8:11], s22 offen lds
  s_add_u32 m0, s21, 60416
  s_nop 0
  buffer_load_dwordx4 v19, s[8:11], s22 offen lds
  s_waitcnt vmcnt(12)
  s_barrier
  s_mov_b32 s22, 1179648
  s_add_u32 m0, s21, 0
  s_nop 0
  buffer_load_dwordx4 v8, s[8:11], s22 offen lds
  s_add_u32 m0, s21, 1024
  s_nop 0
  buffer_load_dwordx4 v9, s[8:11], s22 offen lds
  s_add_u32 m0, s21, 2048
  s_nop 0
  buffer_load_dwordx4 v10, s[8:11], s22 offen lds
  s_add_u32 m0, s21, 3072
  s_nop 0
  buffer_load_dwordx4 v11, s[8:11], s22 offen lds
  s_add_u32 m0, s21, 4096
  s_nop 0
  buffer_load_dwordx4 v12, s[8:11], s22 offen lds
  s_add_u32 m0, s21, 5120
  s_nop 0
  buffer_load_dwordx4 v13, s[8:11], s22 offen lds
  s_add_u32 m0, s21, 6144
  s_nop 0
  buffer_load_dwordx4 v14, s[8:11], s22 offen lds
  s_add_u32 m0, s21, 7168
  s_nop 0
  buffer_load_dwordx4 v15, s[8:11], s22 offen lds
  s_add_u32 m0, s21, 8192
  s_nop 0
  buffer_load_dwordx4 v16, s[8:11], s22 offen lds
  s_add_u32 m0, s21, 9216
  s_nop 0
  buffer_load_dwordx4 v17, s[8:11], s22 offen lds
  s_add_u32 m0, s21, 10240
  s_nop 0
  buffer_load_dwordx4 v18, s[8:11], s22 offen lds
  s_add_u32 m0, s21, 11264
  s_nop 0
  buffer_load_dwordx4 v19, s[8:11], s22 offen lds
  s_waitcnt vmcnt(12)
  s_barrier
  s_mov_b32 s22, 1376256
  s_add_u32 m0, s21, 24576
  s_nop 0
  buffer_load_dwordx4 v8, s[8:11], s22 offen lds
  s_add_u32 m0, s21, 25600
  s_nop 0
  buffer_load_dwordx4 v9, s[8:11], s22 offen lds
  s_add_u32 m0, s21, 26624
  s_nop 0
  buffer_load_dwordx4 v10, s[8:11], s22 offen lds
  s_add_u32 m0, s21, 27648
  s_nop 0
  buffer_load_dwordx4 v11, s[8:11], s22 offen lds
  s_add_u32 m0, s21, 28672
  s_nop 0
  buffer_load_dwordx4 v12, s[8:11], s22 offen lds
  s_add_u32 m0, s21, 29696
  s_nop 0
  buffer_load_dwordx4 v13, s[8:11], s22 offen lds
  s_add_u32 m0, s21, 30720
  s_nop 0
  buffer_load_dwordx4 v14, s[8:11], s22 offen lds
  s_add_u32 m0, s21, 31744
  s_nop 0
  buffer_load_dwordx4 v15, s[8:11], s22 offen lds
  s_add_u32 m0, s21, 32768
  s_nop 0
  buffer_load_dwordx4 v16, s[8:11], s22 offen lds
  s_add_u32 m0, s21, 33792
  s_nop 0
  buffer_load_dwordx4 v17, s[8:11], s22 offen lds
  s_add_u32 m0, s21, 34816
  s_nop 0
  buffer_load_dwordx4 v18, s[8:11], s22 offen lds
  s_add_u32 m0, s21, 35840
  s_nop 0
  buffer_load_dwordx4 v19, s[8:11], s22 offen lds
  s_waitcnt vmcnt(12)
  s_barrier
  s_waitcnt vmcnt(0)
  s_barrier
.Lend_k1a_kernel:
  s_endpgm

.globl k1b_kernel
.p2align 8
.type k1b_kernel,@function
k1b_kernel:
  s_cmp_ge_u32 s2, 256
  s_cbranch_scc1 .Lend_k1b_kernel
  s_load_dwordx2 s[4:5], s[0:1], 80
  s_load_dwordx2 s[12:13], s[0:1], 80
  s_load_dwordx2 s[8:9], s[0:1], 8
  s_and_b32 s16, s2, 7
  s_lshl_b32 s16, s16, 2
  s_lshr_b32 s17, s2, 3
  s_and_b32 s17, s17, 3
  s_add_u32 s16, s16, s17
  s_lshr_b32 s17, s2, 5
  v_and_b32 v1, 63, v0
  v_lshrrev_b32 v4, 6, v0
  v_and_b32 v2, 15, v0
  v_readfirstlane_b32 s18, v4
  v_bfe_u32 v3, v0, 4, 2
  s_cmp_ge_u32 s18, 8
  s_cbranch_scc1 .Lloader_k1b_kernel_1
  s_and_b32 s19, s18, 1
  s_lshr_b32 s20, s18, 1
  s_lshl_b32 s22, s18, 2
  v_add_u32 v4, s22, v3
  s_lshl_b32 s23, s16, 6
  v_add_u32 v5, s23, v4
  v_lshlrev_b32 v5, 10, v5
  v_lshl_add_u32 v11, v2, 4, v5
  v_subrev_u32 v12, 0x4000, v11
  v_and_b32 v5, 15, v4
  v_xor_b32 v5, v5, v2
  v_lshlrev_b32 v5, 4, v5
  v_lshl_add_u32 v13, v4, 10, v5
  v_add_u32 v14, 0x10000, v13
  s_waitcnt lgkmcnt(0)
  s_add_u32 s4, s4, 0x400000
  s_addc_u32 s5, s5, 0
  s_mov_b32 s6, 0x200000
  s_mov_b32 s7, 0x00020000
  s_mov_b32 s14, 0x200000
  s_mov_b32 s15, 0x00020000
  s_mov_b32 s23, 0x8000
  s_cmp_ge_u32 s18, 4
  s_cbranch_scc1 .L_k1b_kernel_2
  buffer_load_dwordx4 v[64:67], v12, s[4:7], 0 offen offset:0
  buffer_load_dwordx4 v[68:71], v12, s[4:7], 0 offen offset:256
  buffer_load_dwordx4 v[72:75], v12, s[4:7], 0 offen offset:512
  buffer_load_dwordx4 v[76:79], v12, s[4:7], 0 offen offset:768
.L_k1b_kernel_2:
  buffer_load_dwordx4 v[32:35], v11, s[4:7], 0 offen offset:0
  buffer_load_dwordx4 v[36:39], v11, s[4:7], 0 offen offset:256
  buffer_load_dwordx4 v[40:43], v11, s[4:7], 0 offen offset:512
  buffer_load_dwordx4 v[44:47], v11, s[4:7], 0 offen offset:768
  buffer_load_dwordx4 v[48:51], v11, s[4:7], s23 offen offset:0
  buffer_load_dwordx4 v[52:55], v11, s[4:7], s23 offen offset:256
  buffer_load_dwordx4 v[56:59], v11, s[4:7], s23 offen offset:512
  buffer_load_dwordx4 v[60:63], v11, s[4:7], s23 offen offset:768
  s_barrier
  s_lshl_b32 s22, s19, 15
  v_xor_b32 v4, v3, v2
  v_and_b32 v4, 3, v4
  v_and_b32 v5, 12, v2
  v_xor_b32 v6, 0, v5
  v_or_b32 v6, v6, v4
  v_lshlrev_b32 v6, 4, v6
  v_lshl_add_u32 v6, v2, 10, v6
  v_add_u32 v16, s22, v6
  v_add_u32 v20, 0x10000, v6
  v_xor_b32 v6, 4, v5
  v_or_b32 v6, v6, v4
  v_lshlrev_b32 v6, 4, v6
  v_lshl_add_u32 v6, v2, 10, v6
  v_add_u32 v17, s22, v6
  v_add_u32 v21, 0x10000, v6
  v_xor_b32 v6, 8, v5
  v_or_b32 v6, v6, v4
  v_lshlrev_b32 v6, 4, v6
  v_lshl_add_u32 v6, v2, 10, v6
  v_add_u32 v18, s22, v6
  v_add_u32 v22, 0x10000, v6
  v_xor_b32 v6, 12, v5
  v_or_b32 v6, v6, v4
  v_lshlrev_b32 v6, 4, v6
  v_lshl_add_u32 v6, v2, 10, v6
  v_add_u32 v19, s22, v6
  v_add_u32 v23, 0x10000, v6
  v_lshrrev_b32 v4, 2, v2
  v_lshl_add_u32 v4, v3, 3, v4
  v_mul_u32_u24 v4, 384, v4
  v_and_b32 v5, 3, v2
  v_lshl_add_u32 v4, v5, 3, v4
  v_add_u32 v4, 81920, v4
  v_bfe_u32 v5, v2, 3, 1
  v_and_b32 v6, 1, v3
  v_lshl_add_u32 v5, v6, 1, v5
  s_mov_b32 s23, s20
  v_xor_b32 v6, s23, v5
  v_lshl_add_u32 v24, v6, 5, v4
  s_lshl_b32 s23, s19, 2
  s_add_u32 s23, s23, s20
  s_add_u32 s23, s23, 4
  v_xor_b32 v6, s23, v5
  v_lshl_add_u32 v25, v6, 5, v4
  s_lshl_b32 s23, s19, 2
  s_sub_u32 s23, s20, s23
  s_add_u32 s23, s23, 8
  v_xor_b32 v6, s23, v5
  v_lshl_add_u32 v26, v6, 5, v4
  s_cmp_ge_u32 s18, 4
  s_cbranch_scc1 .L_k1b_kernel_3
  s_waitcnt vmcnt(8)
  v_lshlrev_b32 v80, 16, v64
  v_and_b32 v81, 0xffff0000, v64
  v_lshlrev_b32 v82, 16, v65
  v_and_b32 v83, 0xffff0000, v65
  v_lshlrev_b32 v84, 16, v66
  v_and_b32 v85, 0xffff0000, v66
  v_lshlrev_b32 v86, 16, v67
  v_and_b32 v87, 0xffff0000, v67
  v_lshlrev_b32 v88, 16, v68
  v_and_b32 v89, 0xffff0000, v68
  v_lshlrev_b32 v90, 16, v69
  v_and_b32 v91, 0xffff0000, v69
  v_lshlrev_b32 v92, 16, v70
  v_and_b32 v93, 0xffff0000, v70
  v_lshlrev_b32 v94, 16, v71
  v_and_b32 v95, 0xffff0000, v71
  v_lshlrev_b32 v96, 16, v72
  v_and_b32 v97, 0xffff0000, v72
  v_lshlrev_b32 v98, 16, v73
  v_and_b32 v99, 0xffff0000, v73
  v_lshlrev_b32 v100, 16, v74
  v_and_b32 v101, 0xffff0000, v74
  v_lshlrev_b32 v102, 16, v75
  v_and_b32 v103, 0xffff0000, v75
  v_lshlrev_b32 v104, 16, v76
  v_and_b32 v105, 0xffff0000, v76
  v_lshlrev_b32 v106, 16, v77
  v_and_b32 v107, 0xffff0000, v77
  v_lshlrev_b32 v108, 16, v78
  v_and_b32 v109, 0xffff0000, v78
  v_lshlrev_b32 v110, 16, v79
  v_and_b32 v111, 0xffff0000, v79
  v_pk_add_f32 v[4:5], v[80:81], v[82:83]
  v_pk_mul_f32 v[6:7], v[80:81], v[80:81]
  v_pk_fma_f32 v[6:7], v[82:83], v[82:83], v[6:7]
  v_pk_add_f32 v[4:5], v[4:5], v[84:85]
  v_pk_fma_f32 v[6:7], v[84:85], v[84:85], v[6:7]
  v_pk_add_f32 v[4:5], v[4:5], v[86:87]
  v_pk_fma_f32 v[6:7], v[86:87], v[86:87], v[6:7]
  v_pk_add_f32 v[4:5], v[4:5], v[88:89]
  v_pk_fma_f32 v[6:7], v[88:89], v[88:89], v[6:7]
  v_pk_add_f32 v[4:5], v[4:5], v[90:91]
  v_pk_fma_f32 v[6:7], v[90:91], v[90:91], v[6:7]
  v_pk_add_f32 v[4:5], v[4:5], v[92:93]
  v_pk_fma_f32 v[6:7], v[92:93], v[92:93], v[6:7]
  v_pk_add_f32 v[4:5], v[4:5], v[94:95]
  v_pk_fma_f32 v[6:7], v[94:95], v[94:95], v[6:7]
  v_pk_add_f32 v[4:5], v[4:5], v[96:97]
  v_pk_fma_f32 v[6:7], v[96:97], v[96:97], v[6:7]
  v_pk_add_f32 v[4:5], v[4:5], v[98:99]
  v_pk_fma_f32 v[6:7], v[98:99], v[98:99], v[6:7]
  v_pk_add_f32 v[4:5], v[4:5], v[100:101]
  v_pk_fma_f32 v[6:7], v[100:101], v[100:101], v[6:7]
  v_pk_add_f32 v[4:5], v[4:5], v[102:103]
  v_pk_fma_f32 v[6:7], v[102:103], v[102:103], v[6:7]
  v_pk_add_f32 v[4:5], v[4:5], v[104:105]
  v_pk_fma_f32 v[6:7], v[104:105], v[104:105], v[6:7]
  v_pk_add_f32 v[4:5], v[4:5], v[106:107]
  v_pk_fma_f32 v[6:7], v[106:107], v[106:107], v[6:7]
  v_pk_add_f32 v[4:5], v[4:5], v[108:109]
  v_pk_fma_f32 v[6:7], v[108:109], v[108:109], v[6:7]
  v_pk_add_f32 v[4:5], v[4:5], v[110:111]
  v_pk_fma_f32 v[6:7], v[110:111], v[110:111], v[6:7]
  v_add_f32 v4, v4, v5
  v_add_f32 v6, v6, v7
  s_nop 1
  v_add_f32_dpp v4, v4, v4 row_ror:8 row_mask:0xf bank_mask:0xf
  v_add_f32_dpp v6, v6, v6 row_ror:8 row_mask:0xf bank_mask:0xf
  s_nop 1
  v_add_f32_dpp v4, v4, v4 row_ror:4 row_mask:0xf bank_mask:0xf
  v_add_f32_dpp v6, v6, v6 row_ror:4 row_mask:0xf bank_mask:0xf
  s_nop 1
  v_add_f32_dpp v4, v4, v4 row_ror:2 row_mask:0xf bank_mask:0xf
  v_add_f32_dpp v6, v6, v6 row_ror:2 row_mask:0xf bank_mask:0xf
  s_nop 1
  v_add_f32_dpp v4, v4, v4 row_ror:1 row_mask:0xf bank_mask:0xf
  v_add_f32_dpp v6, v6, v6 row_ror:1 row_mask:0xf bank_mask:0xf
  v_mul_f32 v4, 0x3b000000, v4
  v_mul_f32 v6, 0x3b000000, v6
  v_fma_f32 v6, -v4, v4, v6
  v_max_f32 v6, 0, v6
  v_cvt_pk_bf16_f32 v112, v4, v4
  v_lshlrev_b32 v112, 16, v112
  v_cvt_pk_bf16_f32 v30, v6, v6
  v_lshlrev_b32 v30, 16, v30
  v_add_f32 v30, 0x3727c5ac, v30
  v_cvt_pk_bf16_f32 v30, v30, v30
  v_lshlrev_b32 v30, 16, v30
  v_sqrt_f32 v15, v30
  s_nop 0
  v_cvt_pk_bf16_f32 v15, v15, v15
  v_lshlrev_b32 v15, 16, v15
  v_rcp_f32 v114, v15
  s_nop 0
  v_sub_f32 v112, 0, v112
  v_mov_b32 v113, v112
  v_mov_b32 v115, v114
  v_pk_add_f32 v[80:81], v[80:81], v[112:113]
  v_cvt_pk_bf16_f32 v64, v80, v81
  v_lshlrev_b32 v80, 16, v64
  v_and_b32 v81, 0xffff0000, v64
  v_pk_mul_f32 v[80:81], v[80:81], v[114:115]
  v_cvt_pk_bf16_f32 v64, v80, v81
  v_pk_add_f32 v[82:83], v[82:83], v[112:113]
  v_cvt_pk_bf16_f32 v65, v82, v83
  v_lshlrev_b32 v82, 16, v65
  v_and_b32 v83, 0xffff0000, v65
  v_pk_mul_f32 v[82:83], v[82:83], v[114:115]
  v_cvt_pk_bf16_f32 v65, v82, v83
  v_pk_add_f32 v[84:85], v[84:85], v[112:113]
  v_cvt_pk_bf16_f32 v66, v84, v85
  v_lshlrev_b32 v84, 16, v66
  v_and_b32 v85, 0xffff0000, v66
  v_pk_mul_f32 v[84:85], v[84:85], v[114:115]
  v_cvt_pk_bf16_f32 v66, v84, v85
  v_pk_add_f32 v[86:87], v[86:87], v[112:113]
  v_cvt_pk_bf16_f32 v67, v86, v87
  v_lshlrev_b32 v86, 16, v67
  v_and_b32 v87, 0xffff0000, v67
  v_pk_mul_f32 v[86:87], v[86:87], v[114:115]
  v_cvt_pk_bf16_f32 v67, v86, v87
  v_pk_add_f32 v[88:89], v[88:89], v[112:113]
  v_cvt_pk_bf16_f32 v68, v88, v89
  v_lshlrev_b32 v88, 16, v68
  v_and_b32 v89, 0xffff0000, v68
  v_pk_mul_f32 v[88:89], v[88:89], v[114:115]
  v_cvt_pk_bf16_f32 v68, v88, v89
  v_pk_add_f32 v[90:91], v[90:91], v[112:113]
  v_cvt_pk_bf16_f32 v69, v90, v91
  v_lshlrev_b32 v90, 16, v69
  v_and_b32 v91, 0xffff0000, v69
  v_pk_mul_f32 v[90:91], v[90:91], v[114:115]
  v_cvt_pk_bf16_f32 v69, v90, v91
  v_pk_add_f32 v[92:93], v[92:93], v[112:113]
  v_cvt_pk_bf16_f32 v70, v92, v93
  v_lshlrev_b32 v92, 16, v70
  v_and_b32 v93, 0xffff0000, v70
  v_pk_mul_f32 v[92:93], v[92:93], v[114:115]
  v_cvt_pk_bf16_f32 v70, v92, v93
  v_pk_add_f32 v[94:95], v[94:95], v[112:113]
  v_cvt_pk_bf16_f32 v71, v94, v95
  v_lshlrev_b32 v94, 16, v71
  v_and_b32 v95, 0xffff0000, v71
  v_pk_mul_f32 v[94:95], v[94:95], v[114:115]
  v_cvt_pk_bf16_f32 v71, v94, v95
  v_pk_add_f32 v[96:97], v[96:97], v[112:113]
  v_cvt_pk_bf16_f32 v72, v96, v97
  v_lshlrev_b32 v96, 16, v72
  v_and_b32 v97, 0xffff0000, v72
  v_pk_mul_f32 v[96:97], v[96:97], v[114:115]
  v_cvt_pk_bf16_f32 v72, v96, v97
  v_pk_add_f32 v[98:99], v[98:99], v[112:113]
  v_cvt_pk_bf16_f32 v73, v98, v99
  v_lshlrev_b32 v98, 16, v73
  v_and_b32 v99, 0xffff0000, v73
  v_pk_mul_f32 v[98:99], v[98:99], v[114:115]
  v_cvt_pk_bf16_f32 v73, v98, v99
  v_pk_add_f32 v[100:101], v[100:101], v[112:113]
  v_cvt_pk_bf16_f32 v74, v100, v101
  v_lshlrev_b32 v100, 16, v74
  v_and_b32 v101, 0xffff0000, v74
  v_pk_mul_f32 v[100:101], v[100:101], v[114:115]
  v_cvt_pk_bf16_f32 v74, v100, v101
  v_pk_add_f32 v[102:103], v[102:103], v[112:113]
  v_cvt_pk_bf16_f32 v75, v102, v103
  v_lshlrev_b32 v102, 16, v75
  v_and_b32 v103, 0xffff0000, v75
  v_pk_mul_f32 v[102:103], v[102:103], v[114:115]
  v_cvt_pk_bf16_f32 v75, v102, v103
  v_pk_add_f32 v[104:105], v[104:105], v[112:113]
  v_cvt_pk_bf16_f32 v76, v104, v105
  v_lshlrev_b32 v104, 16, v76
  v_and_b32 v105, 0xffff0000, v76
  v_pk_mul_f32 v[104:105], v[104:105], v[114:115]
  v_cvt_pk_bf16_f32 v76, v104, v105
  v_pk_add_f32 v[106:107], v[106:107], v[112:113]
  v_cvt_pk_bf16_f32 v77, v106, v107
  v_lshlrev_b32 v106, 16, v77
  v_and_b32 v107, 0xffff0000, v77
  v_pk_mul_f32 v[106:107], v[106:107], v[114:115]
  v_cvt_pk_bf16_f32 v77, v106, v107
  v_pk_add_f32 v[108:109], v[108:109], v[112:113]
  v_cvt_pk_bf16_f32 v78, v108, v109
  v_lshlrev_b32 v108, 16, v78
  v_and_b32 v109, 0xffff0000, v78
  v_pk_mul_f32 v[108:109], v[108:109], v[114:115]
  v_cvt_pk_bf16_f32 v78, v108, v109
  v_pk_add_f32 v[110:111], v[110:111], v[112:113]
  v_cvt_pk_bf16_f32 v79, v110, v111
  v_lshlrev_b32 v110, 16, v79
  v_and_b32 v111, 0xffff0000, v79
  v_pk_mul_f32 v[110:111], v[110:111], v[114:115]
  v_cvt_pk_bf16_f32 v79, v110, v111
  ds_write_b128 v14, v[64:67] offset:0
  ds_write_b128 v14, v[68:71] offset:256
  ds_write_b128 v14, v[72:75] offset:512
  ds_write_b128 v14, v[76:79] offset:768
.L_k1b_kernel_3:
  s_waitcnt vmcnt(4)
  v_lshlrev_b32 v80, 16, v32
  v_and_b32 v81, 0xffff0000, v32
  v_lshlrev_b32 v82, 16, v33
  v_and_b32 v83, 0xffff0000, v33
  v_lshlrev_b32 v84, 16, v34
  v_and_b32 v85, 0xffff0000, v34
  v_lshlrev_b32 v86, 16, v35
  v_and_b32 v87, 0xffff0000, v35
  v_lshlrev_b32 v88, 16, v36
  v_and_b32 v89, 0xffff0000, v36
  v_lshlrev_b32 v90, 16, v37
  v_and_b32 v91, 0xffff0000, v37
  v_lshlrev_b32 v92, 16, v38
  v_and_b32 v93, 0xffff0000, v38
  v_lshlrev_b32 v94, 16, v39
  v_and_b32 v95, 0xffff0000, v39
  v_lshlrev_b32 v96, 16, v40
  v_and_b32 v97, 0xffff0000, v40
  v_lshlrev_b32 v98, 16, v41
  v_and_b32 v99, 0xffff0000, v41
  v_lshlrev_b32 v100, 16, v42
  v_and_b32 v101, 0xffff0000, v42
  v_lshlrev_b32 v102, 16, v43
  v_and_b32 v103, 0xffff0000, v43
  v_lshlrev_b32 v104, 16, v44
  v_and_b32 v105, 0xffff0000, v44
  v_lshlrev_b32 v106, 16, v45
  v_and_b32 v107, 0xffff0000, v45
  v_lshlrev_b32 v108, 16, v46
  v_and_b32 v109, 0xffff0000, v46
  v_lshlrev_b32 v110, 16, v47
  v_and_b32 v111, 0xffff0000, v47
  v_pk_add_f32 v[4:5], v[80:81], v[82:83]
  v_pk_mul_f32 v[6:7], v[80:81], v[80:81]
  v_pk_fma_f32 v[6:7], v[82:83], v[82:83], v[6:7]
  v_pk_add_f32 v[4:5], v[4:5], v[84:85]
  v_pk_fma_f32 v[6:7], v[84:85], v[84:85], v[6:7]
  v_pk_add_f32 v[4:5], v[4:5], v[86:87]
  v_pk_fma_f32 v[6:7], v[86:87], v[86:87], v[6:7]
  v_pk_add_f32 v[4:5], v[4:5], v[88:89]
  v_pk_fma_f32 v[6:7], v[88:89], v[88:89], v[6:7]
  v_pk_add_f32 v[4:5], v[4:5], v[90:91]
  v_pk_fma_f32 v[6:7], v[90:91], v[90:91], v[6:7]
  v_pk_add_f32 v[4:5], v[4:5], v[92:93]
  v_pk_fma_f32 v[6:7], v[92:93], v[92:93], v[6:7]
  v_pk_add_f32 v[4:5], v[4:5], v[94:95]
  v_pk_fma_f32 v[6:7], v[94:95], v[94:95], v[6:7]
  v_pk_add_f32 v[4:5], v[4:5], v[96:97]
  v_pk_fma_f32 v[6:7], v[96:97], v[96:97], v[6:7]
  v_pk_add_f32 v[4:5], v[4:5], v[98:99]
  v_pk_fma_f32 v[6:7], v[98:99], v[98:99], v[6:7]
  v_pk_add_f32 v[4:5], v[4:5], v[100:101]
  v_pk_fma_f32 v[6:7], v[100:101], v[100:101], v[6:7]
  v_pk_add_f32 v[4:5], v[4:5], v[102:103]
  v_pk_fma_f32 v[6:7], v[102:103], v[102:103], v[6:7]
  v_pk_add_f32 v[4:5], v[4:5], v[104:105]
  v_pk_fma_f32 v[6:7], v[104:105], v[104:105], v[6:7]
  v_pk_add_f32 v[4:5], v[4:5], v[106:107]
  v_pk_fma_f32 v[6:7], v[106:107], v[106:107], v[6:7]
  v_pk_add_f32 v[4:5], v[4:5], v[108:109]
  v_pk_fma_f32 v[6:7], v[108:109], v[108:109], v[6:7]
  v_pk_add_f32 v[4:5], v[4:5], v[110:111]
  v_pk_fma_f32 v[6:7], v[110:111], v[110:111], v[6:7]
  v_add_f32 v4, v4, v5
  v_add_f32 v6, v6, v7
  s_nop 1
  v_add_f32_dpp v4, v4, v4 row_ror:8 row_mask:0xf bank_mask:0xf
  v_add_f32_dpp v6, v6, v6 row_ror:8 row_mask:0xf bank_mask:0xf
  s_nop 1
  v_add_f32_dpp v4, v4, v4 row_ror:4 row_mask:0xf bank_mask:0xf
  v_add_f32_dpp v6, v6, v6 row_ror:4 row_mask:0xf bank_mask:0xf
  s_nop 1
  v_add_f32_dpp v4, v4, v4 row_ror:2 row_mask:0xf bank_mask:0xf
  v_add_f32_dpp v6, v6, v6 row_ror:2 row_mask:0xf bank_mask:0xf
  s_nop 1
  v_add_f32_dpp v4, v4, v4 row_ror:1 row_mask:0xf bank_mask:0xf
  v_add_f32_dpp v6, v6, v6 row_ror:1 row_mask:0xf bank_mask:0xf
  v_mul_f32 v4, 0x3b000000, v4
  v_mul_f32 v6, 0x3b000000, v6
  v_fma_f32 v6, -v4, v4, v6
  v_max_f32 v6, 0, v6
  v_cvt_pk_bf16_f32 v112, v4, v4
  v_lshlrev_b32 v112, 16, v112
  v_cvt_pk_bf16_f32 v30, v6, v6
  v_lshlrev_b32 v30, 16, v30
  v_add_f32 v30, 0x3727c5ac, v30
  v_cvt_pk_bf16_f32 v30, v30, v30
  v_lshlrev_b32 v30, 16, v30
  v_sqrt_f32 v15, v30
  s_nop 0
  v_cvt_pk_bf16_f32 v15, v15, v15
  v_lshlrev_b32 v15, 16, v15
  v_rcp_f32 v114, v15
  s_nop 0
  v_sub_f32 v112, 0, v112
  v_mov_b32 v113, v112
  v_mov_b32 v115, v114
  v_pk_add_f32 v[80:81], v[80:81], v[112:113]
  v_cvt_pk_bf16_f32 v32, v80, v81
  v_lshlrev_b32 v80, 16, v32
  v_and_b32 v81, 0xffff0000, v32
  v_pk_mul_f32 v[80:81], v[80:81], v[114:115]
  v_cvt_pk_bf16_f32 v32, v80, v81
  v_pk_add_f32 v[82:83], v[82:83], v[112:113]
  v_cvt_pk_bf16_f32 v33, v82, v83
  v_lshlrev_b32 v82, 16, v33
  v_and_b32 v83, 0xffff0000, v33
  v_pk_mul_f32 v[82:83], v[82:83], v[114:115]
  v_cvt_pk_bf16_f32 v33, v82, v83
  v_pk_add_f32 v[84:85], v[84:85], v[112:113]
  v_cvt_pk_bf16_f32 v34, v84, v85
  v_lshlrev_b32 v84, 16, v34
  v_and_b32 v85, 0xffff0000, v34
  v_pk_mul_f32 v[84:85], v[84:85], v[114:115]
  v_cvt_pk_bf16_f32 v34, v84, v85
  v_pk_add_f32 v[86:87], v[86:87], v[112:113]
  v_cvt_pk_bf16_f32 v35, v86, v87
  v_lshlrev_b32 v86, 16, v35
  v_and_b32 v87, 0xffff0000, v35
  v_pk_mul_f32 v[86:87], v[86:87], v[114:115]
  v_cvt_pk_bf16_f32 v35, v86, v87
  v_pk_add_f32 v[88:89], v[88:89], v[112:113]
  v_cvt_pk_bf16_f32 v36, v88, v89
  v_lshlrev_b32 v88, 16, v36
  v_and_b32 v89, 0xffff0000, v36
  v_pk_mul_f32 v[88:89], v[88:89], v[114:115]
  v_cvt_pk_bf16_f32 v36, v88, v89
  v_pk_add_f32 v[90:91], v[90:91], v[112:113]
  v_cvt_pk_bf16_f32 v37, v90, v91
  v_lshlrev_b32 v90, 16, v37
  v_and_b32 v91, 0xffff0000, v37
  v_pk_mul_f32 v[90:91], v[90:91], v[114:115]
  v_cvt_pk_bf16_f32 v37, v90, v91
  v_pk_add_f32 v[92:93], v[92:93], v[112:113]
  v_cvt_pk_bf16_f32 v38, v92, v93
  v_lshlrev_b32 v92, 16, v38
  v_and_b32 v93, 0xffff0000, v38
  v_pk_mul_f32 v[92:93], v[92:93], v[114:115]
  v_cvt_pk_bf16_f32 v38, v92, v93
  v_pk_add_f32 v[94:95], v[94:95], v[112:113]
  v_cvt_pk_bf16_f32 v39, v94, v95
  v_lshlrev_b32 v94, 16, v39
  v_and_b32 v95, 0xffff0000, v39
  v_pk_mul_f32 v[94:95], v[94:95], v[114:115]
  v_cvt_pk_bf16_f32 v39, v94, v95
  v_pk_add_f32 v[96:97], v[96:97], v[112:113]
  v_cvt_pk_bf16_f32 v40, v96, v97
  v_lshlrev_b32 v96, 16, v40
  v_and_b32 v97, 0xffff0000, v40
  v_pk_mul_f32 v[96:97], v[96:97], v[114:115]
  v_cvt_pk_bf16_f32 v40, v96, v97
  v_pk_add_f32 v[98:99], v[98:99], v[112:113]
  v_cvt_pk_bf16_f32 v41, v98, v99
  v_lshlrev_b32 v98, 16, v41
  v_and_b32 v99, 0xffff0000, v41
  v_pk_mul_f32 v[98:99], v[98:99], v[114:115]
  v_cvt_pk_bf16_f32 v41, v98, v99
  v_pk_add_f32 v[100:101], v[100:101], v[112:113]
  v_cvt_pk_bf16_f32 v42, v100, v101
  v_lshlrev_b32 v100, 16, v42
  v_and_b32 v101, 0xffff0000, v42
  v_pk_mul_f32 v[100:101], v[100:101], v[114:115]
  v_cvt_pk_bf16_f32 v42, v100, v101
  v_pk_add_f32 v[102:103], v[102:103], v[112:113]
  v_cvt_pk_bf16_f32 v43, v102, v103
  v_lshlrev_b32 v102, 16, v43
  v_and_b32 v103, 0xffff0000, v43
  v_pk_mul_f32 v[102:103], v[102:103], v[114:115]
  v_cvt_pk_bf16_f32 v43, v102, v103
  v_pk_add_f32 v[104:105], v[104:105], v[112:113]
  v_cvt_pk_bf16_f32 v44, v104, v105
  v_lshlrev_b32 v104, 16, v44
  v_and_b32 v105, 0xffff0000, v44
  v_pk_mul_f32 v[104:105], v[104:105], v[114:115]
  v_cvt_pk_bf16_f32 v44, v104, v105
  v_pk_add_f32 v[106:107], v[106:107], v[112:113]
  v_cvt_pk_bf16_f32 v45, v106, v107
  v_lshlrev_b32 v106, 16, v45
  v_and_b32 v107, 0xffff0000, v45
  v_pk_mul_f32 v[106:107], v[106:107], v[114:115]
  v_cvt_pk_bf16_f32 v45, v106, v107
  v_pk_add_f32 v[108:109], v[108:109], v[112:113]
  v_cvt_pk_bf16_f32 v46, v108, v109
  v_lshlrev_b32 v108, 16, v46
  v_and_b32 v109, 0xffff0000, v46
  v_pk_mul_f32 v[108:109], v[108:109], v[114:115]
  v_cvt_pk_bf16_f32 v46, v108, v109
  v_pk_add_f32 v[110:111], v[110:111], v[112:113]
  v_cvt_pk_bf16_f32 v47, v110, v111
  v_lshlrev_b32 v110, 16, v47
  v_and_b32 v111, 0xffff0000, v47
  v_pk_mul_f32 v[110:111], v[110:111], v[114:115]
  v_cvt_pk_bf16_f32 v47, v110, v111
  ds_write_b128 v13, v[32:35] offset:0
  ds_write_b128 v13, v[36:39] offset:256
  ds_write_b128 v13, v[40:43] offset:512
  ds_write_b128 v13, v[44:47] offset:768
  s_waitcnt vmcnt(0)
  v_lshlrev_b32 v80, 16, v48
  v_and_b32 v81, 0xffff0000, v48
  v_lshlrev_b32 v82, 16, v49
  v_and_b32 v83, 0xffff0000, v49
  v_lshlrev_b32 v84, 16, v50
  v_and_b32 v85, 0xffff0000, v50
  v_lshlrev_b32 v86, 16, v51
  v_and_b32 v87, 0xffff0000, v51
  v_lshlrev_b32 v88, 16, v52
  v_and_b32 v89, 0xffff0000, v52
  v_lshlrev_b32 v90, 16, v53
  v_and_b32 v91, 0xffff0000, v53
  v_lshlrev_b32 v92, 16, v54
  v_and_b32 v93, 0xffff0000, v54
  v_lshlrev_b32 v94, 16, v55
  v_and_b32 v95, 0xffff0000, v55
  v_lshlrev_b32 v96, 16, v56
  v_and_b32 v97, 0xffff0000, v56
  v_lshlrev_b32 v98, 16, v57
  v_and_b32 v99, 0xffff0000, v57
  v_lshlrev_b32 v100, 16, v58
  v_and_b32 v101, 0xffff0000, v58
  v_lshlrev_b32 v102, 16, v59
  v_and_b32 v103, 0xffff0000, v59
  v_lshlrev_b32 v104, 16, v60
  v_and_b32 v105, 0xffff0000, v60
  v_lshlrev_b32 v106, 16, v61
  v_and_b32 v107, 0xffff0000, v61
  v_lshlrev_b32 v108, 16, v62
  v_and_b32 v109, 0xffff0000, v62
  v_lshlrev_b32 v110, 16, v63
  v_and_b32 v111, 0xffff0000, v63
  v_pk_add_f32 v[4:5], v[80:81], v[82:83]
  v_pk_mul_f32 v[6:7], v[80:81], v[80:81]
  v_pk_fma_f32 v[6:7], v[82:83], v[82:83], v[6:7]
  v_pk_add_f32 v[4:5], v[4:5], v[84:85]
  v_pk_fma_f32 v[6:7], v[84:85], v[84:85], v[6:7]
  v_pk_add_f32 v[4:5], v[4:5], v[86:87]
  v_pk_fma_f32 v[6:7], v[86:87], v[86:87], v[6:7]
  v_pk_add_f32 v[4:5], v[4:5], v[88:89]
  v_pk_fma_f32 v[6:7], v[88:89], v[88:89], v[6:7]
  v_pk_add_f32 v[4:5], v[4:5], v[90:91]
  v_pk_fma_f32 v[6:7], v[90:91], v[90:91], v[6:7]
  v_pk_add_f32 v[4:5], v[4:5], v[92:93]
  v_pk_fma_f32 v[6:7], v[92:93], v[92:93], v[6:7]
  v_pk_add_f32 v[4:5], v[4:5], v[94:95]
  v_pk_fma_f32 v[6:7], v[94:95], v[94:95], v[6:7]
  v_pk_add_f32 v[4:5], v[4:5], v[96:97]
  v_pk_fma_f32 v[6:7], v[96:97], v[96:97], v[6:7]
  v_pk_add_f32 v[4:5], v[4:5], v[98:99]
  v_pk_fma_f32 v[6:7], v[98:99], v[98:99], v[6:7]
  v_pk_add_f32 v[4:5], v[4:5], v[100:101]
  v_pk_fma_f32 v[6:7], v[100:101], v[100:101], v[6:7]
  v_pk_add_f32 v[4:5], v[4:5], v[102:103]
  v_pk_fma_f32 v[6:7], v[102:103], v[102:103], v[6:7]
  v_pk_add_f32 v[4:5], v[4:5], v[104:105]
  v_pk_fma_f32 v[6:7], v[104:105], v[104:105], v[6:7]
  v_pk_add_f32 v[4:5], v[4:5], v[106:107]
  v_pk_fma_f32 v[6:7], v[106:107], v[106:107], v[6:7]
  v_pk_add_f32 v[4:5], v[4:5], v[108:109]
  v_pk_fma_f32 v[6:7], v[108:109], v[108:109], v[6:7]
  v_pk_add_f32 v[4:5], v[4:5], v[110:111]
  v_pk_fma_f32 v[6:7], v[110:111], v[110:111], v[6:7]
  v_add_f32 v4, v4, v5
  v_add_f32 v6, v6, v7
  s_nop 1
  v_add_f32_dpp v4, v4, v4 row_ror:8 row_mask:0xf bank_mask:0xf
  v_add_f32_dpp v6, v6, v6 row_ror:8 row_mask:0xf bank_mask:0xf
  s_nop 1
  v_add_f32_dpp v4, v4, v4 row_ror:4 row_mask:0xf bank_mask:0xf
  v_add_f32_dpp v6, v6, v6 row_ror:4 row_mask:0xf bank_mask:0xf
  s_nop 1
  v_add_f32_dpp v4, v4, v4 row_ror:2 row_mask:0xf bank_mask:0xf
  v_add_f32_dpp v6, v6, v6 row_ror:2 row_mask:0xf bank_mask:0xf
  s_nop 1
  v_add_f32_dpp v4, v4, v4 row_ror:1 row_mask:0xf bank_mask:0xf
  v_add_f32_dpp v6, v6, v6 row_ror:1 row_mask:0xf bank_mask:0xf
  v_mul_f32 v4, 0x3b000000, v4
  v_mul_f32 v6, 0x3b000000, v6
  v_fma_f32 v6, -v4, v4, v6
  v_max_f32 v6, 0, v6
  v_cvt_pk_bf16_f32 v112, v4, v4
  v_lshlrev_b32 v112, 16, v112
  v_cvt_pk_bf16_f32 v30, v6, v6
  v_lshlrev_b32 v30, 16, v30
  v_add_f32 v30, 0x3727c5ac, v30
  v_cvt_pk_bf16_f32 v30, v30, v30
  v_lshlrev_b32 v30, 16, v30
  v_sqrt_f32 v15, v30
  s_nop 0
  v_cvt_pk_bf16_f32 v15, v15, v15
  v_lshlrev_b32 v15, 16, v15
  v_rcp_f32 v114, v15
  s_nop 0
  v_sub_f32 v112, 0, v112
  v_mov_b32 v113, v112
  v_mov_b32 v115, v114
  v_pk_add_f32 v[80:81], v[80:81], v[112:113]
  v_cvt_pk_bf16_f32 v48, v80, v81
  v_lshlrev_b32 v80, 16, v48
  v_and_b32 v81, 0xffff0000, v48
  v_pk_mul_f32 v[80:81], v[80:81], v[114:115]
  v_cvt_pk_bf16_f32 v48, v80, v81
  v_pk_add_f32 v[82:83], v[82:83], v[112:113]
  v_cvt_pk_bf16_f32 v49, v82, v83
  v_lshlrev_b32 v82, 16, v49
  v_and_b32 v83, 0xffff0000, v49
  v_pk_mul_f32 v[82:83], v[82:83], v[114:115]
  v_cvt_pk_bf16_f32 v49, v82, v83
  v_pk_add_f32 v[84:85], v[84:85], v[112:113]
  v_cvt_pk_bf16_f32 v50, v84, v85
  v_lshlrev_b32 v84, 16, v50
  v_and_b32 v85, 0xffff0000, v50
  v_pk_mul_f32 v[84:85], v[84:85], v[114:115]
  v_cvt_pk_bf16_f32 v50, v84, v85
  v_pk_add_f32 v[86:87], v[86:87], v[112:113]
  v_cvt_pk_bf16_f32 v51, v86, v87
  v_lshlrev_b32 v86, 16, v51
  v_and_b32 v87, 0xffff0000, v51
  v_pk_mul_f32 v[86:87], v[86:87], v[114:115]
  v_cvt_pk_bf16_f32 v51, v86, v87
  v_pk_add_f32 v[88:89], v[88:89], v[112:113]
  v_cvt_pk_bf16_f32 v52, v88, v89
  v_lshlrev_b32 v88, 16, v52
  v_and_b32 v89, 0xffff0000, v52
  v_pk_mul_f32 v[88:89], v[88:89], v[114:115]
  v_cvt_pk_bf16_f32 v52, v88, v89
  v_pk_add_f32 v[90:91], v[90:91], v[112:113]
  v_cvt_pk_bf16_f32 v53, v90, v91
  v_lshlrev_b32 v90, 16, v53
  v_and_b32 v91, 0xffff0000, v53
  v_pk_mul_f32 v[90:91], v[90:91], v[114:115]
  v_cvt_pk_bf16_f32 v53, v90, v91
  v_pk_add_f32 v[92:93], v[92:93], v[112:113]
  v_cvt_pk_bf16_f32 v54, v92, v93
  v_lshlrev_b32 v92, 16, v54
  v_and_b32 v93, 0xffff0000, v54
  v_pk_mul_f32 v[92:93], v[92:93], v[114:115]
  v_cvt_pk_bf16_f32 v54, v92, v93
  v_pk_add_f32 v[94:95], v[94:95], v[112:113]
  v_cvt_pk_bf16_f32 v55, v94, v95
  v_lshlrev_b32 v94, 16, v55
  v_and_b32 v95, 0xffff0000, v55
  v_pk_mul_f32 v[94:95], v[94:95], v[114:115]
  v_cvt_pk_bf16_f32 v55, v94, v95
  v_pk_add_f32 v[96:97], v[96:97], v[112:113]
  v_cvt_pk_bf16_f32 v56, v96, v97
  v_lshlrev_b32 v96, 16, v56
  v_and_b32 v97, 0xffff0000, v56
  v_pk_mul_f32 v[96:97], v[96:97], v[114:115]
  v_cvt_pk_bf16_f32 v56, v96, v97
  v_pk_add_f32 v[98:99], v[98:99], v[112:113]
  v_cvt_pk_bf16_f32 v57, v98, v99
  v_lshlrev_b32 v98, 16, v57
  v_and_b32 v99, 0xffff0000, v57
  v_pk_mul_f32 v[98:99], v[98:99], v[114:115]
  v_cvt_pk_bf16_f32 v57, v98, v99
  v_pk_add_f32 v[100:101], v[100:101], v[112:113]
  v_cvt_pk_bf16_f32 v58, v100, v101
  v_lshlrev_b32 v100, 16, v58
  v_and_b32 v101, 0xffff0000, v58
  v_pk_mul_f32 v[100:101], v[100:101], v[114:115]
  v_cvt_pk_bf16_f32 v58, v100, v101
  v_pk_add_f32 v[102:103], v[102:103], v[112:113]
  v_cvt_pk_bf16_f32 v59, v102, v103
  v_lshlrev_b32 v102, 16, v59
  v_and_b32 v103, 0xffff0000, v59
  v_pk_mul_f32 v[102:103], v[102:103], v[114:115]
  v_cvt_pk_bf16_f32 v59, v102, v103
  v_pk_add_f32 v[104:105], v[104:105], v[112:113]
  v_cvt_pk_bf16_f32 v60, v104, v105
  v_lshlrev_b32 v104, 16, v60
  v_and_b32 v105, 0xffff0000, v60
  v_pk_mul_f32 v[104:105], v[104:105], v[114:115]
  v_cvt_pk_bf16_f32 v60, v104, v105
  v_pk_add_f32 v[106:107], v[106:107], v[112:113]
  v_cvt_pk_bf16_f32 v61, v106, v107
  v_lshlrev_b32 v106, 16, v61
  v_and_b32 v107, 0xffff0000, v61
  v_pk_mul_f32 v[106:107], v[106:107], v[114:115]
  v_cvt_pk_bf16_f32 v61, v106, v107
  v_pk_add_f32 v[108:109], v[108:109], v[112:113]
  v_cvt_pk_bf16_f32 v62, v108, v109
  v_lshlrev_b32 v108, 16, v62
  v_and_b32 v109, 0xffff0000, v62
  v_pk_mul_f32 v[108:109], v[108:109], v[114:115]
  v_cvt_pk_bf16_f32 v62, v108, v109
  v_pk_add_f32 v[110:111], v[110:111], v[112:113]
  v_cvt_pk_bf16_f32 v63, v110, v111
  v_lshlrev_b32 v110, 16, v63
  v_and_b32 v111, 0xffff0000, v63
  v_pk_mul_f32 v[110:111], v[110:111], v[114:115]
  v_cvt_pk_bf16_f32 v63, v110, v111
  ds_write_b128 v13, v[48:51] offset:32768
  ds_write_b128 v13, v[52:55] offset:33024
  ds_write_b128 v13, v[56:59] offset:33280
  ds_write_b128 v13, v[60:63] offset:33536
  s_waitcnt lgkmcnt(0)
  s_barrier
  v_mov_b32 v80, 0
  v_mov_b32 v81, 0
  v_mov_b32 v82, 0
  v_mov_b32 v83, 0
  v_mov_b32 v84, 0
  v_mov_b32 v85, 0
  v_mov_b32 v86, 0
  v_mov_b32 v87, 0
  v_mov_b32 v88, 0
  v_mov_b32 v89, 0
  v_mov_b32 v90, 0
  v_mov_b32 v91, 0
  v_mov_b32 v92, 0
  v_mov_b32 v93, 0
  v_mov_b32 v94, 0
  v_mov_b32 v95, 0
  v_mov_b32 v96, 0
  v_mov_b32 v97, 0
  v_mov_b32 v98, 0
  v_mov_b32 v99, 0
  v_mov_b32 v100, 0
  v_mov_b32 v101, 0
  v_mov_b32 v102, 0
  v_mov_b32 v103, 0
  v_mov_b32 v104, 0
  v_mov_b32 v105, 0
  v_mov_b32 v106, 0
  v_mov_b32 v107, 0
  ds_read_b128 v[32:35], v16 offset:0
  ds_read_b64_tr_b16 v[44:45], v24 offset:0
  ds_read_b64_tr_b16 v[46:47], v24 offset:1536
  ds_read_b128 v[36:39], v16 offset:16384
  ds_read_b64_tr_b16 v[48:49], v25 offset:0
  ds_read_b64_tr_b16 v[50:51], v25 offset:1536
  ds_read_b128 v[40:43], v20 offset:0
  ds_read_b64_tr_b16 v[52:53], v26 offset:0
  ds_read_b64_tr_b16 v[54:55], v26 offset:1536
  s_waitcnt lgkmcnt(0)
  v_mfma_f32_16x16x32_bf16 v[80:83], v[44:47], v[32:35], v[80:83]
  ds_read_b128 v[56:59], v17 offset:0
  v_mfma_f32_16x16x32_bf16 v[92:95], v[44:47], v[36:39], v[92:95]
  ds_read_b64_tr_b16 v[68:69], v24 offset:12288
  ds_read_b64_tr_b16 v[70:71], v24 offset:13824
  v_mfma_f32_16x16x32_bf16 v[84:87], v[48:51], v[32:35], v[84:87]
  ds_read_b128 v[60:63], v17 offset:16384
  v_mfma_f32_16x16x32_bf16 v[96:99], v[48:51], v[36:39], v[96:99]
  ds_read_b64_tr_b16 v[72:73], v25 offset:12288
  ds_read_b64_tr_b16 v[74:75], v25 offset:13824
  v_mfma_f32_16x16x32_bf16 v[104:107], v[48:51], v[40:43], v[104:107]
  ds_read_b128 v[64:67], v21 offset:0
  v_mfma_f32_16x16x32_bf16 v[88:91], v[52:55], v[32:35], v[88:91]
  ds_read_b64_tr_b16 v[76:77], v26 offset:12288
  ds_read_b64_tr_b16 v[78:79], v26 offset:13824
  v_mfma_f32_16x16x32_bf16 v[100:103], v[52:55], v[36:39], v[100:103]
  s_waitcnt lgkmcnt(0)
  s_barrier
  v_mfma_f32_16x16x32_bf16 v[80:83], v[68:71], v[56:59], v[80:83]
  ds_read_b128 v[32:35], v18 offset:0
  v_mfma_f32_16x16x32_bf16 v[92:95], v[68:71], v[60:63], v[92:95]
  ds_read_b64_tr_b16 v[44:45], v24 offset:24576
  ds_read_b64_tr_b16 v[46:47], v24 offset:26112
  v_mfma_f32_16x16x32_bf16 v[84:87], v[72:75], v[56:59], v[84:87]
  ds_read_b128 v[36:39], v18 offset:16384
  v_mfma_f32_16x16x32_bf16 v[96:99], v[72:75], v[60:63], v[96:99]
  ds_read_b64_tr_b16 v[48:49], v25 offset:24576
  ds_read_b64_tr_b16 v[50:51], v25 offset:26112
  v_mfma_f32_16x16x32_bf16 v[104:107], v[72:75], v[64:67], v[104:107]
  ds_read_b128 v[40:43], v22 offset:0
  v_mfma_f32_16x16x32_bf16 v[88:91], v[76:79], v[56:59], v[88:91]
  ds_read_b64_tr_b16 v[52:53], v26 offset:24576
  ds_read_b64_tr_b16 v[54:55], v26 offset:26112
  v_mfma_f32_16x16x32_bf16 v[100:103], v[76:79], v[60:63], v[100:103]
  s_waitcnt lgkmcnt(0)
  v_mfma_f32_16x16x32_bf16 v[80:83], v[44:47], v[32:35], v[80:83]
  ds_read_b128 v[56:59], v19 offset:0
  v_mfma_f32_16x16x32_bf16 v[92:95], v[44:47], v[36:39], v[92:95]
  ds_read_b64_tr_b16 v[68:69], v24 offset:36864
  ds_read_b64_tr_b16 v[70:71], v24 offset:38400
  v_mfma_f32_16x16x32_bf16 v[84:87], v[48:51], v[32:35], v[84:87]
  ds_read_b128 v[60:63], v19 offset:16384
  v_mfma_f32_16x16x32_bf16 v[96:99], v[48:51], v[36:39], v[96:99]
  ds_read_b64_tr_b16 v[72:73], v25 offset:36864
  ds_read_b64_tr_b16 v[74:75], v25 offset:38400
  v_mfma_f32_16x16x32_bf16 v[104:107], v[48:51], v[40:43], v[104:107]
  ds_read_b128 v[64:67], v23 offset:0
  v_mfma_f32_16x16x32_bf16 v[88:91], v[52:55], v[32:35], v[88:91]
  ds_read_b64_tr_b16 v[76:77], v26 offset:36864
  ds_read_b64_tr_b16 v[78:79], v26 offset:38400
  v_mfma_f32_16x16x32_bf16 v[100:103], v[52:55], v[36:39], v[100:103]
  s_waitcnt lgkmcnt(0)
  s_barrier
  v_mfma_f32_16x16x32_bf16 v[80:83], v[68:71], v[56:59], v[80:83]
  ds_read_b128 v[32:35], v16 offset:256
  v_mfma_f32_16x16x32_bf16 v[92:95], v[68:71], v[60:63], v[92:95]
  ds_read_b64_tr_b16 v[44:45], v24 offset:49152
  ds_read_b64_tr_b16 v[46:47], v24 offset:50688
  v_mfma_f32_16x16x32_bf16 v[84:87], v[72:75], v[56:59], v[84:87]
  ds_read_b128 v[36:39], v16 offset:16640
  v_mfma_f32_16x16x32_bf16 v[96:99], v[72:75], v[60:63], v[96:99]
  ds_read_b64_tr_b16 v[48:49], v25 offset:49152
  ds_read_b64_tr_b16 v[50:51], v25 offset:50688
  v_mfma_f32_16x16x32_bf16 v[104:107], v[72:75], v[64:67], v[104:107]
  ds_read_b128 v[40:43], v20 offset:256
  v_mfma_f32_16x16x32_bf16 v[88:91], v[76:79], v[56:59], v[88:91]
  ds_read_b64_tr_b16 v[52:53], v26 offset:49152
  ds_read_b64_tr_b16 v[54:55], v26 offset:50688
  v_mfma_f32_16x16x32_bf16 v[100:103], v[76:79], v[60:63], v[100:103]
  s_waitcnt lgkmcnt(0)
  v_mfma_f32_16x16x32_bf16 v[80:83], v[44:47], v[32:35], v[80:83]
  ds_read_b128 v[56:59], v17 offset:256
  v_mfma_f32_16x16x32_bf16 v[92:95], v[44:47], v[36:39], v[92:95]
  ds_read_b64_tr_b16 v[68:69], v24 offset:61440
  ds_read_b64_tr_b16 v[70:71], v24 offset:62976
  v_mfma_f32_16x16x32_bf16 v[84:87], v[48:51], v[32:35], v[84:87]
  ds_read_b128 v[60:63], v17 offset:16640
  v_mfma_f32_16x16x32_bf16 v[96:99], v[48:51], v[36:39], v[96:99]
  ds_read_b64_tr_b16 v[72:73], v25 offset:61440
  ds_read_b64_tr_b16 v[74:75], v25 offset:62976
  v_mfma_f32_16x16x32_bf16 v[104:107], v[48:51], v[40:43], v[104:107]
  ds_read_b128 v[64:67], v21 offset:256
  v_mfma_f32_16x16x32_bf16 v[88:91], v[52:55], v[32:35], v[88:91]
  ds_read_b64_tr_b16 v[76:77], v26 offset:61440
  ds_read_b64_tr_b16 v[78:79], v26 offset:62976
  v_mfma_f32_16x16x32_bf16 v[100:103], v[52:55], v[36:39], v[100:103]
  s_waitcnt lgkmcnt(0)
  s_barrier
  v_mfma_f32_16x16x32_bf16 v[80:83], v[68:71], v[56:59], v[80:83]
  ds_read_b128 v[32:35], v18 offset:256
  v_mfma_f32_16x16x32_bf16 v[92:95], v[68:71], v[60:63], v[92:95]
  ds_read_b64_tr_b16 v[44:45], v24 offset:0
  ds_read_b64_tr_b16 v[46:47], v24 offset:1536
  v_mfma_f32_16x16x32_bf16 v[84:87], v[72:75], v[56:59], v[84:87]
  ds_read_b128 v[36:39], v18 offset:16640
  v_mfma_f32_16x16x32_bf16 v[96:99], v[72:75], v[60:63], v[96:99]
  ds_read_b64_tr_b16 v[48:49], v25 offset:0
  ds_read_b64_tr_b16 v[50:51], v25 offset:1536
  v_mfma_f32_16x16x32_bf16 v[104:107], v[72:75], v[64:67], v[104:107]
  ds_read_b128 v[40:43], v22 offset:256
  v_mfma_f32_16x16x32_bf16 v[88:91], v[76:79], v[56:59], v[88:91]
  ds_read_b64_tr_b16 v[52:53], v26 offset:0
  ds_read_b64_tr_b16 v[54:55], v26 offset:1536
  v_mfma_f32_16x16x32_bf16 v[100:103], v[76:79], v[60:63], v[100:103]
  s_waitcnt lgkmcnt(0)
  v_mfma_f32_16x16x32_bf16 v[80:83], v[44:47], v[32:35], v[80:83]
  ds_read_b128 v[56:59], v19 offset:256
  v_mfma_f32_16x16x32_bf16 v[92:95], v[44:47], v[36:39], v[92:95]
  ds_read_b64_tr_b16 v[68:69], v24 offset:12288
  ds_read_b64_tr_b16 v[70:71], v24 offset:13824
  v_mfma_f32_16x16x32_bf16 v[84:87], v[48:51], v[32:35], v[84:87]
  ds_read_b128 v[60:63], v19 offset:16640
  v_mfma_f32_16x16x32_bf16 v[96:99], v[48:51], v[36:39], v[96:99]
  ds_read_b64_tr_b16 v[72:73], v25 offset:12288
  ds_read_b64_tr_b16 v[74:75], v25 offset:13824
  v_mfma_f32_16x16x32_bf16 v[104:107], v[48:51], v[40:43], v[104:107]
  ds_read_b128 v[64:67], v23 offset:256
  v_mfma_f32_16x16x32_bf16 v[88:91], v[52:55], v[32:35], v[88:91]
  ds_read_b64_tr_b16 v[76:77], v26 offset:12288
  ds_read_b64_tr_b16 v[78:79], v26 offset:13824
  v_mfma_f32_16x16x32_bf16 v[100:103], v[52:55], v[36:39], v[100:103]
  s_waitcnt lgkmcnt(0)
  s_barrier
  v_mfma_f32_16x16x32_bf16 v[80:83], v[68:71], v[56:59], v[80:83]
  ds_read_b128 v[32:35], v16 offset:512
  v_mfma_f32_16x16x32_bf16 v[92:95], v[68:71], v[60:63], v[92:95]
  ds_read_b64_tr_b16 v[44:45], v24 offset:24576
  ds_read_b64_tr_b16 v[46:47], v24 offset:26112
  v_mfma_f32_16x16x32_bf16 v[84:87], v[72:75], v[56:59], v[84:87]
  ds_read_b128 v[36:39], v16 offset:16896
  v_mfma_f32_16x16x32_bf16 v[96:99], v[72:75], v[60:63], v[96:99]
  ds_read_b64_tr_b16 v[48:49], v25 offset:24576
  ds_read_b64_tr_b16 v[50:51], v25 offset:26112
  v_mfma_f32_16x16x32_bf16 v[104:107], v[72:75], v[64:67], v[104:107]
  ds_read_b128 v[40:43], v20 offset:512
  v_mfma_f32_16x16x32_bf16 v[88:91], v[76:79], v[56:59], v[88:91]
  ds_read_b64_tr_b16 v[52:53], v26 offset:24576
  ds_read_b64_tr_b16 v[54:55], v26 offset:26112
  v_mfma_f32_16x16x32_bf16 v[100:103], v[76:79], v[60:63], v[100:103]
  s_waitcnt lgkmcnt(0)
  v_mfma_f32_16x16x32_bf16 v[80:83], v[44:47], v[32:35], v[80:83]
  ds_read_b128 v[56:59], v17 offset:512
  v_mfma_f32_16x16x32_bf16 v[92:95], v[44:47], v[36:39], v[92:95]
  ds_read_b64_tr_b16 v[68:69], v24 offset:36864
  ds_read_b64_tr_b16 v[70:71], v24 offset:38400
  v_mfma_f32_16x16x32_bf16 v[84:87], v[48:51], v[32:35], v[84:87]
  ds_read_b128 v[60:63], v17 offset:16896
  v_mfma_f32_16x16x32_bf16 v[96:99], v[48:51], v[36:39], v[96:99]
  ds_read_b64_tr_b16 v[72:73], v25 offset:36864
  ds_read_b64_tr_b16 v[74:75], v25 offset:38400
  v_mfma_f32_16x16x32_bf16 v[104:107], v[48:51], v[40:43], v[104:107]
  ds_read_b128 v[64:67], v21 offset:512
  v_mfma_f32_16x16x32_bf16 v[88:91], v[52:55], v[32:35], v[88:91]
  ds_read_b64_tr_b16 v[76:77], v26 offset:36864
  ds_read_b64_tr_b16 v[78:79], v26 offset:38400
  v_mfma_f32_16x16x32_bf16 v[100:103], v[52:55], v[36:39], v[100:103]
  s_waitcnt lgkmcnt(0)
  s_barrier
  v_mfma_f32_16x16x32_bf16 v[80:83], v[68:71], v[56:59], v[80:83]
  ds_read_b128 v[32:35], v18 offset:512
  v_mfma_f32_16x16x32_bf16 v[92:95], v[68:71], v[60:63], v[92:95]
  ds_read_b64_tr_b16 v[44:45], v24 offset:49152
  ds_read_b64_tr_b16 v[46:47], v24 offset:50688
  v_mfma_f32_16x16x32_bf16 v[84:87], v[72:75], v[56:59], v[84:87]
  ds_read_b128 v[36:39], v18 offset:16896
  v_mfma_f32_16x16x32_bf16 v[96:99], v[72:75], v[60:63], v[96:99]
  ds_read_b64_tr_b16 v[48:49], v25 offset:49152
  ds_read_b64_tr_b16 v[50:51], v25 offset:50688
  v_mfma_f32_16x16x32_bf16 v[104:107], v[72:75], v[64:67], v[104:107]
  ds_read_b128 v[40:43], v22 offset:512
  v_mfma_f32_16x16x32_bf16 v[88:91], v[76:79], v[56:59], v[88:91]
  ds_read_b64_tr_b16 v[52:53], v26 offset:49152
  ds_read_b64_tr_b16 v[54:55], v26 offset:50688
  v_mfma_f32_16x16x32_bf16 v[100:103], v[76:79], v[60:63], v[100:103]
  s_waitcnt lgkmcnt(0)
  v_mfma_f32_16x16x32_bf16 v[80:83], v[44:47], v[32:35], v[80:83]
  ds_read_b128 v[56:59], v19 offset:512
  v_mfma_f32_16x16x32_bf16 v[92:95], v[44:47], v[36:39], v[92:95]
  ds_read_b64_tr_b16 v[68:69], v24 offset:61440
  ds_read_b64_tr_b16 v[70:71], v24 offset:62976
  v_mfma_f32_16x16x32_bf16 v[84:87], v[48:51], v[32:35], v[84:87]
  ds_read_b128 v[60:63], v19 offset:16896
  v_mfma_f32_16x16x32_bf16 v[96:99], v[48:51], v[36:39], v[96:99]
  ds_read_b64_tr_b16 v[72:73], v25 offset:61440
  ds_read_b64_tr_b16 v[74:75], v25 offset:62976
  v_mfma_f32_16x16x32_bf16 v[104:107], v[48:51], v[40:43], v[104:107]
  ds_read_b128 v[64:67], v23 offset:512
  v_mfma_f32_16x16x32_bf16 v[88:91], v[52:55], v[32:35], v[88:91]
  ds_read_b64_tr_b16 v[76:77], v26 offset:61440
  ds_read_b64_tr_b16 v[78:79], v26 offset:62976
  v_mfma_f32_16x16x32_bf16 v[100:103], v[52:55], v[36:39], v[100:103]
  s_waitcnt lgkmcnt(0)
  s_barrier
  v_mfma_f32_16x16x32_bf16 v[80:83], v[68:71], v[56:59], v[80:83]
  ds_read_b128 v[32:35], v16 offset:768
  v_mfma_f32_16x16x32_bf16 v[92:95], v[68:71], v[60:63], v[92:95]
  ds_read_b64_tr_b16 v[44:45], v24 offset:0
  ds_read_b64_tr_b16 v[46:47], v24 offset:1536
  v_mfma_f32_16x16x32_bf16 v[84:87], v[72:75], v[56:59], v[84:87]
  ds_read_b128 v[36:39], v16 offset:17152
  v_mfma_f32_16x16x32_bf16 v[96:99], v[72:75], v[60:63], v[96:99]
  ds_read_b64_tr_b16 v[48:49], v25 offset:0
  ds_read_b64_tr_b16 v[50:51], v25 offset:1536
  v_mfma_f32_16x16x32_bf16 v[104:107], v[72:75], v[64:67], v[104:107]
  ds_read_b128 v[40:43], v20 offset:768
  v_mfma_f32_16x16x32_bf16 v[88:91], v[76:79], v[56:59], v[88:91]
  ds_read_b64_tr_b16 v[52:53], v26 offset:0
  ds_read_b64_tr_b16 v[54:55], v26 offset:1536
  v_mfma_f32_16x16x32_bf16 v[100:103], v[76:79], v[60:63], v[100:103]
  s_waitcnt lgkmcnt(0)
  v_mfma_f32_16x16x32_bf16 v[80:83], v[44:47], v[32:35], v[80:83]
  ds_read_b128 v[56:59], v17 offset:768
  v_mfma_f32_16x16x32_bf16 v[92:95], v[44:47], v[36:39], v[92:95]
  ds_read_b64_tr_b16 v[68:69], v24 offset:12288
  ds_read_b64_tr_b16 v[70:71], v24 offset:13824
  v_mfma_f32_16x16x32_bf16 v[84:87], v[48:51], v[32:35], v[84:87]
  ds_read_b128 v[60:63], v17 offset:17152
  v_mfma_f32_16x16x32_bf16 v[96:99], v[48:51], v[36:39], v[96:99]
  ds_read_b64_tr_b16 v[72:73], v25 offset:12288
  ds_read_b64_tr_b16 v[74:75], v25 offset:13824
  v_mfma_f32_16x16x32_bf16 v[104:107], v[48:51], v[40:43], v[104:107]
  ds_read_b128 v[64:67], v21 offset:768
  v_mfma_f32_16x16x32_bf16 v[88:91], v[52:55], v[32:35], v[88:91]
  ds_read_b64_tr_b16 v[76:77], v26 offset:12288
  ds_read_b64_tr_b16 v[78:79], v26 offset:13824
  v_mfma_f32_16x16x32_bf16 v[100:103], v[52:55], v[36:39], v[100:103]
  s_waitcnt lgkmcnt(0)
  s_barrier
  v_mfma_f32_16x16x32_bf16 v[80:83], v[68:71], v[56:59], v[80:83]
  ds_read_b128 v[32:35], v18 offset:768
  v_mfma_f32_16x16x32_bf16 v[92:95], v[68:71], v[60:63], v[92:95]
  ds_read_b64_tr_b16 v[44:45], v24 offset:24576
  ds_read_b64_tr_b16 v[46:47], v24 offset:26112
  v_mfma_f32_16x16x32_bf16 v[84:87], v[72:75], v[56:59], v[84:87]
  ds_read_b128 v[36:39], v18 offset:17152
  v_mfma_f32_16x16x32_bf16 v[96:99], v[72:75], v[60:63], v[96:99]
  ds_read_b64_tr_b16 v[48:49], v25 offset:24576
  ds_read_b64_tr_b16 v[50:51], v25 offset:26112
  v_mfma_f32_16x16x32_bf16 v[104:107], v[72:75], v[64:67], v[104:107]
  ds_read_b128 v[40:43], v22 offset:768
  v_mfma_f32_16x16x32_bf16 v[88:91], v[76:79], v[56:59], v[88:91]
  ds_read_b64_tr_b16 v[52:53], v26 offset:24576
  ds_read_b64_tr_b16 v[54:55], v26 offset:26112
  v_mfma_f32_16x16x32_bf16 v[100:103], v[76:79], v[60:63], v[100:103]
  s_waitcnt lgkmcnt(0)
  v_mfma_f32_16x16x32_bf16 v[80:83], v[44:47], v[32:35], v[80:83]
  ds_read_b128 v[56:59], v19 offset:768
  v_mfma_f32_16x16x32_bf16 v[92:95], v[44:47], v[36:39], v[92:95]
  ds_read_b64_tr_b16 v[68:69], v24 offset:36864
  ds_read_b64_tr_b16 v[70:71], v24 offset:38400
  v_mfma_f32_16x16x32_bf16 v[84:87], v[48:51], v[32:35], v[84:87]
  ds_read_b128 v[60:63], v19 offset:17152
  v_mfma_f32_16x16x32_bf16 v[96:99], v[48:51], v[36:39], v[96:99]
  ds_read_b64_tr_b16 v[72:73], v25 offset:36864
  ds_read_b64_tr_b16 v[74:75], v25 offset:38400
  v_mfma_f32_16x16x32_bf16 v[104:107], v[48:51], v[40:43], v[104:107]
  ds_read_b128 v[64:67], v23 offset:768
  v_mfma_f32_16x16x32_bf16 v[88:91], v[52:55], v[32:35], v[88:91]
  ds_read_b64_tr_b16 v[76:77], v26 offset:36864
  ds_read_b64_tr_b16 v[78:79], v26 offset:38400
  v_mfma_f32_16x16x32_bf16 v[100:103], v[52:55], v[36:39], v[100:103]
  s_waitcnt lgkmcnt(0)
  v_mfma_f32_16x16x32_bf16 v[80:83], v[68:71], v[56:59], v[80:83]
  v_mfma_f32_16x16x32_bf16 v[92:95], v[68:71], v[60:63], v[92:95]
  v_mfma_f32_16x16x32_bf16 v[84:87], v[72:75], v[56:59], v[84:87]
  v_mfma_f32_16x16x32_bf16 v[96:99], v[72:75], v[60:63], v[96:99]
  v_mfma_f32_16x16x32_bf16 v[104:107], v[72:75], v[64:67], v[104:107]
  v_mfma_f32_16x16x32_bf16 v[88:91], v[76:79], v[56:59], v[88:91]
  v_mfma_f32_16x16x32_bf16 v[100:103], v[76:79], v[60:63], v[100:103]
  s_nop 9
  s_barrier
  s_mul_i32 s22, s19, 12800
  s_mul_i32 s23, s20, 96
  v_mul_u32_u24 v7, 400, v2
  v_lshl_add_u32 v7, v3, 3, v7
  v_add_u32 v7, s23, v7
  s_add_u32 s22, s22, 6400
  v_add_u32 v4, s22, v7
  s_lshl_b32 s23, s19, 5
  v_add_u32 v5, s23, v4
  v_add_u32 v5, 32, v5
  v_subrev_u32 v6, s23, v4
  v_add_u32 v6, 64, v6
  v_add_u32 v7, s23, v7
  v_add_u32 v7, 32, v7
  v_cvt_pk_bf16_f32 v32, v80, v81
  v_cvt_pk_bf16_f32 v33, v82, v83
  ds_write_b64 v4, v[32:33] offset:0
  v_cvt_pk_bf16_f32 v34, v84, v85
  v_cvt_pk_bf16_f32 v35, v86, v87
  ds_write_b64 v5, v[34:35] offset:0
  v_cvt_pk_bf16_f32 v36, v88, v89
  v_cvt_pk_bf16_f32 v37, v90, v91
  ds_write_b64 v6, v[36:37] offset:0
  v_cvt_pk_bf16_f32 v38, v92, v93
  v_cvt_pk_bf16_f32 v39, v94, v95
  ds_write_b64 v4, v[38:39] offset:6400
  v_cvt_pk_bf16_f32 v40, v96, v97
  v_cvt_pk_bf16_f32 v41, v98, v99
  ds_write_b64 v5, v[40:41] offset:6400
  v_cvt_pk_bf16_f32 v42, v100, v101
  v_cvt_pk_bf16_f32 v43, v102, v103
  ds_write_b64 v6, v[42:43] offset:6400
  v_cvt_pk_bf16_f32 v44, v104, v105
  v_cvt_pk_bf16_f32 v45, v106, v107
  ds_write_b64 v7, v[44:45]
  s_waitcnt lgkmcnt(0)
  s_barrier
  s_cmp_ge_u32 s18, 4
  s_cbranch_scc1 .Lend_k1b_kernel
  s_mul_i32 s22, s18, 96
  v_mul_u32_u24 v4, 400, v1
  v_add_u32 v4, s22, v4
  ds_read_b128 v[32:35], v4 offset:6400
  ds_read_b128 v[36:39], v4 offset:6416
  ds_read_b128 v[40:43], v4 offset:6432
  ds_read_b128 v[44:47], v4 offset:6448
  ds_read_b128 v[48:51], v4 offset:5632
  ds_read_b128 v[52:55], v4 offset:5648
  ds_read_b128 v[56:59], v4 offset:4832
  ds_read_b128 v[60:63], v4 offset:4848
  ds_read_b128 v[64:67], v4 offset:4032
  ds_read_b128 v[68:71], v4 offset:4048
  ds_read_b128 v[72:75], v4 offset:3232
  ds_read_b128 v[76:79], v4 offset:3248
  ds_read_b128 v[80:83], v4 offset:2432
  ds_read_b128 v[84:87], v4 offset:2448
  ds_read_b128 v[88:91], v4 offset:1632
  ds_read_b128 v[92:95], v4 offset:1648
  ds_read_b128 v[96:99], v4 offset:832
  ds_read_b128 v[100:103], v4 offset:848
  s_lshl_b32 s22, s16, 6
  v_add_u32 v5, s22, v1
  v_mov_b32 v6, 0xce6e6b28
  v_mov_b32 v8, 0
  v_mov_b32 v9, 0
  v_mov_b32 v10, 0
  v_mov_b32 v11, 0
  v_mov_b32 v12, 0
  v_mov_b32 v13, 0
  v_mov_b32 v14, 0
  v_mov_b32 v15, 0
  s_waitcnt lgkmcnt(14)
  v_dot2_f32_bf16 v8, v32, v40, v8
  v_dot2_f32_bf16 v8, v33, v41, v8
  v_dot2_f32_bf16 v8, v34, v42, v8
  v_dot2_f32_bf16 v8, v35, v43, v8
  v_dot2_f32_bf16 v8, v36, v44, v8
  v_dot2_f32_bf16 v8, v37, v45, v8
  v_dot2_f32_bf16 v8, v38, v46, v8
  v_dot2_f32_bf16 v8, v39, v47, v8
  s_waitcnt lgkmcnt(12)
  v_dot2_f32_bf16 v9, v32, v48, v9
  v_dot2_f32_bf16 v9, v33, v49, v9
  v_dot2_f32_bf16 v9, v34, v50, v9
  v_dot2_f32_bf16 v9, v35, v51, v9
  v_dot2_f32_bf16 v9, v36, v52, v9
  v_dot2_f32_bf16 v9, v37, v53, v9
  v_dot2_f32_bf16 v9, v38, v54, v9
  v_dot2_f32_bf16 v9, v39, v55, v9
  s_waitcnt lgkmcnt(10)
  v_dot2_f32_bf16 v10, v32, v56, v10
  v_dot2_f32_bf16 v10, v33, v57, v10
  v_dot2_f32_bf16 v10, v34, v58, v10
  v_dot2_f32_bf16 v10, v35, v59, v10
  v_dot2_f32_bf16 v10, v36, v60, v10
  v_dot2_f32_bf16 v10, v37, v61, v10
  v_dot2_f32_bf16 v10, v38, v62, v10
  v_dot2_f32_bf16 v10, v39, v63, v10
  s_waitcnt lgkmcnt(8)
  v_dot2_f32_bf16 v11, v32, v64, v11
  v_dot2_f32_bf16 v11, v33, v65, v11
  v_dot2_f32_bf16 v11, v34, v66, v11
  v_dot2_f32_bf16 v11, v35, v67, v11
  v_dot2_f32_bf16 v11, v36, v68, v11
  v_dot2_f32_bf16 v11, v37, v69, v11
  v_dot2_f32_bf16 v11, v38, v70, v11
  v_dot2_f32_bf16 v11, v39, v71, v11
  s_waitcnt lgkmcnt(6)
  v_dot2_f32_bf16 v12, v32, v72, v12
  v_dot2_f32_bf16 v12, v33, v73, v12
  v_dot2_f32_bf16 v12, v34, v74, v12
  v_dot2_f32_bf16 v12, v35, v75, v12
  v_dot2_f32_bf16 v12, v36, v76, v12
  v_dot2_f32_bf16 v12, v37, v77, v12
  v_dot2_f32_bf16 v12, v38, v78, v12
  v_dot2_f32_bf16 v12, v39, v79, v12
  s_waitcnt lgkmcnt(4)
  v_dot2_f32_bf16 v13, v32, v80, v13
  v_dot2_f32_bf16 v13, v33, v81, v13
  v_dot2_f32_bf16 v13, v34, v82, v13
  v_dot2_f32_bf16 v13, v35, v83, v13
  v_dot2_f32_bf16 v13, v36, v84, v13
  v_dot2_f32_bf16 v13, v37, v85, v13
  v_dot2_f32_bf16 v13, v38, v86, v13
  v_dot2_f32_bf16 v13, v39, v87, v13
  s_waitcnt lgkmcnt(2)
  v_dot2_f32_bf16 v14, v32, v88, v14
  v_dot2_f32_bf16 v14, v33, v89, v14
  v_dot2_f32_bf16 v14, v34, v90, v14
  v_dot2_f32_bf16 v14, v35, v91, v14
  v_dot2_f32_bf16 v14, v36, v92, v14
  v_dot2_f32_bf16 v14, v37, v93, v14
  v_dot2_f32_bf16 v14, v38, v94, v14
  v_dot2_f32_bf16 v14, v39, v95, v14
  s_waitcnt lgkmcnt(0)
  v_dot2_f32_bf16 v15, v32, v96, v15
  v_dot2_f32_bf16 v15, v33, v97, v15
  v_dot2_f32_bf16 v15, v34, v98, v15
  v_dot2_f32_bf16 v15, v35, v99, v15
  v_dot2_f32_bf16 v15, v36, v100, v15
  v_dot2_f32_bf16 v15, v37, v101, v15
  v_dot2_f32_bf16 v15, v38, v102, v15
  v_dot2_f32_bf16 v15, v39, v103, v15
  ds_read_b128 v[40:43], v4 offset:6464
  ds_read_b128 v[44:47], v4 offset:6480
  ds_read_b128 v[48:51], v4 offset:5664
  ds_read_b128 v[52:55], v4 offset:5680
  ds_read_b128 v[56:59], v4 offset:4864
  ds_read_b128 v[60:63], v4 offset:4880
  ds_read_b128 v[64:67], v4 offset:4064
  ds_read_b128 v[68:71], v4 offset:4080
  ds_read_b128 v[72:75], v4 offset:3264
  ds_read_b128 v[76:79], v4 offset:3280
  ds_read_b128 v[80:83], v4 offset:2464
  ds_read_b128 v[84:87], v4 offset:2480
  ds_read_b128 v[88:91], v4 offset:1664
  ds_read_b128 v[92:95], v4 offset:1680
  ds_read_b128 v[96:99], v4 offset:864
  ds_read_b128 v[100:103], v4 offset:880
  v_cvt_pk_bf16_f32 v8, v8, v8
  v_lshlrev_b32 v8, 16, v8
  v_mul_f32 v8, 0.25, v8
  v_cvt_pk_bf16_f32 v9, v9, v9
  v_lshlrev_b32 v9, 16, v9
  v_mul_f32 v9, 0.25, v9
  v_cmp_le_u32 vcc, 2, v5
  s_nop 1
  v_cndmask_b32 v9, v6, v9, vcc
  v_cvt_pk_bf16_f32 v10, v10, v10
  v_lshlrev_b32 v10, 16, v10
  v_mul_f32 v10, 0.25, v10
  v_cmp_le_u32 vcc, 4, v5
  s_nop 1
  v_cndmask_b32 v10, v6, v10, vcc
  v_cvt_pk_bf16_f32 v11, v11, v11
  v_lshlrev_b32 v11, 16, v11
  v_mul_f32 v11, 0.25, v11
  v_cmp_le_u32 vcc, 6, v5
  s_nop 1
  v_cndmask_b32 v11, v6, v11, vcc
  v_cvt_pk_bf16_f32 v12, v12, v12
  v_lshlrev_b32 v12, 16, v12
  v_mul_f32 v12, 0.25, v12
  v_cmp_le_u32 vcc, 8, v5
  s_nop 1
  v_cndmask_b32 v12, v6, v12, vcc
  v_cvt_pk_bf16_f32 v13, v13, v13
  v_lshlrev_b32 v13, 16, v13
  v_mul_f32 v13, 0.25, v13
  v_cmp_le_u32 vcc, 10, v5
  s_nop 1
  v_cndmask_b32 v13, v6, v13, vcc
  v_cvt_pk_bf16_f32 v14, v14, v14
  v_lshlrev_b32 v14, 16, v14
  v_mul_f32 v14, 0.25, v14
  v_cmp_le_u32 vcc, 12, v5
  s_nop 1
  v_cndmask_b32 v14, v6, v14, vcc
  v_cvt_pk_bf16_f32 v15, v15, v15
  v_lshlrev_b32 v15, 16, v15
  v_mul_f32 v15, 0.25, v15
  v_cmp_le_u32 vcc, 14, v5
  s_nop 1
  v_cndmask_b32 v15, v6, v15, vcc
  v_max3_f32 v7, v8, v9, v10
  v_max3_f32 v7, v7, v11, v12
  v_max3_f32 v7, v7, v13, v14
  v_max_f32 v7, v7, v15
  v_sub_f32 v8, v8, v7
  v_mul_f32 v8, 0x3fb8aa3b, v8
  v_exp_f32 v8, v8
  v_sub_f32 v9, v9, v7
  v_mul_f32 v9, 0x3fb8aa3b, v9
  v_exp_f32 v9, v9
  v_sub_f32 v10, v10, v7
  v_mul_f32 v10, 0x3fb8aa3b, v10
  v_exp_f32 v10, v10
  v_sub_f32 v11, v11, v7
  v_mul_f32 v11, 0x3fb8aa3b, v11
  v_exp_f32 v11, v11
  v_sub_f32 v12, v12, v7
  v_mul_f32 v12, 0x3fb8aa3b, v12
  v_exp_f32 v12, v12
  v_sub_f32 v13, v13, v7
  v_mul_f32 v13, 0x3fb8aa3b, v13
  v_exp_f32 v13, v13
  v_sub_f32 v14, v14, v7
  v_mul_f32 v14, 0x3fb8aa3b, v14
  v_exp_f32 v14, v14
  v_sub_f32 v15, v15, v7
  v_mul_f32 v15, 0x3fb8aa3b, v15
  v_exp_f32 v15, v15
  s_nop 0
  v_add_f32 v7, v8, v9
  v_add_f32 v7, v7, v10
  v_add_f32 v7, v7, v11
  v_add_f32 v7, v7, v12
  v_add_f32 v7, v7, v13
  v_add_f32 v7, v7, v14
  v_add_f32 v7, v7, v15
  v_rcp_f32 v7, v7
  s_nop 0
  v_mul_f32 v8, v8, v7
  v_mul_f32 v9, v9, v7
  v_mul_f32 v10, v10, v7
  v_mul_f32 v11, v11, v7
  v_mul_f32 v12, v12, v7
  v_mul_f32 v13, v13, v7
  v_mul_f32 v14, v14, v7
  v_mul_f32 v15, v15, v7
  v_cvt_pk_bf16_f32 v16, v8, v9
  v_cvt_pk_bf16_f32 v17, v10, v11
  v_cvt_pk_bf16_f32 v18, v12, v13
  v_cvt_pk_bf16_f32 v19, v14, v15
  s_mov_b32 s22, 0x05040100
  s_mov_b32 s23, 0x07060302
  v_mov_b32 v104, 0
  v_mov_b32 v105, 0
  v_mov_b32 v106, 0
  v_mov_b32 v107, 0
  v_mov_b32 v108, 0
  v_mov_b32 v109, 0
  v_mov_b32 v110, 0
  v_mov_b32 v111, 0
  v_mov_b32 v112, 0
  v_mov_b32 v113, 0
  v_mov_b32 v114, 0
  v_mov_b32 v115, 0
  v_mov_b32 v116, 0
  v_mov_b32 v117, 0
  v_mov_b32 v118, 0
  v_mov_b32 v119, 0
  s_waitcnt lgkmcnt(12)
  v_perm_b32 v20, v48, v40, s22
  v_perm_b32 v21, v48, v40, s23
  v_dot2_f32_bf16 v104, v20, v16, v104
  v_dot2_f32_bf16 v105, v21, v16, v105
  v_perm_b32 v22, v49, v41, s22
  v_perm_b32 v23, v49, v41, s23
  v_dot2_f32_bf16 v106, v22, v16, v106
  v_dot2_f32_bf16 v107, v23, v16, v107
  v_perm_b32 v20, v50, v42, s22
  v_perm_b32 v21, v50, v42, s23
  v_dot2_f32_bf16 v108, v20, v16, v108
  v_dot2_f32_bf16 v109, v21, v16, v109
  v_perm_b32 v22, v51, v43, s22
  v_perm_b32 v23, v51, v43, s23
  v_dot2_f32_bf16 v110, v22, v16, v110
  v_dot2_f32_bf16 v111, v23, v16, v111
  v_perm_b32 v20, v52, v44, s22
  v_perm_b32 v21, v52, v44, s23
  v_dot2_f32_bf16 v112, v20, v16, v112
  v_dot2_f32_bf16 v113, v21, v16, v113
  v_perm_b32 v22, v53, v45, s22
  v_perm_b32 v23, v53, v45, s23
  v_dot2_f32_bf16 v114, v22, v16, v114
  v_dot2_f32_bf16 v115, v23, v16, v115
  v_perm_b32 v20, v54, v46, s22
  v_perm_b32 v21, v54, v46, s23
  v_dot2_f32_bf16 v116, v20, v16, v116
  v_dot2_f32_bf16 v117, v21, v16, v117
  v_perm_b32 v22, v55, v47, s22
  v_perm_b32 v23, v55, v47, s23
  v_dot2_f32_bf16 v118, v22, v16, v118
  v_dot2_f32_bf16 v119, v23, v16, v119
  s_waitcnt lgkmcnt(8)
  v_perm_b32 v20, v64, v56, s22
  v_perm_b32 v21, v64, v56, s23
  v_dot2_f32_bf16 v104, v20, v17, v104
  v_dot2_f32_bf16 v105, v21, v17, v105
  v_perm_b32 v22, v65, v57, s22
  v_perm_b32 v23, v65, v57, s23
  v_dot2_f32_bf16 v106, v22, v17, v106
  v_dot2_f32_bf16 v107, v23, v17, v107
  v_perm_b32 v20, v66, v58, s22
  v_perm_b32 v21, v66, v58, s23
  v_dot2_f32_bf16 v108, v20, v17, v108
  v_dot2_f32_bf16 v109, v21, v17, v109
  v_perm_b32 v22, v67, v59, s22
  v_perm_b32 v23, v67, v59, s23
  v_dot2_f32_bf16 v110, v22, v17, v110
  v_dot2_f32_bf16 v111, v23, v17, v111
  v_perm_b32 v20, v68, v60, s22
  v_perm_b32 v21, v68, v60, s23
  v_dot2_f32_bf16 v112, v20, v17, v112
  v_dot2_f32_bf16 v113, v21, v17, v113
  v_perm_b32 v22, v69, v61, s22
  v_perm_b32 v23, v69, v61, s23
  v_dot2_f32_bf16 v114, v22, v17, v114
  v_dot2_f32_bf16 v115, v23, v17, v115
  v_perm_b32 v20, v70, v62, s22
  v_perm_b32 v21, v70, v62, s23
  v_dot2_f32_bf16 v116, v20, v17, v116
  v_dot2_f32_bf16 v117, v21, v17, v117
  v_perm_b32 v22, v71, v63, s22
  v_perm_b32 v23, v71, v63, s23
  v_dot2_f32_bf16 v118, v22, v17, v118
  v_dot2_f32_bf16 v119, v23, v17, v119
  s_waitcnt lgkmcnt(4)
  v_perm_b32 v20, v80, v72, s22
  v_perm_b32 v21, v80, v72, s23
  v_dot2_f32_bf16 v104, v20, v18, v104
  v_dot2_f32_bf16 v105, v21, v18, v105
  v_perm_b32 v22, v81, v73, s22
  v_perm_b32 v23, v81, v73, s23
  v_dot2_f32_bf16 v106, v22, v18, v106
  v_dot2_f32_bf16 v107, v23, v18, v107
  v_perm_b32 v20, v82, v74, s22
  v_perm_b32 v21, v82, v74, s23
  v_dot2_f32_bf16 v108, v20, v18, v108
  v_dot2_f32_bf16 v109, v21, v18, v109
  v_perm_b32 v22, v83, v75, s22
  v_perm_b32 v23, v83, v75, s23
  v_dot2_f32_bf16 v110, v22, v18, v110
  v_dot2_f32_bf16 v111, v23, v18, v111
  v_perm_b32 v20, v84, v76, s22
  v_perm_b32 v21, v84, v76, s23
  v_dot2_f32_bf16 v112, v20, v18, v112
  v_dot2_f32_bf16 v113, v21, v18, v113
  v_perm_b32 v22, v85, v77, s22
  v_perm_b32 v23, v85, v77, s23
  v_dot2_f32_bf16 v114, v22, v18, v114
  v_dot2_f32_bf16 v115, v23, v18, v115
  v_perm_b32 v20, v86, v78, s22
  v_perm_b32 v21, v86, v78, s23
  v_dot2_f32_bf16 v116, v20, v18, v116
  v_dot2_f32_bf16 v117, v21, v18, v117
  v_perm_b32 v22, v87, v79, s22
  v_perm_b32 v23, v87, v79, s23
  v_dot2_f32_bf16 v118, v22, v18, v118
  v_dot2_f32_bf16 v119, v23, v18, v119
  s_waitcnt lgkmcnt(0)
  v_perm_b32 v20, v96, v88, s22
  v_perm_b32 v21, v96, v88, s23
  v_dot2_f32_bf16 v104, v20, v19, v104
  v_dot2_f32_bf16 v105, v21, v19, v105
  v_perm_b32 v22, v97, v89, s22
  v_perm_b32 v23, v97, v89, s23
  v_dot2_f32_bf16 v106, v22, v19, v106
  v_dot2_f32_bf16 v107, v23, v19, v107
  v_perm_b32 v20, v98, v90, s22
  v_perm_b32 v21, v98, v90, s23
  v_dot2_f32_bf16 v108, v20, v19, v108
  v_dot2_f32_bf16 v109, v21, v19, v109
  v_perm_b32 v22, v99, v91, s22
  v_perm_b32 v23, v99, v91, s23
  v_dot2_f32_bf16 v110, v22, v19, v110
  v_dot2_f32_bf16 v111, v23, v19, v111
  v_perm_b32 v20, v100, v92, s22
  v_perm_b32 v21, v100, v92, s23
  v_dot2_f32_bf16 v112, v20, v19, v112
  v_dot2_f32_bf16 v113, v21, v19, v113
  v_perm_b32 v22, v101, v93, s22
  v_perm_b32 v23, v101, v93, s23
  v_dot2_f32_bf16 v114, v22, v19, v114
  v_dot2_f32_bf16 v115, v23, v19, v115
  v_perm_b32 v20, v102, v94, s22
  v_perm_b32 v21, v102, v94, s23
  v_dot2_f32_bf16 v116, v20, v19, v116
  v_dot2_f32_bf16 v117, v21, v19, v117
  v_perm_b32 v22, v103, v95, s22
  v_perm_b32 v23, v103, v95, s23
  v_dot2_f32_bf16 v118, v22, v19, v118
  v_dot2_f32_bf16 v119, v23, v19, v119
  s_nop 2
  v_cvt_pk_bf16_f32 v24, v104, v105
  v_cvt_pk_bf16_f32 v25, v106, v107
  v_cvt_pk_bf16_f32 v26, v108, v109
  v_cvt_pk_bf16_f32 v27, v110, v111
  v_cvt_pk_bf16_f32 v28, v112, v113
  v_cvt_pk_bf16_f32 v29, v114, v115
  v_cvt_pk_bf16_f32 v30, v116, v117
  v_cvt_pk_bf16_f32 v31, v118, v119
  s_lshl_b32 s22, s17, 2
  s_add_u32 s22, s22, s18
  s_lshl_b32 s22, s22, 5
  v_lshlrev_b32 v5, 10, v5
  v_add_u32 v5, s22, v5
  buffer_store_dwordx4 v[24:27], v5, s[12:15], 0 offen
  buffer_store_dwordx4 v[28:31], v5, s[12:15], 0 offen offset:16
  s_branch .Lend_k1b_kernel
.Lloader_k1b_kernel_1:
  s_sub_u32 s18, s18, 8
  s_mul_i32 s22, s18, 768
  s_mov_b32 s23, 43691
  s_lshl_b32 s21, s17, 7
  s_mov_b32 s24, 3072
  v_add_u32 v32, s22, v1
  v_mul_lo_u32 v33, v32, s23
  v_lshrrev_b32 v33, 20, v33
  v_mul_u32_u24 v34, 24, v33
  v_sub_u32 v34, v32, v34
  v_bfe_u32 v36, v33, 1, 1
  v_bfe_u32 v35, v33, 3, 1
  v_lshl_add_u32 v36, v35, 1, v36
  v_lshlrev_b32 v36, 1, v36
  v_xor_b32 v34, v34, v36
  v_lshrrev_b32 v35, 3, v34
  v_and_b32 v34, 7, v34
  v_lshlrev_b32 v34, 4, v34
  v_lshl_add_u32 v32, v35, 10, v34
  v_add_u32 v32, s21, v32
  v_mul_lo_u32 v33, v33, s24
  v_add_u32 v8, v33, v32
  v_add_u32 v32, s22, v1
  v_add_u32 v32, 64, v32
  v_mul_lo_u32 v33, v32, s23
  v_lshrrev_b32 v33, 20, v33
  v_mul_u32_u24 v34, 24, v33
  v_sub_u32 v34, v32, v34
  v_bfe_u32 v36, v33, 1, 1
  v_bfe_u32 v35, v33, 3, 1
  v_lshl_add_u32 v36, v35, 1, v36
  v_lshlrev_b32 v36, 1, v36
  v_xor_b32 v34, v34, v36
  v_lshrrev_b32 v35, 3, v34
  v_and_b32 v34, 7, v34
  v_lshlrev_b32 v34, 4, v34
  v_lshl_add_u32 v32, v35, 10, v34
  v_add_u32 v32, s21, v32
  v_mul_lo_u32 v33, v33, s24
  v_add_u32 v9, v33, v32
  v_add_u32 v32, s22, v1
  v_add_u32 v32, 128, v32
  v_mul_lo_u32 v33, v32, s23
  v_lshrrev_b32 v33, 20, v33
  v_mul_u32_u24 v34, 24, v33
  v_sub_u32 v34, v32, v34
  v_bfe_u32 v36, v33, 1, 1
  v_bfe_u32 v35, v33, 3, 1
  v_lshl_add_u32 v36, v35, 1, v36
  v_lshlrev_b32 v36, 1, v36
  v_xor_b32 v34, v34, v36
  v_lshrrev_b32 v35, 3, v34
  v_and_b32 v34, 7, v34
  v_lshlrev_b32 v34, 4, v34
  v_lshl_add_u32 v32, v35, 10, v34
  v_add_u32 v32, s21, v32
  v_mul_lo_u32 v33, v33, s24
  v_add_u32 v10, v33, v32
  v_add_u32 v32, s22, v1
  v_add_u32 v32, 192, v32
  v_mul_lo_u32 v33, v32, s23
  v_lshrrev_b32 v33, 20, v33
  v_mul_u32_u24 v34, 24, v33
  v_sub_u32 v34, v32, v34
  v_bfe_u32 v36, v33, 1, 1
  v_bfe_u32 v35, v33, 3, 1
  v_lshl_add_u32 v36, v35, 1, v36
  v_lshlrev_b32 v36, 1, v36
  v_xor_b32 v34, v34, v36
  v_lshrrev_b32 v35, 3, v34
  v_and_b32 v34, 7, v34
  v_lshlrev_b32 v34, 4, v34
  v_lshl_add_u32 v32, v35, 10, v34
  v_add_u32 v32, s21, v32
  v_mul_lo_u32 v33, v33, s24
  v_add_u32 v11, v33, v32
  v_add_u32 v32, s22, v1
  v_add_u32 v32, 256, v32
  v_mul_lo_u32 v33, v32, s23
  v_lshrrev_b32 v33, 20, v33
  v_mul_u32_u24 v34, 24, v33
  v_sub_u32 v34, v32, v34
  v_bfe_u32 v36, v33, 1, 1
  v_bfe_u32 v35, v33, 3, 1
  v_lshl_add_u32 v36, v35, 1, v36
  v_lshlrev_b32 v36, 1, v36
  v_xor_b32 v34, v34, v36
  v_lshrrev_b32 v35, 3, v34
  v_and_b32 v34, 7, v34
  v_lshlrev_b32 v34, 4, v34
  v_lshl_add_u32 v32, v35, 10, v34
  v_add_u32 v32, s21, v32
  v_mul_lo_u32 v33, v33, s24
  v_add_u32 v12, v33, v32
  v_add_u32 v32, s22, v1
  v_add_u32 v32, 320, v32
  v_mul_lo_u32 v33, v32, s23
  v_lshrrev_b32 v33, 20, v33
  v_mul_u32_u24 v34, 24, v33
  v_sub_u32 v34, v32, v34
  v_bfe_u32 v36, v33, 1, 1
  v_bfe_u32 v35, v33, 3, 1
  v_lshl_add_u32 v36, v35, 1, v36
  v_lshlrev_b32 v36, 1, v36
  v_xor_b32 v34, v34, v36
  v_lshrrev_b32 v35, 3, v34
  v_and_b32 v34, 7, v34
  v_lshlrev_b32 v34, 4, v34
  v_lshl_add_u32 v32, v35, 10, v34
  v_add_u32 v32, s21, v32
  v_mul_lo_u32 v33, v33, s24
  v_add_u32 v13, v33, v32
  v_add_u32 v32, s22, v1
  v_add_u32 v32, 384, v32
  v_mul_lo_u32 v33, v32, s23
  v_lshrrev_b32 v33, 20, v33
  v_mul_u32_u24 v34, 24, v33
  v_sub_u32 v34, v32, v34
  v_bfe_u32 v36, v33, 1, 1
  v_bfe_u32 v35, v33, 3, 1
  v_lshl_add_u32 v36, v35, 1, v36
  v_lshlrev_b32 v36, 1, v36
  v_xor_b32 v34, v34, v36
  v_lshrrev_b32 v35, 3, v34
  v_and_b32 v34, 7, v34
  v_lshlrev_b32 v34, 4, v34
  v_lshl_add_u32 v32, v35, 10, v34
  v_add_u32 v32, s21, v32
  v_mul_lo_u32 v33, v33, s24
  v_add_u32 v14, v33, v32
  v_add_u32 v32, s22, v1
  v_add_u32 v32, 448, v32
  v_mul_lo_u32 v33, v32, s23
  v_lshrrev_b32 v33, 20, v33
  v_mul_u32_u24 v34, 24, v33
  v_sub_u32 v34, v32, v34
  v_bfe_u32 v36, v33, 1, 1
  v_bfe_u32 v35, v33, 3, 1
  v_lshl_add_u32 v36, v35, 1, v36
  v_lshlrev_b32 v36, 1, v36
  v_xor_b32 v34, v34, v36
  v_lshrrev_b32 v35, 3, v34
  v_and_b32 v34, 7, v34
  v_lshlrev_b32 v34, 4, v34
  v_lshl_add_u32 v32, v35, 10, v34
  v_add_u32 v32, s21, v32
  v_mul_lo_u32 v33, v33, s24
  v_add_u32 v15, v33, v32
  v_add_u32 v32, s22, v1
  v_add_u32 v32, 512, v32
  v_mul_lo_u32 v33, v32, s23
  v_lshrrev_b32 v33, 20, v33
  v_mul_u32_u24 v34, 24, v33
  v_sub_u32 v34, v32, v34
  v_bfe_u32 v36, v33, 1, 1
  v_bfe_u32 v35, v33, 3, 1
  v_lshl_add_u32 v36, v35, 1, v36
  v_lshlrev_b32 v36, 1, v36
  v_xor_b32 v34, v34, v36
  v_lshrrev_b32 v35, 3, v34
  v_and_b32 v34, 7, v34
  v_lshlrev_b32 v34, 4, v34
  v_lshl_add_u32 v32, v35, 10, v34
  v_add_u32 v32, s21, v32
  v_mul_lo_u32 v33, v33, s24
  v_add_u32 v16, v33, v32
  v_add_u32 v32, s22, v1
  v_add_u32 v32, 576, v32
  v_mul_lo_u32 v33, v32, s23
  v_lshrrev_b32 v33, 20, v33
  v_mul_u32_u24 v34, 24, v33
  v_sub_u32 v34, v32, v34
  v_bfe_u32 v36, v33, 1, 1
  v_bfe_u32 v35, v33, 3, 1
  v_lshl_add_u32 v36, v35, 1, v36
  v_lshlrev_b32 v36, 1, v36
  v_xor_b32 v34, v34, v36
  v_lshrrev_b32 v35, 3, v34
  v_and_b32 v34, 7, v34
  v_lshlrev_b32 v34, 4, v34
  v_lshl_add_u32 v32, v35, 10, v34
  v_add_u32 v32, s21, v32
  v_mul_lo_u32 v33, v33, s24
  v_add_u32 v17, v33, v32
  v_add_u32 v32, s22, v1
  v_add_u32 v32, 640, v32
  v_mul_lo_u32 v33, v32, s23
  v_lshrrev_b32 v33, 20, v33
  v_mul_u32_u24 v34, 24, v33
  v_sub_u32 v34, v32, v34
  v_bfe_u32 v36, v33, 1, 1
  v_bfe_u32 v35, v33, 3, 1
  v_lshl_add_u32 v36, v35, 1, v36
  v_lshlrev_b32 v36, 1, v36
  v_xor_b32 v34, v34, v36
  v_lshrrev_b32 v35, 3, v34
  v_and_b32 v34, 7, v34
  v_lshlrev_b32 v34, 4, v34
  v_lshl_add_u32 v32, v35, 10, v34
  v_add_u32 v32, s21, v32
  v_mul_lo_u32 v33, v33, s24
  v_add_u32 v18, v33, v32
  v_add_u32 v32, s22, v1
  v_add_u32 v32, 704, v32
  v_mul_lo_u32 v33, v32, s23
  v_lshrrev_b32 v33, 20, v33
  v_mul_u32_u24 v34, 24, v33
  v_sub_u32 v34, v32, v34
  v_bfe_u32 v36, v33, 1, 1
  v_bfe_u32 v35, v33, 3, 1
  v_lshl_add_u32 v36, v35, 1, v36
  v_lshlrev_b32 v36, 1, v36
  v_xor_b32 v34, v34, v36
  v_lshrrev_b32 v35, 3, v34
  v_and_b32 v34, 7, v34
  v_lshlrev_b32 v34, 4, v34
  v_lshl_add_u32 v32, v35, 10, v34
  v_add_u32 v32, s21, v32
  v_mul_lo_u32 v33, v33, s24
  v_add_u32 v19, v33, v32
  s_mul_i32 s21, s18, 12288
  s_add_u32 s21, s21, 81920
  s_waitcnt lgkmcnt(0)
  s_mov_b32 s10, 0x180000
  s_mov_b32 s11, 0x00020000
  s_barrier
  s_mov_b32 s22, 0
  s_add_u32 m0, s21, 0
  s_nop 0
  buffer_load_dwordx4 v8, s[8:11], s22 offen lds
  s_add_u32 m0, s21, 1024
  s_nop 0
  buffer_load_dwordx4 v9, s[8:11], s22 offen lds
  s_add_u32 m0, s21, 2048
  s_nop 0
  buffer_load_dwordx4 v10, s[8:11], s22 offen lds
  s_add_u32 m0, s21, 3072
  s_nop 0
  buffer_load_dwordx4 v11, s[8:11], s22 offen lds
  s_add_u32 m0, s21, 4096
  s_nop 0
  buffer_load_dwordx4 v12, s[8:11], s22 offen lds
  s_add_u32 m0, s21, 5120
  s_nop 0
  buffer_load_dwordx4 v13, s[8:11], s22 offen lds
  s_add_u32 m0, s21, 6144
  s_nop 0
  buffer_load_dwordx4 v14, s[8:11], s22 offen lds
  s_add_u32 m0, s21, 7168
  s_nop 0
  buffer_load_dwordx4 v15, s[8:11], s22 offen lds
  s_add_u32 m0, s21, 8192
  s_nop 0
  buffer_load_dwordx4 v16, s[8:11], s22 offen lds
  s_add_u32 m0, s21, 9216
  s_nop 0
  buffer_load_dwordx4 v17, s[8:11], s22 offen lds
  s_add_u32 m0, s21, 10240
  s_nop 0
  buffer_load_dwordx4 v18, s[8:11], s22 offen lds
  s_add_u32 m0, s21, 11264
  s_nop 0
  buffer_load_dwordx4 v19, s[8:11], s22 offen lds
  s_mov_b32 s22, 196608
  s_add_u32 m0, s21, 24576
  s_nop 0
  buffer_load_dwordx4 v8, s[8:11], s22 offen lds
  s_add_u32 m0, s21, 25600
  s_nop 0
  buffer_load_dwordx4 v9, s[8:11], s22 offen lds
  s_add_u32 m0, s21, 26624
  s_nop 0
  buffer_load_dwordx4 v10, s[8:11], s22 offen lds
  s_add_u32 m0, s21, 27648
  s_nop 0
  buffer_load_dwordx4 v11, s[8:11], s22 offen lds
  s_add_u32 m0, s21, 28672
  s_nop 0
  buffer_load_dwordx4 v12, s[8:11], s22 offen lds
  s_add_u32 m0, s21, 29696
  s_nop 0
  buffer_load_dwordx4 v13, s[8:11], s22 offen lds
  s_add_u32 m0, s21, 30720
  s_nop 0
  buffer_load_dwordx4 v14, s[8:11], s22 offen lds
  s_add_u32 m0, s21, 31744
  s_nop 0
  buffer_load_dwordx4 v15, s[8:11], s22 offen lds
  s_add_u32 m0, s21, 32768
  s_nop 0
  buffer_load_dwordx4 v16, s[8:11], s22 offen lds
  s_add_u32 m0, s21, 33792
  s_nop 0
  buffer_load_dwordx4 v17, s[8:11], s22 offen lds
  s_add_u32 m0, s21, 34816
  s_nop 0
  buffer_load_dwordx4 v18, s[8:11], s22 offen lds
  s_add_u32 m0, s21, 35840
  s_nop 0
  buffer_load_dwordx4 v19, s[8:11], s22 offen lds
  s_mov_b32 s22, 393216
  s_add_u32 m0, s21, 49152
  s_nop 0
  buffer_load_dwordx4 v8, s[8:11], s22 offen lds
  s_add_u32 m0, s21, 50176
  s_nop 0
  buffer_load_dwordx4 v9, s[8:11], s22 offen lds
  s_add_u32 m0, s21, 51200
  s_nop 0
  buffer_load_dwordx4 v10, s[8:11], s22 offen lds
  s_add_u32 m0, s21, 52224
  s_nop 0
  buffer_load_dwordx4 v11, s[8:11], s22 offen lds
  s_add_u32 m0, s21, 53248
  s_nop 0
  buffer_load_dwordx4 v12, s[8:11], s22 offen lds
  s_add_u32 m0, s21, 54272
  s_nop 0
  buffer_load_dwordx4 v13, s[8:11], s22 offen lds
  s_add_u32 m0, s21, 55296
  s_nop 0
  buffer_load_dwordx4 v14, s[8:11], s22 offen lds
  s_add_u32 m0, s21, 56320
  s_nop 0
  buffer_load_dwordx4 v15, s[8:11], s22 offen lds
  s_add_u32 m0, s21, 57344
  s_nop 0
  buffer_load_dwordx4 v16, s[8:11], s22 offen lds
  s_add_u32 m0, s21, 58368
  s_nop 0
  buffer_load_dwordx4 v17, s[8:11], s22 offen lds
  s_add_u32 m0, s21, 59392
  s_nop 0
  buffer_load_dwordx4 v18, s[8:11], s22 offen lds
  s_add_u32 m0, s21, 60416
  s_nop 0
  buffer_load_dwordx4 v19, s[8:11], s22 offen lds
  s_waitcnt vmcnt(24)
  s_barrier
  s_waitcnt vmcnt(12)
  s_barrier
  s_mov_b32 s22, 589824
  s_add_u32 m0, s21, 0
  s_nop 0
  buffer_load_dwordx4 v8, s[8:11], s22 offen lds
  s_add_u32 m0, s21, 1024
  s_nop 0
  buffer_load_dwordx4 v9, s[8:11], s22 offen lds
  s_add_u32 m0, s21, 2048
  s_nop 0
  buffer_load_dwordx4 v10, s[8:11], s22 offen lds
  s_add_u32 m0, s21, 3072
  s_nop 0
  buffer_load_dwordx4 v11, s[8:11], s22 offen lds
  s_add_u32 m0, s21, 4096
  s_nop 0
  buffer_load_dwordx4 v12, s[8:11], s22 offen lds
  s_add_u32 m0, s21, 5120
  s_nop 0
  buffer_load_dwordx4 v13, s[8:11], s22 offen lds
  s_add_u32 m0, s21, 6144
  s_nop 0
  buffer_load_dwordx4 v14, s[8:11], s22 offen lds
  s_add_u32 m0, s21, 7168
  s_nop 0
  buffer_load_dwordx4 v15, s[8:11], s22 offen lds
  s_add_u32 m0, s21, 8192
  s_nop 0
  buffer_load_dwordx4 v16, s[8:11], s22 offen lds
  s_add_u32 m0, s21, 9216
  s_nop 0
  buffer_load_dwordx4 v17, s[8:11], s22 offen lds
  s_add_u32 m0, s21, 10240
  s_nop 0
  buffer_load_dwordx4 v18, s[8:11], s22 offen lds
  s_add_u32 m0, s21, 11264
  s_nop 0
  buffer_load_dwordx4 v19, s[8:11], s22 offen lds
  s_waitcnt vmcnt(12)
  s_barrier
  s_mov_b32 s22, 786432
  s_add_u32 m0, s21, 24576
  s_nop 0
  buffer_load_dwordx4 v8, s[8:11], s22 offen lds
  s_add_u32 m0, s21, 25600
  s_nop 0
  buffer_load_dwordx4 v9, s[8:11], s22 offen lds
  s_add_u32 m0, s21, 26624
  s_nop 0
  buffer_load_dwordx4 v10, s[8:11], s22 offen lds
  s_add_u32 m0, s21, 27648
  s_nop 0
  buffer_load_dwordx4 v11, s[8:11], s22 offen lds
  s_add_u32 m0, s21, 28672
  s_nop 0
  buffer_load_dwordx4 v12, s[8:11], s22 offen lds
  s_add_u32 m0, s21, 29696
  s_nop 0
  buffer_load_dwordx4 v13, s[8:11], s22 offen lds
  s_add_u32 m0, s21, 30720
  s_nop 0
  buffer_load_dwordx4 v14, s[8:11], s22 offen lds
  s_add_u32 m0, s21, 31744
  s_nop 0
  buffer_load_dwordx4 v15, s[8:11], s22 offen lds
  s_add_u32 m0, s21, 32768
  s_nop 0
  buffer_load_dwordx4 v16, s[8:11], s22 offen lds
  s_add_u32 m0, s21, 33792
  s_nop 0
  buffer_load_dwordx4 v17, s[8:11], s22 offen lds
  s_add_u32 m0, s21, 34816
  s_nop 0
  buffer_load_dwordx4 v18, s[8:11], s22 offen lds
  s_add_u32 m0, s21, 35840
  s_nop 0
  buffer_load_dwordx4 v19, s[8:11], s22 offen lds
  s_waitcnt vmcnt(12)
  s_barrier
  s_mov_b32 s22, 983040
  s_add_u32 m0, s21, 49152
  s_nop 0
  buffer_load_dwordx4 v8, s[8:11], s22 offen lds
  s_add_u32 m0, s21, 50176
  s_nop 0
  buffer_load_dwordx4 v9, s[8:11], s22 offen lds
  s_add_u32 m0, s21, 51200
  s_nop 0
  buffer_load_dwordx4 v10, s[8:11], s22 offen lds
  s_add_u32 m0, s21, 52224
  s_nop 0
  buffer_load_dwordx4 v11, s[8:11], s22 offen lds
  s_add_u32 m0, s21, 53248
  s_nop 0
  buffer_load_dwordx4 v12, s[8:11], s22 offen lds
  s_add_u32 m0, s21, 54272
  s_nop 0
  buffer_load_dwordx4 v13, s[8:11], s22 offen lds
  s_add_u32 m0, s21, 55296
  s_nop 0
  buffer_load_dwordx4 v14, s[8:11], s22 offen lds
  s_add_u32 m0, s21, 56320
  s_nop 0
  buffer_load_dwordx4 v15, s[8:11], s22 offen lds
  s_add_u32 m0, s21, 57344
  s_nop 0
  buffer_load_dwordx4 v16, s[8:11], s22 offen lds
  s_add_u32 m0, s21, 58368
  s_nop 0
  buffer_load_dwordx4 v17, s[8:11], s22 offen lds
  s_add_u32 m0, s21, 59392
  s_nop 0
  buffer_load_dwordx4 v18, s[8:11], s22 offen lds
  s_add_u32 m0, s21, 60416
  s_nop 0
  buffer_load_dwordx4 v19, s[8:11], s22 offen lds
  s_waitcnt vmcnt(12)
  s_barrier
  s_mov_b32 s22, 1179648
  s_add_u32 m0, s21, 0
  s_nop 0
  buffer_load_dwordx4 v8, s[8:11], s22 offen lds
  s_add_u32 m0, s21, 1024
  s_nop 0
  buffer_load_dwordx4 v9, s[8:11], s22 offen lds
  s_add_u32 m0, s21, 2048
  s_nop 0
  buffer_load_dwordx4 v10, s[8:11], s22 offen lds
  s_add_u32 m0, s21, 3072
  s_nop 0
  buffer_load_dwordx4 v11, s[8:11], s22 offen lds
  s_add_u32 m0, s21, 4096
  s_nop 0
  buffer_load_dwordx4 v12, s[8:11], s22 offen lds
  s_add_u32 m0, s21, 5120
  s_nop 0
  buffer_load_dwordx4 v13, s[8:11], s22 offen lds
  s_add_u32 m0, s21, 6144
  s_nop 0
  buffer_load_dwordx4 v14, s[8:11], s22 offen lds
  s_add_u32 m0, s21, 7168
  s_nop 0
  buffer_load_dwordx4 v15, s[8:11], s22 offen lds
  s_add_u32 m0, s21, 8192
  s_nop 0
  buffer_load_dwordx4 v16, s[8:11], s22 offen lds
  s_add_u32 m0, s21, 9216
  s_nop 0
  buffer_load_dwordx4 v17, s[8:11], s22 offen lds
  s_add_u32 m0, s21, 10240
  s_nop 0
  buffer_load_dwordx4 v18, s[8:11], s22 offen lds
  s_add_u32 m0, s21, 11264
  s_nop 0
  buffer_load_dwordx4 v19, s[8:11], s22 offen lds
  s_waitcnt vmcnt(12)
  s_barrier
  s_mov_b32 s22, 1376256
  s_add_u32 m0, s21, 24576
  s_nop 0
  buffer_load_dwordx4 v8, s[8:11], s22 offen lds
  s_add_u32 m0, s21, 25600
  s_nop 0
  buffer_load_dwordx4 v9, s[8:11], s22 offen lds
  s_add_u32 m0, s21, 26624
  s_nop 0
  buffer_load_dwordx4 v10, s[8:11], s22 offen lds
  s_add_u32 m0, s21, 27648
  s_nop 0
  buffer_load_dwordx4 v11, s[8:11], s22 offen lds
  s_add_u32 m0, s21, 28672
  s_nop 0
  buffer_load_dwordx4 v12, s[8:11], s22 offen lds
  s_add_u32 m0, s21, 29696
  s_nop 0
  buffer_load_dwordx4 v13, s[8:11], s22 offen lds
  s_add_u32 m0, s21, 30720
  s_nop 0
  buffer_load_dwordx4 v14, s[8:11], s22 offen lds
  s_add_u32 m0, s21, 31744
  s_nop 0
  buffer_load_dwordx4 v15, s[8:11], s22 offen lds
  s_add_u32 m0, s21, 32768
  s_nop 0
  buffer_load_dwordx4 v16, s[8:11], s22 offen lds
  s_add_u32 m0, s21, 33792
  s_nop 0
  buffer_load_dwordx4 v17, s[8:11], s22 offen lds
  s_add_u32 m0, s21, 34816
  s_nop 0
  buffer_load_dwordx4 v18, s[8:11], s22 offen lds
  s_add_u32 m0, s21, 35840
  s_nop 0
  buffer_load_dwordx4 v19, s[8:11], s22 offen lds
  s_waitcnt vmcnt(12)
  s_barrier
  s_waitcnt vmcnt(0)
  s_barrier
.Lend_k1b_kernel:
  s_endpgm

.globl k2a_kernel
.p2align 8
.type k2a_kernel,@function
k2a_kernel:
  s_cmp_ge_u32 s2, 256
  s_cbranch_scc1 .Lend_k2a_kernel
  s_load_dwordx2 s[4:5], s[0:1], 80
  s_load_dwordx2 s[8:9], s[0:1], 16
  s_load_dwordx2 s[12:13], s[0:1], 80
  s_load_dwordx2 s[16:17], s[0:1], 0
  s_and_b32 s24, s2, 7
  s_lshl_b32 s24, s24, 2
  s_lshr_b32 s25, s2, 3
  s_and_b32 s25, s25, 3
  s_add_u32 s24, s24, s25
  s_lshr_b32 s25, s2, 5
  v_and_b32 v1, 63, v0
  v_lshrrev_b32 v4, 6, v0
  v_and_b32 v2, 15, v0
  v_readfirstlane_b32 s26, v4
  v_bfe_u32 v3, v0, 4, 2
  s_lshl_b32 s33, s25, 2
  s_cmp_ge_u32 s26, 4
  s_cbranch_scc1 .Lloader_k2a_kernel_1
  s_and_b32 s27, s26, 1
  s_lshr_b32 s28, s26, 1
  s_lshl_b32 s31, s24, 6
  s_lshl_b32 s32, s27, 5
  s_add_u32 s31, s31, s32
  v_add_u32 v4, s31, v2
  s_mul_i32 s34, s28, 2
  s_add_u32 s34, s34, s33
  s_lshl_b32 s34, s34, 5
  s_mov_b32 s32, 1024
  v_mul_lo_u32 v16, v4, s32
  v_lshl_add_u32 v16, v3, 3, v16
  v_add_u32 v16, s34, v16
  s_mov_b32 s32, 1024
  v_mul_lo_u32 v17, v4, s32
  v_lshl_add_u32 v17, v3, 3, v17
  v_add_u32 v17, s34, v17
  v_lshlrev_b32 v18, 1, v4
  s_mov_b32 s35, 16384
  s_mov_b32 s36, 16384
  s_lshl_b32 s31, s27, 12
  v_lshrrev_b32 v4, 1, v2
  v_xor_b32 v5, v3, v4
  v_and_b32 v5, 3, v5
  v_and_b32 v4, 4, v4
  v_xor_b32 v6, 0, v4
  v_or_b32 v6, v6, v5
  v_lshlrev_b32 v6, 4, v6
  v_lshl_add_u32 v6, v2, 7, v6
  v_add_u32 v20, s31, v6
  v_xor_b32 v6, 4, v4
  v_or_b32 v6, v6, v5
  v_lshlrev_b32 v6, 4, v6
  v_lshl_add_u32 v6, v2, 7, v6
  v_add_u32 v21, s31, v6
  v_lshrrev_b32 v4, 2, v2
  v_lshl_add_u32 v4, v3, 3, v4
  v_mul_u32_u24 v4, 128, v4
  v_and_b32 v5, 3, v2
  v_lshl_add_u32 v4, v5, 3, v4
  v_add_u32 v4, 0x2000, v4
  v_and_b32 v6, 1, v3
  s_mul_i32 s31, s28, 2
  v_bfe_u32 v5, v2, 3, 1
  v_lshl_add_u32 v5, v6, 1, v5
  s_add_u32 s32, s31, 0
  v_xor_b32 v7, s32, v5
  v_lshl_add_u32 v22, v7, 5, v4
  s_add_u32 s32, s31, 1
  v_xor_b32 v7, s32, v5
  v_lshl_add_u32 v23, v7, 5, v4
  v_mov_b32 v128, 0
  v_mov_b32 v129, 0
  v_mov_b32 v130, 0
  v_mov_b32 v131, 0
  v_mov_b32 v132, 0
  v_mov_b32 v133, 0
  v_mov_b32 v134, 0
  v_mov_b32 v135, 0
  v_mov_b32 v136, 0
  v_mov_b32 v137, 0
  v_mov_b32 v138, 0
  v_mov_b32 v139, 0
  v_mov_b32 v140, 0
  v_mov_b32 v141, 0
  v_mov_b32 v142, 0
  v_mov_b32 v143, 0
  s_waitcnt lgkmcnt(0)
  s_add_u32 s12, s12, 0x200000
  s_addc_u32 s13, s13, 0
  s_mov_b32 s14, 0x200000
  s_mov_b32 s15, 0x00020000
  s_mov_b32 s18, 0x200000
  s_mov_b32 s19, 0x00020000
  s_barrier
  ds_read_b128 v[64:67], v20 offset:0
  ds_read_b128 v[68:71], v20 offset:2048
  ds_read_b64_tr_b16 v[80:81], v22 offset:0
  ds_read_b64_tr_b16 v[82:83], v22 offset:512
  ds_read_b64_tr_b16 v[84:85], v23 offset:0
  ds_read_b64_tr_b16 v[86:87], v23 offset:512
  ds_read_b128 v[72:75], v21 offset:0
  ds_read_b128 v[76:79], v21 offset:2048
  ds_read_b64_tr_b16 v[88:89], v22 offset:4096
  ds_read_b64_tr_b16 v[90:91], v22 offset:4608
  ds_read_b64_tr_b16 v[92:93], v23 offset:4096
  ds_read_b64_tr_b16 v[94:95], v23 offset:4608
  s_waitcnt lgkmcnt(0)
  s_barrier
  v_add_u32 v26, 0x4000, v20
  v_add_u32 v27, 0x4000, v21
  v_add_u32 v28, 0x4000, v22
  v_add_u32 v29, 0x4000, v23
  v_mfma_f32_16x16x32_bf16 v[128:131], v[80:83], v[64:67], v[128:131]
  ds_read_b128 v[96:99], v26 offset:0
  ds_read_b128 v[100:103], v26 offset:2048
  v_mfma_f32_16x16x32_bf16 v[136:139], v[80:83], v[68:71], v[136:139]
  ds_read_b64_tr_b16 v[112:113], v28 offset:0
  ds_read_b64_tr_b16 v[114:115], v28 offset:512
  v_mfma_f32_16x16x32_bf16 v[132:135], v[84:87], v[64:67], v[132:135]
  ds_read_b64_tr_b16 v[116:117], v29 offset:0
  ds_read_b64_tr_b16 v[118:119], v29 offset:512
  v_mfma_f32_16x16x32_bf16 v[140:143], v[84:87], v[68:71], v[140:143]
  ds_read_b128 v[104:107], v27 offset:0
  ds_read_b128 v[108:111], v27 offset:2048
  v_mfma_f32_16x16x32_bf16 v[128:131], v[88:91], v[72:75], v[128:131]
  ds_read_b64_tr_b16 v[120:121], v28 offset:4096
  ds_read_b64_tr_b16 v[122:123], v28 offset:4608
  v_mfma_f32_16x16x32_bf16 v[136:139], v[88:91], v[76:79], v[136:139]
  ds_read_b64_tr_b16 v[124:125], v29 offset:4096
  ds_read_b64_tr_b16 v[126:127], v29 offset:4608
  v_mfma_f32_16x16x32_bf16 v[132:135], v[92:95], v[72:75], v[132:135]
  v_mfma_f32_16x16x32_bf16 v[140:143], v[92:95], v[76:79], v[140:143]
  s_waitcnt lgkmcnt(0)
  s_barrier
  v_add_u32 v26, 0x8000, v20
  v_add_u32 v27, 0x8000, v21
  v_add_u32 v28, 0x8000, v22
  v_add_u32 v29, 0x8000, v23
  v_mfma_f32_16x16x32_bf16 v[128:131], v[112:115], v[96:99], v[128:131]
  ds_read_b128 v[64:67], v26 offset:0
  ds_read_b128 v[68:71], v26 offset:2048
  v_mfma_f32_16x16x32_bf16 v[136:139], v[112:115], v[100:103], v[136:139]
  ds_read_b64_tr_b16 v[80:81], v28 offset:0
  ds_read_b64_tr_b16 v[82:83], v28 offset:512
  v_mfma_f32_16x16x32_bf16 v[132:135], v[116:119], v[96:99], v[132:135]
  ds_read_b64_tr_b16 v[84:85], v29 offset:0
  ds_read_b64_tr_b16 v[86:87], v29 offset:512
  v_mfma_f32_16x16x32_bf16 v[140:143], v[116:119], v[100:103], v[140:143]
  ds_read_b128 v[72:75], v27 offset:0
  ds_read_b128 v[76:79], v27 offset:2048
  v_mfma_f32_16x16x32_bf16 v[128:131], v[120:123], v[104:107], v[128:131]
  ds_read_b64_tr_b16 v[88:89], v28 offset:4096
  ds_read_b64_tr_b16 v[90:91], v28 offset:4608
  v_mfma_f32_16x16x32_bf16 v[136:139], v[120:123], v[108:111], v[136:139]
  ds_read_b64_tr_b16 v[92:93], v29 offset:4096
  ds_read_b64_tr_b16 v[94:95], v29 offset:4608
  v_mfma_f32_16x16x32_bf16 v[132:135], v[124:127], v[104:107], v[132:135]
  v_mfma_f32_16x16x32_bf16 v[140:143], v[124:127], v[108:111], v[140:143]
  s_waitcnt lgkmcnt(0)
  s_barrier
  v_add_u32 v26, 0xc000, v20
  v_add_u32 v27, 0xc000, v21
  v_add_u32 v28, 0xc000, v22
  v_add_u32 v29, 0xc000, v23
  v_mfma_f32_16x16x32_bf16 v[128:131], v[80:83], v[64:67], v[128:131]
  ds_read_b128 v[96:99], v26 offset:0
  ds_read_b128 v[100:103], v26 offset:2048
  v_mfma_f32_16x16x32_bf16 v[136:139], v[80:83], v[68:71], v[136:139]
  ds_read_b64_tr_b16 v[112:113], v28 offset:0
  ds_read_b64_tr_b16 v[114:115], v28 offset:512
  v_mfma_f32_16x16x32_bf16 v[132:135], v[84:87], v[64:67], v[132:135]
  ds_read_b64_tr_b16 v[116:117], v29 offset:0
  ds_read_b64_tr_b16 v[118:119], v29 offset:512
  v_mfma_f32_16x16x32_bf16 v[140:143], v[84:87], v[68:71], v[140:143]
  ds_read_b128 v[104:107], v27 offset:0
  ds_read_b128 v[108:111], v27 offset:2048
  v_mfma_f32_16x16x32_bf16 v[128:131], v[88:91], v[72:75], v[128:131]
  ds_read_b64_tr_b16 v[120:121], v28 offset:4096
  ds_read_b64_tr_b16 v[122:123], v28 offset:4608
  v_mfma_f32_16x16x32_bf16 v[136:139], v[88:91], v[76:79], v[136:139]
  ds_read_b64_tr_b16 v[124:125], v29 offset:4096
  ds_read_b64_tr_b16 v[126:127], v29 offset:4608
  v_mfma_f32_16x16x32_bf16 v[132:135], v[92:95], v[72:75], v[132:135]
  v_mfma_f32_16x16x32_bf16 v[140:143], v[92:95], v[76:79], v[140:143]
  s_waitcnt lgkmcnt(0)
  s_barrier
  v_add_u32 v26, 0x10000, v20
  v_add_u32 v27, 0x10000, v21
  v_add_u32 v28, 0x10000, v22
  v_add_u32 v29, 0x10000, v23
  v_mfma_f32_16x16x32_bf16 v[128:131], v[112:115], v[96:99], v[128:131]
  ds_read_b128 v[64:67], v26 offset:0
  ds_read_b128 v[68:71], v26 offset:2048
  v_mfma_f32_16x16x32_bf16 v[136:139], v[112:115], v[100:103], v[136:139]
  ds_read_b64_tr_b16 v[80:81], v28 offset:0
  ds_read_b64_tr_b16 v[82:83], v28 offset:512
  v_mfma_f32_16x16x32_bf16 v[132:135], v[116:119], v[96:99], v[132:135]
  ds_read_b64_tr_b16 v[84:85], v29 offset:0
  ds_read_b64_tr_b16 v[86:87], v29 offset:512
  v_mfma_f32_16x16x32_bf16 v[140:143], v[116:119], v[100:103], v[140:143]
  ds_read_b128 v[72:75], v27 offset:0
  ds_read_b128 v[76:79], v27 offset:2048
  v_mfma_f32_16x16x32_bf16 v[128:131], v[120:123], v[104:107], v[128:131]
  ds_read_b64_tr_b16 v[88:89], v28 offset:4096
  ds_read_b64_tr_b16 v[90:91], v28 offset:4608
  v_mfma_f32_16x16x32_bf16 v[136:139], v[120:123], v[108:111], v[136:139]
  ds_read_b64_tr_b16 v[92:93], v29 offset:4096
  ds_read_b64_tr_b16 v[94:95], v29 offset:4608
  v_mfma_f32_16x16x32_bf16 v[132:135], v[124:127], v[104:107], v[132:135]
  v_mfma_f32_16x16x32_bf16 v[140:143], v[124:127], v[108:111], v[140:143]
  buffer_load_dwordx2 v[32:33], v17, s[16:19], 0 offen offset:0
  buffer_load_dwordx2 v[34:35], v17, s[16:19], 0 offen offset:32
  buffer_load_dwordx2 v[36:37], v17, s[16:19], s35 offen offset:0
  buffer_load_dwordx2 v[38:39], v17, s[16:19], s35 offen offset:32
  s_waitcnt lgkmcnt(0)
  s_barrier
  v_add_u32 v26, 0x14000, v20
  v_add_u32 v27, 0x14000, v21
  v_add_u32 v28, 0x14000, v22
  v_add_u32 v29, 0x14000, v23
  v_mfma_f32_16x16x32_bf16 v[128:131], v[80:83], v[64:67], v[128:131]
  ds_read_b128 v[96:99], v26 offset:0
  ds_read_b128 v[100:103], v26 offset:2048
  v_mfma_f32_16x16x32_bf16 v[136:139], v[80:83], v[68:71], v[136:139]
  ds_read_b64_tr_b16 v[112:113], v28 offset:0
  ds_read_b64_tr_b16 v[114:115], v28 offset:512
  v_mfma_f32_16x16x32_bf16 v[132:135], v[84:87], v[64:67], v[132:135]
  ds_read_b64_tr_b16 v[116:117], v29 offset:0
  ds_read_b64_tr_b16 v[118:119], v29 offset:512
  v_mfma_f32_16x16x32_bf16 v[140:143], v[84:87], v[68:71], v[140:143]
  ds_read_b128 v[104:107], v27 offset:0
  ds_read_b128 v[108:111], v27 offset:2048
  v_mfma_f32_16x16x32_bf16 v[128:131], v[88:91], v[72:75], v[128:131]
  ds_read_b64_tr_b16 v[120:121], v28 offset:4096
  ds_read_b64_tr_b16 v[122:123], v28 offset:4608
  v_mfma_f32_16x16x32_bf16 v[136:139], v[88:91], v[76:79], v[136:139]
  ds_read_b64_tr_b16 v[124:125], v29 offset:4096
  ds_read_b64_tr_b16 v[126:127], v29 offset:4608
  v_mfma_f32_16x16x32_bf16 v[132:135], v[92:95], v[72:75], v[132:135]
  v_mfma_f32_16x16x32_bf16 v[140:143], v[92:95], v[76:79], v[140:143]
  s_waitcnt lgkmcnt(0)
  s_barrier
  v_add_u32 v26, 0x18000, v20
  v_add_u32 v27, 0x18000, v21
  v_add_u32 v28, 0x18000, v22
  v_add_u32 v29, 0x18000, v23
  v_mfma_f32_16x16x32_bf16 v[128:131], v[112:115], v[96:99], v[128:131]
  ds_read_b128 v[64:67], v26 offset:0
  ds_read_b128 v[68:71], v26 offset:2048
  v_mfma_f32_16x16x32_bf16 v[136:139], v[112:115], v[100:103], v[136:139]
  ds_read_b64_tr_b16 v[80:81], v28 offset:0
  ds_read_b64_tr_b16 v[82:83], v28 offset:512
  v_mfma_f32_16x16x32_bf16 v[132:135], v[116:119], v[96:99], v[132:135]
  ds_read_b64_tr_b16 v[84:85], v29 offset:0
  ds_read_b64_tr_b16 v[86:87], v29 offset:512
  v_mfma_f32_16x16x32_bf16 v[140:143], v[116:119], v[100:103], v[140:143]
  ds_read_b128 v[72:75], v27 offset:0
  ds_read_b128 v[76:79], v27 offset:2048
  v_mfma_f32_16x16x32_bf16 v[128:131], v[120:123], v[104:107], v[128:131]
  ds_read_b64_tr_b16 v[88:89], v28 offset:4096
  ds_read_b64_tr_b16 v[90:91], v28 offset:4608
  v_mfma_f32_16x16x32_bf16 v[136:139], v[120:123], v[108:111], v[136:139]
  ds_read_b64_tr_b16 v[92:93], v29 offset:4096
  ds_read_b64_tr_b16 v[94:95], v29 offset:4608
  v_mfma_f32_16x16x32_bf16 v[132:135], v[124:127], v[104:107], v[132:135]
  v_mfma_f32_16x16x32_bf16 v[140:143], v[124:127], v[108:111], v[140:143]
  s_waitcnt lgkmcnt(0)
  s_barrier
  v_add_u32 v26, 0x1c000, v20
  v_add_u32 v27, 0x1c000, v21
  v_add_u32 v28, 0x1c000, v22
  v_add_u32 v29, 0x1c000, v23
  v_mfma_f32_16x16x32_bf16 v[128:131], v[80:83], v[64:67], v[128:131]
  ds_read_b128 v[96:99], v26 offset:0
  ds_read_b128 v[100:103], v26 offset:2048
  v_mfma_f32_16x16x32_bf16 v[136:139], v[80:83], v[68:71], v[136:139]
  ds_read_b64_tr_b16 v[112:113], v28 offset:0
  ds_read_b64_tr_b16 v[114:115], v28 offset:512
  v_mfma_f32_16x16x32_bf16 v[132:135], v[84:87], v[64:67], v[132:135]
  ds_read_b64_tr_b16 v[116:117], v29 offset:0
  ds_read_b64_tr_b16 v[118:119], v29 offset:512
  v_mfma_f32_16x16x32_bf16 v[140:143], v[84:87], v[68:71], v[140:143]
  ds_read_b128 v[104:107], v27 offset:0
  ds_read_b128 v[108:111], v27 offset:2048
  v_mfma_f32_16x16x32_bf16 v[128:131], v[88:91], v[72:75], v[128:131]
  ds_read_b64_tr_b16 v[120:121], v28 offset:4096
  ds_read_b64_tr_b16 v[122:123], v28 offset:4608
  v_mfma_f32_16x16x32_bf16 v[136:139], v[88:91], v[76:79], v[136:139]
  ds_read_b64_tr_b16 v[124:125], v29 offset:4096
  ds_read_b64_tr_b16 v[126:127], v29 offset:4608
  v_mfma_f32_16x16x32_bf16 v[132:135], v[92:95], v[72:75], v[132:135]
  v_mfma_f32_16x16x32_bf16 v[140:143], v[92:95], v[76:79], v[140:143]
  s_waitcnt lgkmcnt(0)
  v_mfma_f32_16x16x32_bf16 v[128:131], v[112:115], v[96:99], v[128:131]
  v_mfma_f32_16x16x32_bf16 v[136:139], v[112:115], v[100:103], v[136:139]
  v_mfma_f32_16x16x32_bf16 v[132:135], v[116:119], v[96:99], v[132:135]
  v_mfma_f32_16x16x32_bf16 v[140:143], v[116:119], v[100:103], v[140:143]
  v_mfma_f32_16x16x32_bf16 v[128:131], v[120:123], v[104:107], v[128:131]
  v_mfma_f32_16x16x32_bf16 v[136:139], v[120:123], v[108:111], v[136:139]
  v_mfma_f32_16x16x32_bf16 v[132:135], v[124:127], v[104:107], v[132:135]
  v_mfma_f32_16x16x32_bf16 v[140:143], v[124:127], v[108:111], v[140:143]
  s_waitcnt vmcnt(0)
  s_nop 7
  v_cvt_pk_bf16_f32 v8, v128, v129
  v_cvt_pk_bf16_f32 v9, v130, v131
  v_lshlrev_b32 v4, 16, v32
  v_and_b32 v5, 0xffff0000, v32
  v_lshlrev_b32 v6, 16, v33
  v_and_b32 v7, 0xffff0000, v33
  v_lshlrev_b32 v128, 16, v8
  v_and_b32 v129, 0xffff0000, v8
  v_lshlrev_b32 v130, 16, v9
  v_and_b32 v131, 0xffff0000, v9
  v_pk_add_f32 v[128:129], v[128:129], v[4:5]
  v_pk_add_f32 v[130:131], v[130:131], v[6:7]
  v_cvt_pk_bf16_f32 v32, v128, v129
  v_cvt_pk_bf16_f32 v33, v130, v131
  buffer_store_dwordx2 v[32:33], v16, s[12:15], 0 offen offset:0
  v_cvt_pk_bf16_f32 v8, v132, v133
  v_cvt_pk_bf16_f32 v9, v134, v135
  v_lshlrev_b32 v4, 16, v34
  v_and_b32 v5, 0xffff0000, v34
  v_lshlrev_b32 v6, 16, v35
  v_and_b32 v7, 0xffff0000, v35
  v_lshlrev_b32 v132, 16, v8
  v_and_b32 v133, 0xffff0000, v8
  v_lshlrev_b32 v134, 16, v9
  v_and_b32 v135, 0xffff0000, v9
  v_pk_add_f32 v[132:133], v[132:133], v[4:5]
  v_pk_add_f32 v[134:135], v[134:135], v[6:7]
  v_cvt_pk_bf16_f32 v34, v132, v133
  v_cvt_pk_bf16_f32 v35, v134, v135
  buffer_store_dwordx2 v[34:35], v16, s[12:15], 0 offen offset:32
  v_cvt_pk_bf16_f32 v8, v136, v137
  v_cvt_pk_bf16_f32 v9, v138, v139
  v_lshlrev_b32 v4, 16, v36
  v_and_b32 v5, 0xffff0000, v36
  v_lshlrev_b32 v6, 16, v37
  v_and_b32 v7, 0xffff0000, v37
  v_lshlrev_b32 v136, 16, v8
  v_and_b32 v137, 0xffff0000, v8
  v_lshlrev_b32 v138, 16, v9
  v_and_b32 v139, 0xffff0000, v9
  v_pk_add_f32 v[136:137], v[136:137], v[4:5]
  v_pk_add_f32 v[138:139], v[138:139], v[6:7]
  v_cvt_pk_bf16_f32 v36, v136, v137
  v_cvt_pk_bf16_f32 v37, v138, v139
  buffer_store_dwordx2 v[36:37], v16, s[12:15], s36 offen offset:0
  v_cvt_pk_bf16_f32 v8, v140, v141
  v_cvt_pk_bf16_f32 v9, v142, v143
  v_lshlrev_b32 v4, 16, v38
  v_and_b32 v5, 0xffff0000, v38
  v_lshlrev_b32 v6, 16, v39
  v_and_b32 v7, 0xffff0000, v39
  v_lshlrev_b32 v140, 16, v8
  v_and_b32 v141, 0xffff0000, v8
  v_lshlrev_b32 v142, 16, v9
  v_and_b32 v143, 0xffff0000, v9
  v_pk_add_f32 v[140:141], v[140:141], v[4:5]
  v_pk_add_f32 v[142:143], v[142:143], v[6:7]
  v_cvt_pk_bf16_f32 v38, v140, v141
  v_cvt_pk_bf16_f32 v39, v142, v143
  buffer_store_dwordx2 v[38:39], v16, s[12:15], s36 offen offset:32
  s_branch .Lend_k2a_kernel
.Lloader_k2a_kernel_1:
  s_sub_u32 s26, s26, 4
  v_lshrrev_b32 v4, 3, v1
  v_and_b32 v5, 7, v1
  s_lshl_b32 s31, s26, 4
  s_mov_b32 s32, 1024
  s_lshl_b32 s34, s24, 6
  v_add_u32 v6, s31, v4
  v_bfe_u32 v7, v6, 1, 3
  v_xor_b32 v7, v7, v5
  v_add_u32 v6, s34, v6
  v_mul_lo_u32 v6, v6, s32
  v_lshl_add_u32 v8, v7, 4, v6
  v_add_u32 v6, s31, v4
  v_add_u32 v6, 8, v6
  v_bfe_u32 v7, v6, 1, 3
  v_xor_b32 v7, v7, v5
  v_add_u32 v6, s34, v6
  v_mul_lo_u32 v6, v6, s32
  v_lshl_add_u32 v9, v7, 4, v6
  s_mov_b32 s32, 1024
  v_add_u32 v6, s31, v4
  v_bfe_u32 v7, v6, 1, 1
  v_bfe_u32 v13, v6, 3, 1
  v_lshl_add_u32 v7, v13, 1, v7
  v_lshrrev_b32 v13, 1, v5
  v_xor_b32 v7, v7, v13
  v_add_u32 v7, s33, v7
  v_lshlrev_b32 v7, 4, v7
  v_and_b32 v13, 1, v5
  v_lshl_add_u32 v7, v13, 3, v7
  v_lshlrev_b32 v7, 1, v7
  v_mul_lo_u32 v6, v6, s32
  v_add_u32 v10, v6, v7
  v_add_u32 v6, s31, v4
  v_add_u32 v6, 8, v6
  v_bfe_u32 v7, v6, 1, 1
  v_bfe_u32 v13, v6, 3, 1
  v_lshl_add_u32 v7, v13, 1, v7
  v_lshrrev_b32 v13, 1, v5
  v_xor_b32 v7, v7, v13
  v_add_u32 v7, s33, v7
  v_lshlrev_b32 v7, 4, v7
  v_and_b32 v13, 1, v5
  v_lshl_add_u32 v7, v13, 3, v7
  v_lshlrev_b32 v7, 1, v7
  v_mul_lo_u32 v6, v6, s32
  v_add_u32 v11, v6, v7
  s_lshl_b32 s29, s26, 11
  s_mul_i32 s30, s26, 2048
  s_add_u32 s30, s30, 8192
  s_waitcnt lgkmcnt(0)
  s_mov_b32 s6, 0x200000
  s_mov_b32 s7, 0x00020000
  s_mov_b32 s10, 0x80000
  s_mov_b32 s11, 0x00020000
  s_mov_b32 s31, 0
  s_mov_b32 s32, 0
  s_add_u32 m0, s29, 0
  s_nop 0
  buffer_load_dwordx4 v8, s[4:7], s31 offen lds
  s_add_u32 m0, s29, 1024
  s_nop 0
  buffer_load_dwordx4 v9, s[4:7], s31 offen lds
  s_add_u32 m0, s30, 0
  s_nop 0
  buffer_load_dwordx4 v10, s[8:11], s32 offen lds
  s_add_u32 m0, s30, 1024
  s_nop 0
  buffer_load_dwordx4 v11, s[8:11], s32 offen lds
  s_mov_b32 s31, 128
  s_mov_b32 s32, 65536
  s_add_u32 m0, s29, 16384
  s_nop 0
  buffer_load_dwordx4 v8, s[4:7], s31 offen lds
  s_add_u32 m0, s29, 17408
  s_nop 0
  buffer_load_dwordx4 v9, s[4:7], s31 offen lds
  s_add_u32 m0, s30, 16384
  s_nop 0
  buffer_load_dwordx4 v10, s[8:11], s32 offen lds
  s_add_u32 m0, s30, 17408
  s_nop 0
  buffer_load_dwordx4 v11, s[8:11], s32 offen lds
  s_mov_b32 s31, 256
  s_mov_b32 s32, 131072
  s_add_u32 m0, s29, 32768
  s_nop 0
  buffer_load_dwordx4 v8, s[4:7], s31 offen lds
  s_add_u32 m0, s29, 33792
  s_nop 0
  buffer_load_dwordx4 v9, s[4:7], s31 offen lds
  s_add_u32 m0, s30, 32768
  s_nop 0
  buffer_load_dwordx4 v10, s[8:11], s32 offen lds
  s_add_u32 m0, s30, 33792
  s_nop 0
  buffer_load_dwordx4 v11, s[8:11], s32 offen lds
  s_mov_b32 s31, 384
  s_mov_b32 s32, 196608
  s_add_u32 m0, s29, 49152
  s_nop 0
  buffer_load_dwordx4 v8, s[4:7], s31 offen lds
  s_add_u32 m0, s29, 50176
  s_nop 0
  buffer_load_dwordx4 v9, s[4:7], s31 offen lds
  s_add_u32 m0, s30, 49152
  s_nop 0
  buffer_load_dwordx4 v10, s[8:11], s32 offen lds
  s_add_u32 m0, s30, 50176
  s_nop 0
  buffer_load_dwordx4 v11, s[8:11], s32 offen lds
  s_waitcnt vmcnt(12)
  s_barrier
  s_mov_b32 s31, 512
  s_mov_b32 s32, 262144
  s_add_u32 m0, s29, 65536
  s_nop 0
  buffer_load_dwordx4 v8, s[4:7], s31 offen lds
  s_add_u32 m0, s29, 66560
  s_nop 0
  buffer_load_dwordx4 v9, s[4:7], s31 offen lds
  s_add_u32 m0, s30, 65536
  s_nop 0
  buffer_load_dwordx4 v10, s[8:11], s32 offen lds
  s_add_u32 m0, s30, 66560
  s_nop 0
  buffer_load_dwordx4 v11, s[8:11], s32 offen lds
  s_mov_b32 s31, 640
  s_mov_b32 s32, 327680
  s_add_u32 m0, s29, 81920
  s_nop 0
  buffer_load_dwordx4 v8, s[4:7], s31 offen lds
  s_add_u32 m0, s29, 82944
  s_nop 0
  buffer_load_dwordx4 v9, s[4:7], s31 offen lds
  s_add_u32 m0, s30, 81920
  s_nop 0
  buffer_load_dwordx4 v10, s[8:11], s32 offen lds
  s_add_u32 m0, s30, 82944
  s_nop 0
  buffer_load_dwordx4 v11, s[8:11], s32 offen lds
  s_waitcnt vmcnt(16)
  s_barrier
  s_mov_b32 s31, 768
  s_mov_b32 s32, 393216
  s_add_u32 m0, s29, 98304
  s_nop 0
  buffer_load_dwordx4 v8, s[4:7], s31 offen lds
  s_add_u32 m0, s29, 99328
  s_nop 0
  buffer_load_dwordx4 v9, s[4:7], s31 offen lds
  s_add_u32 m0, s30, 98304
  s_nop 0
  buffer_load_dwordx4 v10, s[8:11], s32 offen lds
  s_add_u32 m0, s30, 99328
  s_nop 0
  buffer_load_dwordx4 v11, s[8:11], s32 offen lds
  s_mov_b32 s31, 896
  s_mov_b32 s32, 458752
  s_add_u32 m0, s29, 114688
  s_nop 0
  buffer_load_dwordx4 v8, s[4:7], s31 offen lds
  s_add_u32 m0, s29, 115712
  s_nop 0
  buffer_load_dwordx4 v9, s[4:7], s31 offen lds
  s_add_u32 m0, s30, 114688
  s_nop 0
  buffer_load_dwordx4 v10, s[8:11], s32 offen lds
  s_add_u32 m0, s30, 115712
  s_nop 0
  buffer_load_dwordx4 v11, s[8:11], s32 offen lds
  s_waitcnt vmcnt(20)
  s_barrier
  s_waitcnt vmcnt(16)
  s_barrier
  s_waitcnt vmcnt(12)
  s_barrier
  s_waitcnt vmcnt(8)
  s_barrier
  s_waitcnt vmcnt(4)
  s_barrier
  s_waitcnt vmcnt(0)
  s_barrier
.Lend_k2a_kernel:
  s_endpgm

.globl k2b_kernel
.p2align 8
.type k2b_kernel,@function
k2b_kernel:
  s_cmp_ge_u32 s2, 256
  s_cbranch_scc1 .Lend_k2b_kernel
  s_load_dwordx2 s[4:5], s[0:1], 80
  s_load_dwordx2 s[8:9], s[0:1], 16
  s_load_dwordx2 s[12:13], s[0:1], 80
  s_load_dwordx2 s[16:17], s[0:1], 80
  s_and_b32 s24, s2, 7
  s_lshl_b32 s24, s24, 2
  s_lshr_b32 s25, s2, 3
  s_and_b32 s25, s25, 3
  s_add_u32 s24, s24, s25
  s_lshr_b32 s25, s2, 5
  v_and_b32 v1, 63, v0
  v_lshrrev_b32 v4, 6, v0
  v_and_b32 v2, 15, v0
  v_readfirstlane_b32 s26, v4
  v_bfe_u32 v3, v0, 4, 2
  s_lshl_b32 s33, s25, 2
  s_cmp_ge_u32 s26, 4
  s_cbranch_scc1 .Lloader_k2b_kernel_1
  s_and_b32 s27, s26, 1
  s_lshr_b32 s28, s26, 1
  s_lshl_b32 s31, s24, 6
  s_lshl_b32 s32, s27, 5
  s_add_u32 s31, s31, s32
  v_add_u32 v4, s31, v2
  s_mul_i32 s34, s28, 2
  s_add_u32 s34, s34, s33
  s_lshl_b32 s34, s34, 5
  s_mov_b32 s32, 1024
  v_mul_lo_u32 v16, v4, s32
  v_lshl_add_u32 v16, v3, 3, v16
  v_add_u32 v16, s34, v16
  s_mov_b32 s32, 1024
  v_mul_lo_u32 v17, v4, s32
  v_lshl_add_u32 v17, v3, 3, v17
  v_add_u32 v17, s34, v17
  v_lshlrev_b32 v18, 1, v4
  s_mov_b32 s35, 16384
  s_mov_b32 s36, 16384
  s_lshl_b32 s31, s27, 12
  v_lshrrev_b32 v4, 1, v2
  v_xor_b32 v5, v3, v4
  v_and_b32 v5, 3, v5
  v_and_b32 v4, 4, v4
  v_xor_b32 v6, 0, v4
  v_or_b32 v6, v6, v5
  v_lshlrev_b32 v6, 4, v6
  v_lshl_add_u32 v6, v2, 7, v6
  v_add_u32 v20, s31, v6
  v_xor_b32 v6, 4, v4
  v_or_b32 v6, v6, v5
  v_lshlrev_b32 v6, 4, v6
  v_lshl_add_u32 v6, v2, 7, v6
  v_add_u32 v21, s31, v6
  v_lshrrev_b32 v4, 2, v2
  v_lshl_add_u32 v4, v3, 3, v4
  v_mul_u32_u24 v4, 128, v4
  v_and_b32 v5, 3, v2
  v_lshl_add_u32 v4, v5, 3, v4
  v_add_u32 v4, 0x2000, v4
  v_and_b32 v6, 1, v3
  s_mul_i32 s31, s28, 2
  v_bfe_u32 v5, v2, 3, 1
  v_lshl_add_u32 v5, v6, 1, v5
  s_add_u32 s32, s31, 0
  v_xor_b32 v7, s32, v5
  v_lshl_add_u32 v22, v7, 5, v4
  s_add_u32 s32, s31, 1
  v_xor_b32 v7, s32, v5
  v_lshl_add_u32 v23, v7, 5, v4
  v_mov_b32 v128, 0
  v_mov_b32 v129, 0
  v_mov_b32 v130, 0
  v_mov_b32 v131, 0
  v_mov_b32 v132, 0
  v_mov_b32 v133, 0
  v_mov_b32 v134, 0
  v_mov_b32 v135, 0
  v_mov_b32 v136, 0
  v_mov_b32 v137, 0
  v_mov_b32 v138, 0
  v_mov_b32 v139, 0
  v_mov_b32 v140, 0
  v_mov_b32 v141, 0
  v_mov_b32 v142, 0
  v_mov_b32 v143, 0
  s_waitcnt lgkmcnt(0)
  s_add_u32 s12, s12, 0x200000
  s_addc_u32 s13, s13, 0
  s_mov_b32 s14, 0x200000
  s_mov_b32 s15, 0x00020000
  s_add_u32 s16, s16, 0x400000
  s_addc_u32 s17, s17, 0
  s_mov_b32 s18, 0x200000
  s_mov_b32 s19, 0x00020000
  s_barrier
  ds_read_b128 v[64:67], v20 offset:0
  ds_read_b128 v[68:71], v20 offset:2048
  ds_read_b64_tr_b16 v[80:81], v22 offset:0
  ds_read_b64_tr_b16 v[82:83], v22 offset:512
  ds_read_b64_tr_b16 v[84:85], v23 offset:0
  ds_read_b64_tr_b16 v[86:87], v23 offset:512
  ds_read_b128 v[72:75], v21 offset:0
  ds_read_b128 v[76:79], v21 offset:2048
  ds_read_b64_tr_b16 v[88:89], v22 offset:4096
  ds_read_b64_tr_b16 v[90:91], v22 offset:4608
  ds_read_b64_tr_b16 v[92:93], v23 offset:4096
  ds_read_b64_tr_b16 v[94:95], v23 offset:4608
  s_waitcnt lgkmcnt(0)
  s_barrier
  v_add_u32 v26, 0x4000, v20
  v_add_u32 v27, 0x4000, v21
  v_add_u32 v28, 0x4000, v22
  v_add_u32 v29, 0x4000, v23
  v_mfma_f32_16x16x32_bf16 v[128:131], v[80:83], v[64:67], v[128:131]
  ds_read_b128 v[96:99], v26 offset:0
  ds_read_b128 v[100:103], v26 offset:2048
  v_mfma_f32_16x16x32_bf16 v[136:139], v[80:83], v[68:71], v[136:139]
  ds_read_b64_tr_b16 v[112:113], v28 offset:0
  ds_read_b64_tr_b16 v[114:115], v28 offset:512
  v_mfma_f32_16x16x32_bf16 v[132:135], v[84:87], v[64:67], v[132:135]
  ds_read_b64_tr_b16 v[116:117], v29 offset:0
  ds_read_b64_tr_b16 v[118:119], v29 offset:512
  v_mfma_f32_16x16x32_bf16 v[140:143], v[84:87], v[68:71], v[140:143]
  ds_read_b128 v[104:107], v27 offset:0
  ds_read_b128 v[108:111], v27 offset:2048
  v_mfma_f32_16x16x32_bf16 v[128:131], v[88:91], v[72:75], v[128:131]
  ds_read_b64_tr_b16 v[120:121], v28 offset:4096
  ds_read_b64_tr_b16 v[122:123], v28 offset:4608
  v_mfma_f32_16x16x32_bf16 v[136:139], v[88:91], v[76:79], v[136:139]
  ds_read_b64_tr_b16 v[124:125], v29 offset:4096
  ds_read_b64_tr_b16 v[126:127], v29 offset:4608
  v_mfma_f32_16x16x32_bf16 v[132:135], v[92:95], v[72:75], v[132:135]
  v_mfma_f32_16x16x32_bf16 v[140:143], v[92:95], v[76:79], v[140:143]
  s_waitcnt lgkmcnt(0)
  s_barrier
  v_add_u32 v26, 0x8000, v20
  v_add_u32 v27, 0x8000, v21
  v_add_u32 v28, 0x8000, v22
  v_add_u32 v29, 0x8000, v23
  v_mfma_f32_16x16x32_bf16 v[128:131], v[112:115], v[96:99], v[128:131]
  ds_read_b128 v[64:67], v26 offset:0
  ds_read_b128 v[68:71], v26 offset:2048
  v_mfma_f32_16x16x32_bf16 v[136:139], v[112:115], v[100:103], v[136:139]
  ds_read_b64_tr_b16 v[80:81], v28 offset:0
  ds_read_b64_tr_b16 v[82:83], v28 offset:512
  v_mfma_f32_16x16x32_bf16 v[132:135], v[116:119], v[96:99], v[132:135]
  ds_read_b64_tr_b16 v[84:85], v29 offset:0
  ds_read_b64_tr_b16 v[86:87], v29 offset:512
  v_mfma_f32_16x16x32_bf16 v[140:143], v[116:119], v[100:103], v[140:143]
  ds_read_b128 v[72:75], v27 offset:0
  ds_read_b128 v[76:79], v27 offset:2048
  v_mfma_f32_16x16x32_bf16 v[128:131], v[120:123], v[104:107], v[128:131]
  ds_read_b64_tr_b16 v[88:89], v28 offset:4096
  ds_read_b64_tr_b16 v[90:91], v28 offset:4608
  v_mfma_f32_16x16x32_bf16 v[136:139], v[120:123], v[108:111], v[136:139]
  ds_read_b64_tr_b16 v[92:93], v29 offset:4096
  ds_read_b64_tr_b16 v[94:95], v29 offset:4608
  v_mfma_f32_16x16x32_bf16 v[132:135], v[124:127], v[104:107], v[132:135]
  v_mfma_f32_16x16x32_bf16 v[140:143], v[124:127], v[108:111], v[140:143]
  s_waitcnt lgkmcnt(0)
  s_barrier
  v_add_u32 v26, 0xc000, v20
  v_add_u32 v27, 0xc000, v21
  v_add_u32 v28, 0xc000, v22
  v_add_u32 v29, 0xc000, v23
  v_mfma_f32_16x16x32_bf16 v[128:131], v[80:83], v[64:67], v[128:131]
  ds_read_b128 v[96:99], v26 offset:0
  ds_read_b128 v[100:103], v26 offset:2048
  v_mfma_f32_16x16x32_bf16 v[136:139], v[80:83], v[68:71], v[136:139]
  ds_read_b64_tr_b16 v[112:113], v28 offset:0
  ds_read_b64_tr_b16 v[114:115], v28 offset:512
  v_mfma_f32_16x16x32_bf16 v[132:135], v[84:87], v[64:67], v[132:135]
  ds_read_b64_tr_b16 v[116:117], v29 offset:0
  ds_read_b64_tr_b16 v[118:119], v29 offset:512
  v_mfma_f32_16x16x32_bf16 v[140:143], v[84:87], v[68:71], v[140:143]
  ds_read_b128 v[104:107], v27 offset:0
  ds_read_b128 v[108:111], v27 offset:2048
  v_mfma_f32_16x16x32_bf16 v[128:131], v[88:91], v[72:75], v[128:131]
  ds_read_b64_tr_b16 v[120:121], v28 offset:4096
  ds_read_b64_tr_b16 v[122:123], v28 offset:4608
  v_mfma_f32_16x16x32_bf16 v[136:139], v[88:91], v[76:79], v[136:139]
  ds_read_b64_tr_b16 v[124:125], v29 offset:4096
  ds_read_b64_tr_b16 v[126:127], v29 offset:4608
  v_mfma_f32_16x16x32_bf16 v[132:135], v[92:95], v[72:75], v[132:135]
  v_mfma_f32_16x16x32_bf16 v[140:143], v[92:95], v[76:79], v[140:143]
  s_waitcnt lgkmcnt(0)
  s_barrier
  v_add_u32 v26, 0x10000, v20
  v_add_u32 v27, 0x10000, v21
  v_add_u32 v28, 0x10000, v22
  v_add_u32 v29, 0x10000, v23
  v_mfma_f32_16x16x32_bf16 v[128:131], v[112:115], v[96:99], v[128:131]
  ds_read_b128 v[64:67], v26 offset:0
  ds_read_b128 v[68:71], v26 offset:2048
  v_mfma_f32_16x16x32_bf16 v[136:139], v[112:115], v[100:103], v[136:139]
  ds_read_b64_tr_b16 v[80:81], v28 offset:0
  ds_read_b64_tr_b16 v[82:83], v28 offset:512
  v_mfma_f32_16x16x32_bf16 v[132:135], v[116:119], v[96:99], v[132:135]
  ds_read_b64_tr_b16 v[84:85], v29 offset:0
  ds_read_b64_tr_b16 v[86:87], v29 offset:512
  v_mfma_f32_16x16x32_bf16 v[140:143], v[116:119], v[100:103], v[140:143]
  ds_read_b128 v[72:75], v27 offset:0
  ds_read_b128 v[76:79], v27 offset:2048
  v_mfma_f32_16x16x32_bf16 v[128:131], v[120:123], v[104:107], v[128:131]
  ds_read_b64_tr_b16 v[88:89], v28 offset:4096
  ds_read_b64_tr_b16 v[90:91], v28 offset:4608
  v_mfma_f32_16x16x32_bf16 v[136:139], v[120:123], v[108:111], v[136:139]
  ds_read_b64_tr_b16 v[92:93], v29 offset:4096
  ds_read_b64_tr_b16 v[94:95], v29 offset:4608
  v_mfma_f32_16x16x32_bf16 v[132:135], v[124:127], v[104:107], v[132:135]
  v_mfma_f32_16x16x32_bf16 v[140:143], v[124:127], v[108:111], v[140:143]
  buffer_load_dwordx2 v[32:33], v17, s[16:19], 0 offen offset:0
  buffer_load_dwordx2 v[34:35], v17, s[16:19], 0 offen offset:32
  buffer_load_dwordx2 v[36:37], v17, s[16:19], s35 offen offset:0
  buffer_load_dwordx2 v[38:39], v17, s[16:19], s35 offen offset:32
  s_waitcnt lgkmcnt(0)
  s_barrier
  v_add_u32 v26, 0x14000, v20
  v_add_u32 v27, 0x14000, v21
  v_add_u32 v28, 0x14000, v22
  v_add_u32 v29, 0x14000, v23
  v_mfma_f32_16x16x32_bf16 v[128:131], v[80:83], v[64:67], v[128:131]
  ds_read_b128 v[96:99], v26 offset:0
  ds_read_b128 v[100:103], v26 offset:2048
  v_mfma_f32_16x16x32_bf16 v[136:139], v[80:83], v[68:71], v[136:139]
  ds_read_b64_tr_b16 v[112:113], v28 offset:0
  ds_read_b64_tr_b16 v[114:115], v28 offset:512
  v_mfma_f32_16x16x32_bf16 v[132:135], v[84:87], v[64:67], v[132:135]
  ds_read_b64_tr_b16 v[116:117], v29 offset:0
  ds_read_b64_tr_b16 v[118:119], v29 offset:512
  v_mfma_f32_16x16x32_bf16 v[140:143], v[84:87], v[68:71], v[140:143]
  ds_read_b128 v[104:107], v27 offset:0
  ds_read_b128 v[108:111], v27 offset:2048
  v_mfma_f32_16x16x32_bf16 v[128:131], v[88:91], v[72:75], v[128:131]
  ds_read_b64_tr_b16 v[120:121], v28 offset:4096
  ds_read_b64_tr_b16 v[122:123], v28 offset:4608
  v_mfma_f32_16x16x32_bf16 v[136:139], v[88:91], v[76:79], v[136:139]
  ds_read_b64_tr_b16 v[124:125], v29 offset:4096
  ds_read_b64_tr_b16 v[126:127], v29 offset:4608
  v_mfma_f32_16x16x32_bf16 v[132:135], v[92:95], v[72:75], v[132:135]
  v_mfma_f32_16x16x32_bf16 v[140:143], v[92:95], v[76:79], v[140:143]
  s_waitcnt lgkmcnt(0)
  s_barrier
  v_add_u32 v26, 0x18000, v20
  v_add_u32 v27, 0x18000, v21
  v_add_u32 v28, 0x18000, v22
  v_add_u32 v29, 0x18000, v23
  v_mfma_f32_16x16x32_bf16 v[128:131], v[112:115], v[96:99], v[128:131]
  ds_read_b128 v[64:67], v26 offset:0
  ds_read_b128 v[68:71], v26 offset:2048
  v_mfma_f32_16x16x32_bf16 v[136:139], v[112:115], v[100:103], v[136:139]
  ds_read_b64_tr_b16 v[80:81], v28 offset:0
  ds_read_b64_tr_b16 v[82:83], v28 offset:512
  v_mfma_f32_16x16x32_bf16 v[132:135], v[116:119], v[96:99], v[132:135]
  ds_read_b64_tr_b16 v[84:85], v29 offset:0
  ds_read_b64_tr_b16 v[86:87], v29 offset:512
  v_mfma_f32_16x16x32_bf16 v[140:143], v[116:119], v[100:103], v[140:143]
  ds_read_b128 v[72:75], v27 offset:0
  ds_read_b128 v[76:79], v27 offset:2048
  v_mfma_f32_16x16x32_bf16 v[128:131], v[120:123], v[104:107], v[128:131]
  ds_read_b64_tr_b16 v[88:89], v28 offset:4096
  ds_read_b64_tr_b16 v[90:91], v28 offset:4608
  v_mfma_f32_16x16x32_bf16 v[136:139], v[120:123], v[108:111], v[136:139]
  ds_read_b64_tr_b16 v[92:93], v29 offset:4096
  ds_read_b64_tr_b16 v[94:95], v29 offset:4608
  v_mfma_f32_16x16x32_bf16 v[132:135], v[124:127], v[104:107], v[132:135]
  v_mfma_f32_16x16x32_bf16 v[140:143], v[124:127], v[108:111], v[140:143]
  s_waitcnt lgkmcnt(0)
  s_barrier
  v_add_u32 v26, 0x1c000, v20
  v_add_u32 v27, 0x1c000, v21
  v_add_u32 v28, 0x1c000, v22
  v_add_u32 v29, 0x1c000, v23
  v_mfma_f32_16x16x32_bf16 v[128:131], v[80:83], v[64:67], v[128:131]
  ds_read_b128 v[96:99], v26 offset:0
  ds_read_b128 v[100:103], v26 offset:2048
  v_mfma_f32_16x16x32_bf16 v[136:139], v[80:83], v[68:71], v[136:139]
  ds_read_b64_tr_b16 v[112:113], v28 offset:0
  ds_read_b64_tr_b16 v[114:115], v28 offset:512
  v_mfma_f32_16x16x32_bf16 v[132:135], v[84:87], v[64:67], v[132:135]
  ds_read_b64_tr_b16 v[116:117], v29 offset:0
  ds_read_b64_tr_b16 v[118:119], v29 offset:512
  v_mfma_f32_16x16x32_bf16 v[140:143], v[84:87], v[68:71], v[140:143]
  ds_read_b128 v[104:107], v27 offset:0
  ds_read_b128 v[108:111], v27 offset:2048
  v_mfma_f32_16x16x32_bf16 v[128:131], v[88:91], v[72:75], v[128:131]
  ds_read_b64_tr_b16 v[120:121], v28 offset:4096
  ds_read_b64_tr_b16 v[122:123], v28 offset:4608
  v_mfma_f32_16x16x32_bf16 v[136:139], v[88:91], v[76:79], v[136:139]
  ds_read_b64_tr_b16 v[124:125], v29 offset:4096
  ds_read_b64_tr_b16 v[126:127], v29 offset:4608
  v_mfma_f32_16x16x32_bf16 v[132:135], v[92:95], v[72:75], v[132:135]
  v_mfma_f32_16x16x32_bf16 v[140:143], v[92:95], v[76:79], v[140:143]
  s_waitcnt lgkmcnt(0)
  v_mfma_f32_16x16x32_bf16 v[128:131], v[112:115], v[96:99], v[128:131]
  v_mfma_f32_16x16x32_bf16 v[136:139], v[112:115], v[100:103], v[136:139]
  v_mfma_f32_16x16x32_bf16 v[132:135], v[116:119], v[96:99], v[132:135]
  v_mfma_f32_16x16x32_bf16 v[140:143], v[116:119], v[100:103], v[140:143]
  v_mfma_f32_16x16x32_bf16 v[128:131], v[120:123], v[104:107], v[128:131]
  v_mfma_f32_16x16x32_bf16 v[136:139], v[120:123], v[108:111], v[136:139]
  v_mfma_f32_16x16x32_bf16 v[132:135], v[124:127], v[104:107], v[132:135]
  v_mfma_f32_16x16x32_bf16 v[140:143], v[124:127], v[108:111], v[140:143]
  s_waitcnt vmcnt(0)
  s_nop 7
  v_cvt_pk_bf16_f32 v8, v128, v129
  v_cvt_pk_bf16_f32 v9, v130, v131
  v_lshlrev_b32 v4, 16, v32
  v_and_b32 v5, 0xffff0000, v32
  v_lshlrev_b32 v6, 16, v33
  v_and_b32 v7, 0xffff0000, v33
  v_lshlrev_b32 v128, 16, v8
  v_and_b32 v129, 0xffff0000, v8
  v_lshlrev_b32 v130, 16, v9
  v_and_b32 v131, 0xffff0000, v9
  v_pk_add_f32 v[128:129], v[128:129], v[4:5]
  v_pk_add_f32 v[130:131], v[130:131], v[6:7]
  v_cvt_pk_bf16_f32 v32, v128, v129
  v_cvt_pk_bf16_f32 v33, v130, v131
  buffer_store_dwordx2 v[32:33], v16, s[12:15], 0 offen offset:0
  v_cvt_pk_bf16_f32 v8, v132, v133
  v_cvt_pk_bf16_f32 v9, v134, v135
  v_lshlrev_b32 v4, 16, v34
  v_and_b32 v5, 0xffff0000, v34
  v_lshlrev_b32 v6, 16, v35
  v_and_b32 v7, 0xffff0000, v35
  v_lshlrev_b32 v132, 16, v8
  v_and_b32 v133, 0xffff0000, v8
  v_lshlrev_b32 v134, 16, v9
  v_and_b32 v135, 0xffff0000, v9
  v_pk_add_f32 v[132:133], v[132:133], v[4:5]
  v_pk_add_f32 v[134:135], v[134:135], v[6:7]
  v_cvt_pk_bf16_f32 v34, v132, v133
  v_cvt_pk_bf16_f32 v35, v134, v135
  buffer_store_dwordx2 v[34:35], v16, s[12:15], 0 offen offset:32
  v_cvt_pk_bf16_f32 v8, v136, v137
  v_cvt_pk_bf16_f32 v9, v138, v139
  v_lshlrev_b32 v4, 16, v36
  v_and_b32 v5, 0xffff0000, v36
  v_lshlrev_b32 v6, 16, v37
  v_and_b32 v7, 0xffff0000, v37
  v_lshlrev_b32 v136, 16, v8
  v_and_b32 v137, 0xffff0000, v8
  v_lshlrev_b32 v138, 16, v9
  v_and_b32 v139, 0xffff0000, v9
  v_pk_add_f32 v[136:137], v[136:137], v[4:5]
  v_pk_add_f32 v[138:139], v[138:139], v[6:7]
  v_cvt_pk_bf16_f32 v36, v136, v137
  v_cvt_pk_bf16_f32 v37, v138, v139
  buffer_store_dwordx2 v[36:37], v16, s[12:15], s36 offen offset:0
  v_cvt_pk_bf16_f32 v8, v140, v141
  v_cvt_pk_bf16_f32 v9, v142, v143
  v_lshlrev_b32 v4, 16, v38
  v_and_b32 v5, 0xffff0000, v38
  v_lshlrev_b32 v6, 16, v39
  v_and_b32 v7, 0xffff0000, v39
  v_lshlrev_b32 v140, 16, v8
  v_and_b32 v141, 0xffff0000, v8
  v_lshlrev_b32 v142, 16, v9
  v_and_b32 v143, 0xffff0000, v9
  v_pk_add_f32 v[140:141], v[140:141], v[4:5]
  v_pk_add_f32 v[142:143], v[142:143], v[6:7]
  v_cvt_pk_bf16_f32 v38, v140, v141
  v_cvt_pk_bf16_f32 v39, v142, v143
  buffer_store_dwordx2 v[38:39], v16, s[12:15], s36 offen offset:32
  s_branch .Lend_k2b_kernel
.Lloader_k2b_kernel_1:
  s_sub_u32 s26, s26, 4
  v_lshrrev_b32 v4, 3, v1
  v_and_b32 v5, 7, v1
  s_lshl_b32 s31, s26, 4
  s_mov_b32 s32, 1024
  s_lshl_b32 s34, s24, 6
  v_add_u32 v6, s31, v4
  v_bfe_u32 v7, v6, 1, 3
  v_xor_b32 v7, v7, v5
  v_add_u32 v6, s34, v6
  v_mul_lo_u32 v6, v6, s32
  v_lshl_add_u32 v8, v7, 4, v6
  v_add_u32 v6, s31, v4
  v_add_u32 v6, 8, v6
  v_bfe_u32 v7, v6, 1, 3
  v_xor_b32 v7, v7, v5
  v_add_u32 v6, s34, v6
  v_mul_lo_u32 v6, v6, s32
  v_lshl_add_u32 v9, v7, 4, v6
  s_mov_b32 s32, 1024
  v_add_u32 v6, s31, v4
  v_bfe_u32 v7, v6, 1, 1
  v_bfe_u32 v13, v6, 3, 1
  v_lshl_add_u32 v7, v13, 1, v7
  v_lshrrev_b32 v13, 1, v5
  v_xor_b32 v7, v7, v13
  v_add_u32 v7, s33, v7
  v_lshlrev_b32 v7, 4, v7
  v_and_b32 v13, 1, v5
  v_lshl_add_u32 v7, v13, 3, v7
  v_lshlrev_b32 v7, 1, v7
  v_mul_lo_u32 v6, v6, s32
  v_add_u32 v10, v6, v7
  v_add_u32 v6, s31, v4
  v_add_u32 v6, 8, v6
  v_bfe_u32 v7, v6, 1, 1
  v_bfe_u32 v13, v6, 3, 1
  v_lshl_add_u32 v7, v13, 1, v7
  v_lshrrev_b32 v13, 1, v5
  v_xor_b32 v7, v7, v13
  v_add_u32 v7, s33, v7
  v_lshlrev_b32 v7, 4, v7
  v_and_b32 v13, 1, v5
  v_lshl_add_u32 v7, v13, 3, v7
  v_lshlrev_b32 v7, 1, v7
  v_mul_lo_u32 v6, v6, s32
  v_add_u32 v11, v6, v7
  s_lshl_b32 s29, s26, 11
  s_mul_i32 s30, s26, 2048
  s_add_u32 s30, s30, 8192
  s_waitcnt lgkmcnt(0)
  s_mov_b32 s6, 0x200000
  s_mov_b32 s7, 0x00020000
  s_mov_b32 s10, 0x80000
  s_mov_b32 s11, 0x00020000
  s_mov_b32 s31, 0
  s_mov_b32 s32, 0
  s_add_u32 m0, s29, 0
  s_nop 0
  buffer_load_dwordx4 v8, s[4:7], s31 offen lds
  s_add_u32 m0, s29, 1024
  s_nop 0
  buffer_load_dwordx4 v9, s[4:7], s31 offen lds
  s_add_u32 m0, s30, 0
  s_nop 0
  buffer_load_dwordx4 v10, s[8:11], s32 offen lds
  s_add_u32 m0, s30, 1024
  s_nop 0
  buffer_load_dwordx4 v11, s[8:11], s32 offen lds
  s_mov_b32 s31, 128
  s_mov_b32 s32, 65536
  s_add_u32 m0, s29, 16384
  s_nop 0
  buffer_load_dwordx4 v8, s[4:7], s31 offen lds
  s_add_u32 m0, s29, 17408
  s_nop 0
  buffer_load_dwordx4 v9, s[4:7], s31 offen lds
  s_add_u32 m0, s30, 16384
  s_nop 0
  buffer_load_dwordx4 v10, s[8:11], s32 offen lds
  s_add_u32 m0, s30, 17408
  s_nop 0
  buffer_load_dwordx4 v11, s[8:11], s32 offen lds
  s_mov_b32 s31, 256
  s_mov_b32 s32, 131072
  s_add_u32 m0, s29, 32768
  s_nop 0
  buffer_load_dwordx4 v8, s[4:7], s31 offen lds
  s_add_u32 m0, s29, 33792
  s_nop 0
  buffer_load_dwordx4 v9, s[4:7], s31 offen lds
  s_add_u32 m0, s30, 32768
  s_nop 0
  buffer_load_dwordx4 v10, s[8:11], s32 offen lds
  s_add_u32 m0, s30, 33792
  s_nop 0
  buffer_load_dwordx4 v11, s[8:11], s32 offen lds
  s_mov_b32 s31, 384
  s_mov_b32 s32, 196608
  s_add_u32 m0, s29, 49152
  s_nop 0
  buffer_load_dwordx4 v8, s[4:7], s31 offen lds
  s_add_u32 m0, s29, 50176
  s_nop 0
  buffer_load_dwordx4 v9, s[4:7], s31 offen lds
  s_add_u32 m0, s30, 49152
  s_nop 0
  buffer_load_dwordx4 v10, s[8:11], s32 offen lds
  s_add_u32 m0, s30, 50176
  s_nop 0
  buffer_load_dwordx4 v11, s[8:11], s32 offen lds
  s_waitcnt vmcnt(12)
  s_barrier
  s_mov_b32 s31, 512
  s_mov_b32 s32, 262144
  s_add_u32 m0, s29, 65536
  s_nop 0
  buffer_load_dwordx4 v8, s[4:7], s31 offen lds
  s_add_u32 m0, s29, 66560
  s_nop 0
  buffer_load_dwordx4 v9, s[4:7], s31 offen lds
  s_add_u32 m0, s30, 65536
  s_nop 0
  buffer_load_dwordx4 v10, s[8:11], s32 offen lds
  s_add_u32 m0, s30, 66560
  s_nop 0
  buffer_load_dwordx4 v11, s[8:11], s32 offen lds
  s_mov_b32 s31, 640
  s_mov_b32 s32, 327680
  s_add_u32 m0, s29, 81920
  s_nop 0
  buffer_load_dwordx4 v8, s[4:7], s31 offen lds
  s_add_u32 m0, s29, 82944
  s_nop 0
  buffer_load_dwordx4 v9, s[4:7], s31 offen lds
  s_add_u32 m0, s30, 81920
  s_nop 0
  buffer_load_dwordx4 v10, s[8:11], s32 offen lds
  s_add_u32 m0, s30, 82944
  s_nop 0
  buffer_load_dwordx4 v11, s[8:11], s32 offen lds
  s_waitcnt vmcnt(16)
  s_barrier
  s_mov_b32 s31, 768
  s_mov_b32 s32, 393216
  s_add_u32 m0, s29, 98304
  s_nop 0
  buffer_load_dwordx4 v8, s[4:7], s31 offen lds
  s_add_u32 m0, s29, 99328
  s_nop 0
  buffer_load_dwordx4 v9, s[4:7], s31 offen lds
  s_add_u32 m0, s30, 98304
  s_nop 0
  buffer_load_dwordx4 v10, s[8:11], s32 offen lds
  s_add_u32 m0, s30, 99328
  s_nop 0
  buffer_load_dwordx4 v11, s[8:11], s32 offen lds
  s_mov_b32 s31, 896
  s_mov_b32 s32, 458752
  s_add_u32 m0, s29, 114688
  s_nop 0
  buffer_load_dwordx4 v8, s[4:7], s31 offen lds
  s_add_u32 m0, s29, 115712
  s_nop 0
  buffer_load_dwordx4 v9, s[4:7], s31 offen lds
  s_add_u32 m0, s30, 114688
  s_nop 0
  buffer_load_dwordx4 v10, s[8:11], s32 offen lds
  s_add_u32 m0, s30, 115712
  s_nop 0
  buffer_load_dwordx4 v11, s[8:11], s32 offen lds
  s_waitcnt vmcnt(20)
  s_barrier
  s_waitcnt vmcnt(16)
  s_barrier
  s_waitcnt vmcnt(12)
  s_barrier
  s_waitcnt vmcnt(8)
  s_barrier
  s_waitcnt vmcnt(4)
  s_barrier
  s_waitcnt vmcnt(0)
  s_barrier
.Lend_k2b_kernel:
  s_endpgm

.globl k3_kernel
.p2align 8
.type k3_kernel,@function
k3_kernel:
  s_cmp_ge_u32 s2, 256
  s_cbranch_scc1 .Lend_k3_kernel
  s_load_dwordx2 s[4:5], s[0:1], 80
  s_load_dwordx2 s[12:13], s[0:1], 80
  s_load_dwordx2 s[8:9], s[0:1], 32
  s_and_b32 s16, s2, 7
  s_lshl_b32 s16, s16, 2
  s_lshr_b32 s17, s2, 3
  s_and_b32 s17, s17, 3
  s_add_u32 s16, s16, s17
  s_lshr_b32 s17, s2, 5
  v_and_b32 v1, 63, v0
  v_lshrrev_b32 v4, 6, v0
  v_and_b32 v2, 15, v0
  v_readfirstlane_b32 s18, v4
  v_bfe_u32 v3, v0, 4, 2
  s_mul_i32 s24, s17, 346431
  s_lshr_b32 s24, s24, 16
  s_lshl_b32 s24, s24, 1
  s_cmp_ge_u32 s18, 8
  s_cbranch_scc1 .Lloader_k3_kernel_1
  s_and_b32 s19, s18, 1
  s_lshr_b32 s20, s18, 1
  s_lshl_b32 s22, s18, 2
  v_add_u32 v4, s22, v3
  s_lshl_b32 s23, s16, 6
  v_add_u32 v5, s23, v4
  v_lshlrev_b32 v5, 10, v5
  v_lshl_add_u32 v11, v2, 4, v5
  v_subrev_u32 v12, 0x4000, v11
  v_and_b32 v5, 15, v4
  v_xor_b32 v5, v5, v2
  v_lshlrev_b32 v5, 4, v5
  v_lshl_add_u32 v13, v4, 10, v5
  v_add_u32 v14, 0x10000, v13
  s_waitcnt lgkmcnt(0)
  s_add_u32 s4, s4, 0x200000
  s_addc_u32 s5, s5, 0
  s_mov_b32 s6, 0x200000
  s_mov_b32 s7, 0x00020000
  s_add_u32 s12, s12, 0x600000
  s_addc_u32 s13, s13, 0
  s_mov_b32 s14, 0x560000
  s_mov_b32 s15, 0x00020000
  s_mov_b32 s23, 0x8000
  buffer_load_dwordx4 v[32:35], v11, s[4:7], 0 offen offset:0
  buffer_load_dwordx4 v[36:39], v11, s[4:7], 0 offen offset:256
  buffer_load_dwordx4 v[40:43], v11, s[4:7], 0 offen offset:512
  buffer_load_dwordx4 v[44:47], v11, s[4:7], 0 offen offset:768
  buffer_load_dwordx4 v[48:51], v11, s[4:7], s23 offen offset:0
  buffer_load_dwordx4 v[52:55], v11, s[4:7], s23 offen offset:256
  buffer_load_dwordx4 v[56:59], v11, s[4:7], s23 offen offset:512
  buffer_load_dwordx4 v[60:63], v11, s[4:7], s23 offen offset:768
  s_barrier
  s_lshl_b32 s22, s19, 15
  v_xor_b32 v4, v3, v2
  v_and_b32 v4, 3, v4
  v_and_b32 v5, 12, v2
  v_xor_b32 v6, 0, v5
  v_or_b32 v6, v6, v4
  v_lshlrev_b32 v6, 4, v6
  v_lshl_add_u32 v6, v2, 10, v6
  v_add_u32 v16, s22, v6
  v_xor_b32 v6, 4, v5
  v_or_b32 v6, v6, v4
  v_lshlrev_b32 v6, 4, v6
  v_lshl_add_u32 v6, v2, 10, v6
  v_add_u32 v17, s22, v6
  v_xor_b32 v6, 8, v5
  v_or_b32 v6, v6, v4
  v_lshlrev_b32 v6, 4, v6
  v_lshl_add_u32 v6, v2, 10, v6
  v_add_u32 v18, s22, v6
  v_xor_b32 v6, 12, v5
  v_or_b32 v6, v6, v4
  v_lshlrev_b32 v6, 4, v6
  v_lshl_add_u32 v6, v2, 10, v6
  v_add_u32 v19, s22, v6
  v_lshrrev_b32 v4, 2, v2
  v_lshl_add_u32 v4, v3, 3, v4
  v_mul_u32_u24 v4, 384, v4
  v_and_b32 v5, 3, v2
  v_lshl_add_u32 v4, v5, 3, v4
  v_add_u32 v4, 65536, v4
  v_bfe_u32 v5, v2, 3, 1
  v_and_b32 v6, 1, v3
  v_lshl_add_u32 v5, v6, 1, v5
  s_mul_i32 s23, s20, 3
  s_add_u32 s23, s23, 0
  v_xor_b32 v6, s23, v5
  v_lshl_add_u32 v24, v6, 5, v4
  s_mul_i32 s23, s20, 3
  s_add_u32 s23, s23, 1
  v_xor_b32 v6, s23, v5
  v_lshl_add_u32 v25, v6, 5, v4
  s_mul_i32 s23, s20, 3
  s_add_u32 s23, s23, 2
  v_xor_b32 v6, s23, v5
  v_lshl_add_u32 v26, v6, 5, v4
  s_waitcnt vmcnt(4)
  v_lshlrev_b32 v80, 16, v32
  v_and_b32 v81, 0xffff0000, v32
  v_lshlrev_b32 v82, 16, v33
  v_and_b32 v83, 0xffff0000, v33
  v_lshlrev_b32 v84, 16, v34
  v_and_b32 v85, 0xffff0000, v34
  v_lshlrev_b32 v86, 16, v35
  v_and_b32 v87, 0xffff0000, v35
  v_lshlrev_b32 v88, 16, v36
  v_and_b32 v89, 0xffff0000, v36
  v_lshlrev_b32 v90, 16, v37
  v_and_b32 v91, 0xffff0000, v37
  v_lshlrev_b32 v92, 16, v38
  v_and_b32 v93, 0xffff0000, v38
  v_lshlrev_b32 v94, 16, v39
  v_and_b32 v95, 0xffff0000, v39
  v_lshlrev_b32 v96, 16, v40
  v_and_b32 v97, 0xffff0000, v40
  v_lshlrev_b32 v98, 16, v41
  v_and_b32 v99, 0xffff0000, v41
  v_lshlrev_b32 v100, 16, v42
  v_and_b32 v101, 0xffff0000, v42
  v_lshlrev_b32 v102, 16, v43
  v_and_b32 v103, 0xffff0000, v43
  v_lshlrev_b32 v104, 16, v44
  v_and_b32 v105, 0xffff0000, v44
  v_lshlrev_b32 v106, 16, v45
  v_and_b32 v107, 0xffff0000, v45
  v_lshlrev_b32 v108, 16, v46
  v_and_b32 v109, 0xffff0000, v46
  v_lshlrev_b32 v110, 16, v47
  v_and_b32 v111, 0xffff0000, v47
  v_pk_add_f32 v[4:5], v[80:81], v[82:83]
  v_pk_mul_f32 v[6:7], v[80:81], v[80:81]
  v_pk_fma_f32 v[6:7], v[82:83], v[82:83], v[6:7]
  v_pk_add_f32 v[4:5], v[4:5], v[84:85]
  v_pk_fma_f32 v[6:7], v[84:85], v[84:85], v[6:7]
  v_pk_add_f32 v[4:5], v[4:5], v[86:87]
  v_pk_fma_f32 v[6:7], v[86:87], v[86:87], v[6:7]
  v_pk_add_f32 v[4:5], v[4:5], v[88:89]
  v_pk_fma_f32 v[6:7], v[88:89], v[88:89], v[6:7]
  v_pk_add_f32 v[4:5], v[4:5], v[90:91]
  v_pk_fma_f32 v[6:7], v[90:91], v[90:91], v[6:7]
  v_pk_add_f32 v[4:5], v[4:5], v[92:93]
  v_pk_fma_f32 v[6:7], v[92:93], v[92:93], v[6:7]
  v_pk_add_f32 v[4:5], v[4:5], v[94:95]
  v_pk_fma_f32 v[6:7], v[94:95], v[94:95], v[6:7]
  v_pk_add_f32 v[4:5], v[4:5], v[96:97]
  v_pk_fma_f32 v[6:7], v[96:97], v[96:97], v[6:7]
  v_pk_add_f32 v[4:5], v[4:5], v[98:99]
  v_pk_fma_f32 v[6:7], v[98:99], v[98:99], v[6:7]
  v_pk_add_f32 v[4:5], v[4:5], v[100:101]
  v_pk_fma_f32 v[6:7], v[100:101], v[100:101], v[6:7]
  v_pk_add_f32 v[4:5], v[4:5], v[102:103]
  v_pk_fma_f32 v[6:7], v[102:103], v[102:103], v[6:7]
  v_pk_add_f32 v[4:5], v[4:5], v[104:105]
  v_pk_fma_f32 v[6:7], v[104:105], v[104:105], v[6:7]
  v_pk_add_f32 v[4:5], v[4:5], v[106:107]
  v_pk_fma_f32 v[6:7], v[106:107], v[106:107], v[6:7]
  v_pk_add_f32 v[4:5], v[4:5], v[108:109]
  v_pk_fma_f32 v[6:7], v[108:109], v[108:109], v[6:7]
  v_pk_add_f32 v[4:5], v[4:5], v[110:111]
  v_pk_fma_f32 v[6:7], v[110:111], v[110:111], v[6:7]
  v_add_f32 v4, v4, v5
  v_add_f32 v6, v6, v7
  s_nop 1
  v_add_f32_dpp v4, v4, v4 row_ror:8 row_mask:0xf bank_mask:0xf
  v_add_f32_dpp v6, v6, v6 row_ror:8 row_mask:0xf bank_mask:0xf
  s_nop 1
  v_add_f32_dpp v4, v4, v4 row_ror:4 row_mask:0xf bank_mask:0xf
  v_add_f32_dpp v6, v6, v6 row_ror:4 row_mask:0xf bank_mask:0xf
  s_nop 1
  v_add_f32_dpp v4, v4, v4 row_ror:2 row_mask:0xf bank_mask:0xf
  v_add_f32_dpp v6, v6, v6 row_ror:2 row_mask:0xf bank_mask:0xf
  s_nop 1
  v_add_f32_dpp v4, v4, v4 row_ror:1 row_mask:0xf bank_mask:0xf
  v_add_f32_dpp v6, v6, v6 row_ror:1 row_mask:0xf bank_mask:0xf
  v_mul_f32 v4, 0x3b000000, v4
  v_mul_f32 v6, 0x3b000000, v6
  v_fma_f32 v6, -v4, v4, v6
  v_max_f32 v6, 0, v6
  v_cvt_pk_bf16_f32 v112, v4, v4
  v_lshlrev_b32 v112, 16, v112
  v_cvt_pk_bf16_f32 v30, v6, v6
  v_lshlrev_b32 v30, 16, v30
  v_add_f32 v30, 0x3727c5ac, v30
  v_cvt_pk_bf16_f32 v30, v30, v30
  v_lshlrev_b32 v30, 16, v30
  v_sqrt_f32 v15, v30
  s_nop 0
  v_cvt_pk_bf16_f32 v15, v15, v15
  v_lshlrev_b32 v15, 16, v15
  v_rcp_f32 v114, v15
  s_nop 0
  v_sub_f32 v112, 0, v112
  v_mov_b32 v113, v112
  v_mov_b32 v115, v114
  v_pk_add_f32 v[80:81], v[80:81], v[112:113]
  v_cvt_pk_bf16_f32 v32, v80, v81
  v_lshlrev_b32 v80, 16, v32
  v_and_b32 v81, 0xffff0000, v32
  v_pk_mul_f32 v[80:81], v[80:81], v[114:115]
  v_cvt_pk_bf16_f32 v32, v80, v81
  v_pk_add_f32 v[82:83], v[82:83], v[112:113]
  v_cvt_pk_bf16_f32 v33, v82, v83
  v_lshlrev_b32 v82, 16, v33
  v_and_b32 v83, 0xffff0000, v33
  v_pk_mul_f32 v[82:83], v[82:83], v[114:115]
  v_cvt_pk_bf16_f32 v33, v82, v83
  v_pk_add_f32 v[84:85], v[84:85], v[112:113]
  v_cvt_pk_bf16_f32 v34, v84, v85
  v_lshlrev_b32 v84, 16, v34
  v_and_b32 v85, 0xffff0000, v34
  v_pk_mul_f32 v[84:85], v[84:85], v[114:115]
  v_cvt_pk_bf16_f32 v34, v84, v85
  v_pk_add_f32 v[86:87], v[86:87], v[112:113]
  v_cvt_pk_bf16_f32 v35, v86, v87
  v_lshlrev_b32 v86, 16, v35
  v_and_b32 v87, 0xffff0000, v35
  v_pk_mul_f32 v[86:87], v[86:87], v[114:115]
  v_cvt_pk_bf16_f32 v35, v86, v87
  v_pk_add_f32 v[88:89], v[88:89], v[112:113]
  v_cvt_pk_bf16_f32 v36, v88, v89
  v_lshlrev_b32 v88, 16, v36
  v_and_b32 v89, 0xffff0000, v36
  v_pk_mul_f32 v[88:89], v[88:89], v[114:115]
  v_cvt_pk_bf16_f32 v36, v88, v89
  v_pk_add_f32 v[90:91], v[90:91], v[112:113]
  v_cvt_pk_bf16_f32 v37, v90, v91
  v_lshlrev_b32 v90, 16, v37
  v_and_b32 v91, 0xffff0000, v37
  v_pk_mul_f32 v[90:91], v[90:91], v[114:115]
  v_cvt_pk_bf16_f32 v37, v90, v91
  v_pk_add_f32 v[92:93], v[92:93], v[112:113]
  v_cvt_pk_bf16_f32 v38, v92, v93
  v_lshlrev_b32 v92, 16, v38
  v_and_b32 v93, 0xffff0000, v38
  v_pk_mul_f32 v[92:93], v[92:93], v[114:115]
  v_cvt_pk_bf16_f32 v38, v92, v93
  v_pk_add_f32 v[94:95], v[94:95], v[112:113]
  v_cvt_pk_bf16_f32 v39, v94, v95
  v_lshlrev_b32 v94, 16, v39
  v_and_b32 v95, 0xffff0000, v39
  v_pk_mul_f32 v[94:95], v[94:95], v[114:115]
  v_cvt_pk_bf16_f32 v39, v94, v95
  v_pk_add_f32 v[96:97], v[96:97], v[112:113]
  v_cvt_pk_bf16_f32 v40, v96, v97
  v_lshlrev_b32 v96, 16, v40
  v_and_b32 v97, 0xffff0000, v40
  v_pk_mul_f32 v[96:97], v[96:97], v[114:115]
  v_cvt_pk_bf16_f32 v40, v96, v97
  v_pk_add_f32 v[98:99], v[98:99], v[112:113]
  v_cvt_pk_bf16_f32 v41, v98, v99
  v_lshlrev_b32 v98, 16, v41
  v_and_b32 v99, 0xffff0000, v41
  v_pk_mul_f32 v[98:99], v[98:99], v[114:115]
  v_cvt_pk_bf16_f32 v41, v98, v99
  v_pk_add_f32 v[100:101], v[100:101], v[112:113]
  v_cvt_pk_bf16_f32 v42, v100, v101
  v_lshlrev_b32 v100, 16, v42
  v_and_b32 v101, 0xffff0000, v42
  v_pk_mul_f32 v[100:101], v[100:101], v[114:115]
  v_cvt_pk_bf16_f32 v42, v100, v101
  v_pk_add_f32 v[102:103], v[102:103], v[112:113]
  v_cvt_pk_bf16_f32 v43, v102, v103
  v_lshlrev_b32 v102, 16, v43
  v_and_b32 v103, 0xffff0000, v43
  v_pk_mul_f32 v[102:103], v[102:103], v[114:115]
  v_cvt_pk_bf16_f32 v43, v102, v103
  v_pk_add_f32 v[104:105], v[104:105], v[112:113]
  v_cvt_pk_bf16_f32 v44, v104, v105
  v_lshlrev_b32 v104, 16, v44
  v_and_b32 v105, 0xffff0000, v44
  v_pk_mul_f32 v[104:105], v[104:105], v[114:115]
  v_cvt_pk_bf16_f32 v44, v104, v105
  v_pk_add_f32 v[106:107], v[106:107], v[112:113]
  v_cvt_pk_bf16_f32 v45, v106, v107
  v_lshlrev_b32 v106, 16, v45
  v_and_b32 v107, 0xffff0000, v45
  v_pk_mul_f32 v[106:107], v[106:107], v[114:115]
  v_cvt_pk_bf16_f32 v45, v106, v107
  v_pk_add_f32 v[108:109], v[108:109], v[112:113]
  v_cvt_pk_bf16_f32 v46, v108, v109
  v_lshlrev_b32 v108, 16, v46
  v_and_b32 v109, 0xffff0000, v46
  v_pk_mul_f32 v[108:109], v[108:109], v[114:115]
  v_cvt_pk_bf16_f32 v46, v108, v109
  v_pk_add_f32 v[110:111], v[110:111], v[112:113]
  v_cvt_pk_bf16_f32 v47, v110, v111
  v_lshlrev_b32 v110, 16, v47
  v_and_b32 v111, 0xffff0000, v47
  v_pk_mul_f32 v[110:111], v[110:111], v[114:115]
  v_cvt_pk_bf16_f32 v47, v110, v111
  ds_write_b128 v13, v[32:35] offset:0
  ds_write_b128 v13, v[36:39] offset:256
  ds_write_b128 v13, v[40:43] offset:512
  ds_write_b128 v13, v[44:47] offset:768
  s_waitcnt vmcnt(0)
  v_lshlrev_b32 v80, 16, v48
  v_and_b32 v81, 0xffff0000, v48
  v_lshlrev_b32 v82, 16, v49
  v_and_b32 v83, 0xffff0000, v49
  v_lshlrev_b32 v84, 16, v50
  v_and_b32 v85, 0xffff0000, v50
  v_lshlrev_b32 v86, 16, v51
  v_and_b32 v87, 0xffff0000, v51
  v_lshlrev_b32 v88, 16, v52
  v_and_b32 v89, 0xffff0000, v52
  v_lshlrev_b32 v90, 16, v53
  v_and_b32 v91, 0xffff0000, v53
  v_lshlrev_b32 v92, 16, v54
  v_and_b32 v93, 0xffff0000, v54
  v_lshlrev_b32 v94, 16, v55
  v_and_b32 v95, 0xffff0000, v55
  v_lshlrev_b32 v96, 16, v56
  v_and_b32 v97, 0xffff0000, v56
  v_lshlrev_b32 v98, 16, v57
  v_and_b32 v99, 0xffff0000, v57
  v_lshlrev_b32 v100, 16, v58
  v_and_b32 v101, 0xffff0000, v58
  v_lshlrev_b32 v102, 16, v59
  v_and_b32 v103, 0xffff0000, v59
  v_lshlrev_b32 v104, 16, v60
  v_and_b32 v105, 0xffff0000, v60
  v_lshlrev_b32 v106, 16, v61
  v_and_b32 v107, 0xffff0000, v61
  v_lshlrev_b32 v108, 16, v62
  v_and_b32 v109, 0xffff0000, v62
  v_lshlrev_b32 v110, 16, v63
  v_and_b32 v111, 0xffff0000, v63
  v_pk_add_f32 v[4:5], v[80:81], v[82:83]
  v_pk_mul_f32 v[6:7], v[80:81], v[80:81]
  v_pk_fma_f32 v[6:7], v[82:83], v[82:83], v[6:7]
  v_pk_add_f32 v[4:5], v[4:5], v[84:85]
  v_pk_fma_f32 v[6:7], v[84:85], v[84:85], v[6:7]
  v_pk_add_f32 v[4:5], v[4:5], v[86:87]
  v_pk_fma_f32 v[6:7], v[86:87], v[86:87], v[6:7]
  v_pk_add_f32 v[4:5], v[4:5], v[88:89]
  v_pk_fma_f32 v[6:7], v[88:89], v[88:89], v[6:7]
  v_pk_add_f32 v[4:5], v[4:5], v[90:91]
  v_pk_fma_f32 v[6:7], v[90:91], v[90:91], v[6:7]
  v_pk_add_f32 v[4:5], v[4:5], v[92:93]
  v_pk_fma_f32 v[6:7], v[92:93], v[92:93], v[6:7]
  v_pk_add_f32 v[4:5], v[4:5], v[94:95]
  v_pk_fma_f32 v[6:7], v[94:95], v[94:95], v[6:7]
  v_pk_add_f32 v[4:5], v[4:5], v[96:97]
  v_pk_fma_f32 v[6:7], v[96:97], v[96:97], v[6:7]
  v_pk_add_f32 v[4:5], v[4:5], v[98:99]
  v_pk_fma_f32 v[6:7], v[98:99], v[98:99], v[6:7]
  v_pk_add_f32 v[4:5], v[4:5], v[100:101]
  v_pk_fma_f32 v[6:7], v[100:101], v[100:101], v[6:7]
  v_pk_add_f32 v[4:5], v[4:5], v[102:103]
  v_pk_fma_f32 v[6:7], v[102:103], v[102:103], v[6:7]
  v_pk_add_f32 v[4:5], v[4:5], v[104:105]
  v_pk_fma_f32 v[6:7], v[104:105], v[104:105], v[6:7]
  v_pk_add_f32 v[4:5], v[4:5], v[106:107]
  v_pk_fma_f32 v[6:7], v[106:107], v[106:107], v[6:7]
  v_pk_add_f32 v[4:5], v[4:5], v[108:109]
  v_pk_fma_f32 v[6:7], v[108:109], v[108:109], v[6:7]
  v_pk_add_f32 v[4:5], v[4:5], v[110:111]
  v_pk_fma_f32 v[6:7], v[110:111], v[110:111], v[6:7]
  v_add_f32 v4, v4, v5
  v_add_f32 v6, v6, v7
  s_nop 1
  v_add_f32_dpp v4, v4, v4 row_ror:8 row_mask:0xf bank_mask:0xf
  v_add_f32_dpp v6, v6, v6 row_ror:8 row_mask:0xf bank_mask:0xf
  s_nop 1
  v_add_f32_dpp v4, v4, v4 row_ror:4 row_mask:0xf bank_mask:0xf
  v_add_f32_dpp v6, v6, v6 row_ror:4 row_mask:0xf bank_mask:0xf
  s_nop 1
  v_add_f32_dpp v4, v4, v4 row_ror:2 row_mask:0xf bank_mask:0xf
  v_add_f32_dpp v6, v6, v6 row_ror:2 row_mask:0xf bank_mask:0xf
  s_nop 1
  v_add_f32_dpp v4, v4, v4 row_ror:1 row_mask:0xf bank_mask:0xf
  v_add_f32_dpp v6, v6, v6 row_ror:1 row_mask:0xf bank_mask:0xf
  v_mul_f32 v4, 0x3b000000, v4
  v_mul_f32 v6, 0x3b000000, v6
  v_fma_f32 v6, -v4, v4, v6
  v_max_f32 v6, 0, v6
  v_cvt_pk_bf16_f32 v112, v4, v4
  v_lshlrev_b32 v112, 16, v112
  v_cvt_pk_bf16_f32 v30, v6, v6
  v_lshlrev_b32 v30, 16, v30
  v_add_f32 v30, 0x3727c5ac, v30
  v_cvt_pk_bf16_f32 v30, v30, v30
  v_lshlrev_b32 v30, 16, v30
  v_sqrt_f32 v15, v30
  s_nop 0
  v_cvt_pk_bf16_f32 v15, v15, v15
  v_lshlrev_b32 v15, 16, v15
  v_rcp_f32 v114, v15
  s_nop 0
  v_sub_f32 v112, 0, v112
  v_mov_b32 v113, v112
  v_mov_b32 v115, v114
  v_pk_add_f32 v[80:81], v[80:81], v[112:113]
  v_cvt_pk_bf16_f32 v48, v80, v81
  v_lshlrev_b32 v80, 16, v48
  v_and_b32 v81, 0xffff0000, v48
  v_pk_mul_f32 v[80:81], v[80:81], v[114:115]
  v_cvt_pk_bf16_f32 v48, v80, v81
  v_pk_add_f32 v[82:83], v[82:83], v[112:113]
  v_cvt_pk_bf16_f32 v49, v82, v83
  v_lshlrev_b32 v82, 16, v49
  v_and_b32 v83, 0xffff0000, v49
  v_pk_mul_f32 v[82:83], v[82:83], v[114:115]
  v_cvt_pk_bf16_f32 v49, v82, v83
  v_pk_add_f32 v[84:85], v[84:85], v[112:113]
  v_cvt_pk_bf16_f32 v50, v84, v85
  v_lshlrev_b32 v84, 16, v50
  v_and_b32 v85, 0xffff0000, v50
  v_pk_mul_f32 v[84:85], v[84:85], v[114:115]
  v_cvt_pk_bf16_f32 v50, v84, v85
  v_pk_add_f32 v[86:87], v[86:87], v[112:113]
  v_cvt_pk_bf16_f32 v51, v86, v87
  v_lshlrev_b32 v86, 16, v51
  v_and_b32 v87, 0xffff0000, v51
  v_pk_mul_f32 v[86:87], v[86:87], v[114:115]
  v_cvt_pk_bf16_f32 v51, v86, v87
  v_pk_add_f32 v[88:89], v[88:89], v[112:113]
  v_cvt_pk_bf16_f32 v52, v88, v89
  v_lshlrev_b32 v88, 16, v52
  v_and_b32 v89, 0xffff0000, v52
  v_pk_mul_f32 v[88:89], v[88:89], v[114:115]
  v_cvt_pk_bf16_f32 v52, v88, v89
  v_pk_add_f32 v[90:91], v[90:91], v[112:113]
  v_cvt_pk_bf16_f32 v53, v90, v91
  v_lshlrev_b32 v90, 16, v53
  v_and_b32 v91, 0xffff0000, v53
  v_pk_mul_f32 v[90:91], v[90:91], v[114:115]
  v_cvt_pk_bf16_f32 v53, v90, v91
  v_pk_add_f32 v[92:93], v[92:93], v[112:113]
  v_cvt_pk_bf16_f32 v54, v92, v93
  v_lshlrev_b32 v92, 16, v54
  v_and_b32 v93, 0xffff0000, v54
  v_pk_mul_f32 v[92:93], v[92:93], v[114:115]
  v_cvt_pk_bf16_f32 v54, v92, v93
  v_pk_add_f32 v[94:95], v[94:95], v[112:113]
  v_cvt_pk_bf16_f32 v55, v94, v95
  v_lshlrev_b32 v94, 16, v55
  v_and_b32 v95, 0xffff0000, v55
  v_pk_mul_f32 v[94:95], v[94:95], v[114:115]
  v_cvt_pk_bf16_f32 v55, v94, v95
  v_pk_add_f32 v[96:97], v[96:97], v[112:113]
  v_cvt_pk_bf16_f32 v56, v96, v97
  v_lshlrev_b32 v96, 16, v56
  v_and_b32 v97, 0xffff0000, v56
  v_pk_mul_f32 v[96:97], v[96:97], v[114:115]
  v_cvt_pk_bf16_f32 v56, v96, v97
  v_pk_add_f32 v[98:99], v[98:99], v[112:113]
  v_cvt_pk_bf16_f32 v57, v98, v99
  v_lshlrev_b32 v98, 16, v57
  v_and_b32 v99, 0xffff0000, v57
  v_pk_mul_f32 v[98:99], v[98:99], v[114:115]
  v_cvt_pk_bf16_f32 v57, v98, v99
  v_pk_add_f32 v[100:101], v[100:101], v[112:113]
  v_cvt_pk_bf16_f32 v58, v100, v101
  v_lshlrev_b32 v100, 16, v58
  v_and_b32 v101, 0xffff0000, v58
  v_pk_mul_f32 v[100:101], v[100:101], v[114:115]
  v_cvt_pk_bf16_f32 v58, v100, v101
  v_pk_add_f32 v[102:103], v[102:103], v[112:113]
  v_cvt_pk_bf16_f32 v59, v102, v103
  v_lshlrev_b32 v102, 16, v59
  v_and_b32 v103, 0xffff0000, v59
  v_pk_mul_f32 v[102:103], v[102:103], v[114:115]
  v_cvt_pk_bf16_f32 v59, v102, v103
  v_pk_add_f32 v[104:105], v[104:105], v[112:113]
  v_cvt_pk_bf16_f32 v60, v104, v105
  v_lshlrev_b32 v104, 16, v60
  v_and_b32 v105, 0xffff0000, v60
  v_pk_mul_f32 v[104:105], v[104:105], v[114:115]
  v_cvt_pk_bf16_f32 v60, v104, v105
  v_pk_add_f32 v[106:107], v[106:107], v[112:113]
  v_cvt_pk_bf16_f32 v61, v106, v107
  v_lshlrev_b32 v106, 16, v61
  v_and_b32 v107, 0xffff0000, v61
  v_pk_mul_f32 v[106:107], v[106:107], v[114:115]
  v_cvt_pk_bf16_f32 v61, v106, v107
  v_pk_add_f32 v[108:109], v[108:109], v[112:113]
  v_cvt_pk_bf16_f32 v62, v108, v109
  v_lshlrev_b32 v108, 16, v62
  v_and_b32 v109, 0xffff0000, v62
  v_pk_mul_f32 v[108:109], v[108:109], v[114:115]
  v_cvt_pk_bf16_f32 v62, v108, v109
  v_pk_add_f32 v[110:111], v[110:111], v[112:113]
  v_cvt_pk_bf16_f32 v63, v110, v111
  v_lshlrev_b32 v110, 16, v63
  v_and_b32 v111, 0xffff0000, v63
  v_pk_mul_f32 v[110:111], v[110:111], v[114:115]
  v_cvt_pk_bf16_f32 v63, v110, v111
  ds_write_b128 v13, v[48:51] offset:32768
  ds_write_b128 v13, v[52:55] offset:33024
  ds_write_b128 v13, v[56:59] offset:33280
  ds_write_b128 v13, v[60:63] offset:33536
  s_waitcnt lgkmcnt(0)
  s_barrier
  v_mov_b32 v80, 0
  v_mov_b32 v81, 0
  v_mov_b32 v82, 0
  v_mov_b32 v83, 0
  v_mov_b32 v84, 0
  v_mov_b32 v85, 0
  v_mov_b32 v86, 0
  v_mov_b32 v87, 0
  v_mov_b32 v88, 0
  v_mov_b32 v89, 0
  v_mov_b32 v90, 0
  v_mov_b32 v91, 0
  v_mov_b32 v92, 0
  v_mov_b32 v93, 0
  v_mov_b32 v94, 0
  v_mov_b32 v95, 0
  v_mov_b32 v96, 0
  v_mov_b32 v97, 0
  v_mov_b32 v98, 0
  v_mov_b32 v99, 0
  v_mov_b32 v100, 0
  v_mov_b32 v101, 0
  v_mov_b32 v102, 0
  v_mov_b32 v103, 0
  ds_read_b128 v[32:35], v16 offset:0
  ds_read_b64_tr_b16 v[44:45], v24 offset:0
  ds_read_b64_tr_b16 v[46:47], v24 offset:1536
  ds_read_b128 v[36:39], v16 offset:16384
  ds_read_b64_tr_b16 v[48:49], v25 offset:0
  ds_read_b64_tr_b16 v[50:51], v25 offset:1536
  ds_read_b64_tr_b16 v[52:53], v26 offset:0
  ds_read_b64_tr_b16 v[54:55], v26 offset:1536
  s_waitcnt lgkmcnt(0)
  v_mfma_f32_16x16x32_bf16 v[80:83], v[44:47], v[32:35], v[80:83]
  ds_read_b128 v[56:59], v17 offset:0
  v_mfma_f32_16x16x32_bf16 v[92:95], v[44:47], v[36:39], v[92:95]
  ds_read_b64_tr_b16 v[68:69], v24 offset:12288
  ds_read_b64_tr_b16 v[70:71], v24 offset:13824
  v_mfma_f32_16x16x32_bf16 v[84:87], v[48:51], v[32:35], v[84:87]
  ds_read_b128 v[60:63], v17 offset:16384
  v_mfma_f32_16x16x32_bf16 v[96:99], v[48:51], v[36:39], v[96:99]
  ds_read_b64_tr_b16 v[72:73], v25 offset:12288
  ds_read_b64_tr_b16 v[74:75], v25 offset:13824
  v_mfma_f32_16x16x32_bf16 v[88:91], v[52:55], v[32:35], v[88:91]
  ds_read_b64_tr_b16 v[76:77], v26 offset:12288
  ds_read_b64_tr_b16 v[78:79], v26 offset:13824
  v_mfma_f32_16x16x32_bf16 v[100:103], v[52:55], v[36:39], v[100:103]
  s_waitcnt lgkmcnt(0)
  s_barrier
  v_mfma_f32_16x16x32_bf16 v[80:83], v[68:71], v[56:59], v[80:83]
  ds_read_b128 v[32:35], v18 offset:0
  v_mfma_f32_16x16x32_bf16 v[92:95], v[68:71], v[60:63], v[92:95]
  ds_read_b64_tr_b16 v[44:45], v24 offset:24576
  ds_read_b64_tr_b16 v[46:47], v24 offset:26112
  v_mfma_f32_16x16x32_bf16 v[84:87], v[72:75], v[56:59], v[84:87]
  ds_read_b128 v[36:39], v18 offset:16384
  v_mfma_f32_16x16x32_bf16 v[96:99], v[72:75], v[60:63], v[96:99]
  ds_read_b64_tr_b16 v[48:49], v25 offset:24576
  ds_read_b64_tr_b16 v[50:51], v25 offset:26112
  v_mfma_f32_16x16x32_bf16 v[88:91], v[76:79], v[56:59], v[88:91]
  ds_read_b64_tr_b16 v[52:53], v26 offset:24576
  ds_read_b64_tr_b16 v[54:55], v26 offset:26112
  v_mfma_f32_16x16x32_bf16 v[100:103], v[76:79], v[60:63], v[100:103]
  s_waitcnt lgkmcnt(0)
  v_mfma_f32_16x16x32_bf16 v[80:83], v[44:47], v[32:35], v[80:83]
  ds_read_b128 v[56:59], v19 offset:0
  v_mfma_f32_16x16x32_bf16 v[92:95], v[44:47], v[36:39], v[92:95]
  ds_read_b64_tr_b16 v[68:69], v24 offset:36864
  ds_read_b64_tr_b16 v[70:71], v24 offset:38400
  v_mfma_f32_16x16x32_bf16 v[84:87], v[48:51], v[32:35], v[84:87]
  ds_read_b128 v[60:63], v19 offset:16384
  v_mfma_f32_16x16x32_bf16 v[96:99], v[48:51], v[36:39], v[96:99]
  ds_read_b64_tr_b16 v[72:73], v25 offset:36864
  ds_read_b64_tr_b16 v[74:75], v25 offset:38400
  v_mfma_f32_16x16x32_bf16 v[88:91], v[52:55], v[32:35], v[88:91]
  ds_read_b64_tr_b16 v[76:77], v26 offset:36864
  ds_read_b64_tr_b16 v[78:79], v26 offset:38400
  v_mfma_f32_16x16x32_bf16 v[100:103], v[52:55], v[36:39], v[100:103]
  s_waitcnt lgkmcnt(0)
  s_barrier
  v_mfma_f32_16x16x32_bf16 v[80:83], v[68:71], v[56:59], v[80:83]
  ds_read_b128 v[32:35], v16 offset:256
  v_mfma_f32_16x16x32_bf16 v[92:95], v[68:71], v[60:63], v[92:95]
  ds_read_b64_tr_b16 v[44:45], v24 offset:49152
  ds_read_b64_tr_b16 v[46:47], v24 offset:50688
  v_mfma_f32_16x16x32_bf16 v[84:87], v[72:75], v[56:59], v[84:87]
  ds_read_b128 v[36:39], v16 offset:16640
  v_mfma_f32_16x16x32_bf16 v[96:99], v[72:75], v[60:63], v[96:99]
  ds_read_b64_tr_b16 v[48:49], v25 offset:49152
  ds_read_b64_tr_b16 v[50:51], v25 offset:50688
  v_mfma_f32_16x16x32_bf16 v[88:91], v[76:79], v[56:59], v[88:91]
  ds_read_b64_tr_b16 v[52:53], v26 offset:49152
  ds_read_b64_tr_b16 v[54:55], v26 offset:50688
  v_mfma_f32_16x16x32_bf16 v[100:103], v[76:79], v[60:63], v[100:103]
  s_waitcnt lgkmcnt(0)
  v_mfma_f32_16x16x32_bf16 v[80:83], v[44:47], v[32:35], v[80:83]
  ds_read_b128 v[56:59], v17 offset:256
  v_mfma_f32_16x16x32_bf16 v[92:95], v[44:47], v[36:39], v[92:95]
  ds_read_b64_tr_b16 v[68:69], v24 offset:61440
  ds_read_b64_tr_b16 v[70:71], v24 offset:62976
  v_mfma_f32_16x16x32_bf16 v[84:87], v[48:51], v[32:35], v[84:87]
  ds_read_b128 v[60:63], v17 offset:16640
  v_mfma_f32_16x16x32_bf16 v[96:99], v[48:51], v[36:39], v[96:99]
  ds_read_b64_tr_b16 v[72:73], v25 offset:61440
  ds_read_b64_tr_b16 v[74:75], v25 offset:62976
  v_mfma_f32_16x16x32_bf16 v[88:91], v[52:55], v[32:35], v[88:91]
  ds_read_b64_tr_b16 v[76:77], v26 offset:61440
  ds_read_b64_tr_b16 v[78:79], v26 offset:62976
  v_mfma_f32_16x16x32_bf16 v[100:103], v[52:55], v[36:39], v[100:103]
  s_waitcnt lgkmcnt(0)
  s_barrier
  v_mfma_f32_16x16x32_bf16 v[80:83], v[68:71], v[56:59], v[80:83]
  ds_read_b128 v[32:35], v18 offset:256
  v_mfma_f32_16x16x32_bf16 v[92:95], v[68:71], v[60:63], v[92:95]
  ds_read_b64_tr_b16 v[44:45], v24 offset:0
  ds_read_b64_tr_b16 v[46:47], v24 offset:1536
  v_mfma_f32_16x16x32_bf16 v[84:87], v[72:75], v[56:59], v[84:87]
  ds_read_b128 v[36:39], v18 offset:16640
  v_mfma_f32_16x16x32_bf16 v[96:99], v[72:75], v[60:63], v[96:99]
  ds_read_b64_tr_b16 v[48:49], v25 offset:0
  ds_read_b64_tr_b16 v[50:51], v25 offset:1536
  v_mfma_f32_16x16x32_bf16 v[88:91], v[76:79], v[56:59], v[88:91]
  ds_read_b64_tr_b16 v[52:53], v26 offset:0
  ds_read_b64_tr_b16 v[54:55], v26 offset:1536
  v_mfma_f32_16x16x32_bf16 v[100:103], v[76:79], v[60:63], v[100:103]
  s_waitcnt lgkmcnt(0)
  v_mfma_f32_16x16x32_bf16 v[80:83], v[44:47], v[32:35], v[80:83]
  ds_read_b128 v[56:59], v19 offset:256
  v_mfma_f32_16x16x32_bf16 v[92:95], v[44:47], v[36:39], v[92:95]
  ds_read_b64_tr_b16 v[68:69], v24 offset:12288
  ds_read_b64_tr_b16 v[70:71], v24 offset:13824
  v_mfma_f32_16x16x32_bf16 v[84:87], v[48:51], v[32:35], v[84:87]
  ds_read_b128 v[60:63], v19 offset:16640
  v_mfma_f32_16x16x32_bf16 v[96:99], v[48:51], v[36:39], v[96:99]
  ds_read_b64_tr_b16 v[72:73], v25 offset:12288
  ds_read_b64_tr_b16 v[74:75], v25 offset:13824
  v_mfma_f32_16x16x32_bf16 v[88:91], v[52:55], v[32:35], v[88:91]
  ds_read_b64_tr_b16 v[76:77], v26 offset:12288
  ds_read_b64_tr_b16 v[78:79], v26 offset:13824
  v_mfma_f32_16x16x32_bf16 v[100:103], v[52:55], v[36:39], v[100:103]
  s_waitcnt lgkmcnt(0)
  s_barrier
  v_mfma_f32_16x16x32_bf16 v[80:83], v[68:71], v[56:59], v[80:83]
  ds_read_b128 v[32:35], v16 offset:512
  v_mfma_f32_16x16x32_bf16 v[92:95], v[68:71], v[60:63], v[92:95]
  ds_read_b64_tr_b16 v[44:45], v24 offset:24576
  ds_read_b64_tr_b16 v[46:47], v24 offset:26112
  v_mfma_f32_16x16x32_bf16 v[84:87], v[72:75], v[56:59], v[84:87]
  ds_read_b128 v[36:39], v16 offset:16896
  v_mfma_f32_16x16x32_bf16 v[96:99], v[72:75], v[60:63], v[96:99]
  ds_read_b64_tr_b16 v[48:49], v25 offset:24576
  ds_read_b64_tr_b16 v[50:51], v25 offset:26112
  v_mfma_f32_16x16x32_bf16 v[88:91], v[76:79], v[56:59], v[88:91]
  ds_read_b64_tr_b16 v[52:53], v26 offset:24576
  ds_read_b64_tr_b16 v[54:55], v26 offset:26112
  v_mfma_f32_16x16x32_bf16 v[100:103], v[76:79], v[60:63], v[100:103]
  s_waitcnt lgkmcnt(0)
  v_mfma_f32_16x16x32_bf16 v[80:83], v[44:47], v[32:35], v[80:83]
  ds_read_b128 v[56:59], v17 offset:512
  v_mfma_f32_16x16x32_bf16 v[92:95], v[44:47], v[36:39], v[92:95]
  ds_read_b64_tr_b16 v[68:69], v24 offset:36864
  ds_read_b64_tr_b16 v[70:71], v24 offset:38400
  v_mfma_f32_16x16x32_bf16 v[84:87], v[48:51], v[32:35], v[84:87]
  ds_read_b128 v[60:63], v17 offset:16896
  v_mfma_f32_16x16x32_bf16 v[96:99], v[48:51], v[36:39], v[96:99]
  ds_read_b64_tr_b16 v[72:73], v25 offset:36864
  ds_read_b64_tr_b16 v[74:75], v25 offset:38400
  v_mfma_f32_16x16x32_bf16 v[88:91], v[52:55], v[32:35], v[88:91]
  ds_read_b64_tr_b16 v[76:77], v26 offset:36864
  ds_read_b64_tr_b16 v[78:79], v26 offset:38400
  v_mfma_f32_16x16x32_bf16 v[100:103], v[52:55], v[36:39], v[100:103]
  s_waitcnt lgkmcnt(0)
  s_barrier
  v_mfma_f32_16x16x32_bf16 v[80:83], v[68:71], v[56:59], v[80:83]
  ds_read_b128 v[32:35], v18 offset:512
  v_mfma_f32_16x16x32_bf16 v[92:95], v[68:71], v[60:63], v[92:95]
  ds_read_b64_tr_b16 v[44:45], v24 offset:49152
  ds_read_b64_tr_b16 v[46:47], v24 offset:50688
  v_mfma_f32_16x16x32_bf16 v[84:87], v[72:75], v[56:59], v[84:87]
  ds_read_b128 v[36:39], v18 offset:16896
  v_mfma_f32_16x16x32_bf16 v[96:99], v[72:75], v[60:63], v[96:99]
  ds_read_b64_tr_b16 v[48:49], v25 offset:49152
  ds_read_b64_tr_b16 v[50:51], v25 offset:50688
  v_mfma_f32_16x16x32_bf16 v[88:91], v[76:79], v[56:59], v[88:91]
  ds_read_b64_tr_b16 v[52:53], v26 offset:49152
  ds_read_b64_tr_b16 v[54:55], v26 offset:50688
  v_mfma_f32_16x16x32_bf16 v[100:103], v[76:79], v[60:63], v[100:103]
  s_waitcnt lgkmcnt(0)
  v_mfma_f32_16x16x32_bf16 v[80:83], v[44:47], v[32:35], v[80:83]
  ds_read_b128 v[56:59], v19 offset:512
  v_mfma_f32_16x16x32_bf16 v[92:95], v[44:47], v[36:39], v[92:95]
  ds_read_b64_tr_b16 v[68:69], v24 offset:61440
  ds_read_b64_tr_b16 v[70:71], v24 offset:62976
  v_mfma_f32_16x16x32_bf16 v[84:87], v[48:51], v[32:35], v[84:87]
  ds_read_b128 v[60:63], v19 offset:16896
  v_mfma_f32_16x16x32_bf16 v[96:99], v[48:51], v[36:39], v[96:99]
  ds_read_b64_tr_b16 v[72:73], v25 offset:61440
  ds_read_b64_tr_b16 v[74:75], v25 offset:62976
  v_mfma_f32_16x16x32_bf16 v[88:91], v[52:55], v[32:35], v[88:91]
  ds_read_b64_tr_b16 v[76:77], v26 offset:61440
  ds_read_b64_tr_b16 v[78:79], v26 offset:62976
  v_mfma_f32_16x16x32_bf16 v[100:103], v[52:55], v[36:39], v[100:103]
  s_waitcnt lgkmcnt(0)
  s_barrier
  v_mfma_f32_16x16x32_bf16 v[80:83], v[68:71], v[56:59], v[80:83]
  ds_read_b128 v[32:35], v16 offset:768
  v_mfma_f32_16x16x32_bf16 v[92:95], v[68:71], v[60:63], v[92:95]
  ds_read_b64_tr_b16 v[44:45], v24 offset:0
  ds_read_b64_tr_b16 v[46:47], v24 offset:1536
  v_mfma_f32_16x16x32_bf16 v[84:87], v[72:75], v[56:59], v[84:87]
  ds_read_b128 v[36:39], v16 offset:17152
  v_mfma_f32_16x16x32_bf16 v[96:99], v[72:75], v[60:63], v[96:99]
  ds_read_b64_tr_b16 v[48:49], v25 offset:0
  ds_read_b64_tr_b16 v[50:51], v25 offset:1536
  v_mfma_f32_16x16x32_bf16 v[88:91], v[76:79], v[56:59], v[88:91]
  ds_read_b64_tr_b16 v[52:53], v26 offset:0
  ds_read_b64_tr_b16 v[54:55], v26 offset:1536
  v_mfma_f32_16x16x32_bf16 v[100:103], v[76:79], v[60:63], v[100:103]
  s_waitcnt lgkmcnt(0)
  v_mfma_f32_16x16x32_bf16 v[80:83], v[44:47], v[32:35], v[80:83]
  ds_read_b128 v[56:59], v17 offset:768
  v_mfma_f32_16x16x32_bf16 v[92:95], v[44:47], v[36:39], v[92:95]
  ds_read_b64_tr_b16 v[68:69], v24 offset:12288
  ds_read_b64_tr_b16 v[70:71], v24 offset:13824
  v_mfma_f32_16x16x32_bf16 v[84:87], v[48:51], v[32:35], v[84:87]
  ds_read_b128 v[60:63], v17 offset:17152
  v_mfma_f32_16x16x32_bf16 v[96:99], v[48:51], v[36:39], v[96:99]
  ds_read_b64_tr_b16 v[72:73], v25 offset:12288
  ds_read_b64_tr_b16 v[74:75], v25 offset:13824
  v_mfma_f32_16x16x32_bf16 v[88:91], v[52:55], v[32:35], v[88:91]
  ds_read_b64_tr_b16 v[76:77], v26 offset:12288
  ds_read_b64_tr_b16 v[78:79], v26 offset:13824
  v_mfma_f32_16x16x32_bf16 v[100:103], v[52:55], v[36:39], v[100:103]
  s_waitcnt lgkmcnt(0)
  s_barrier
  v_mfma_f32_16x16x32_bf16 v[80:83], v[68:71], v[56:59], v[80:83]
  ds_read_b128 v[32:35], v18 offset:768
  v_mfma_f32_16x16x32_bf16 v[92:95], v[68:71], v[60:63], v[92:95]
  ds_read_b64_tr_b16 v[44:45], v24 offset:24576
  ds_read_b64_tr_b16 v[46:47], v24 offset:26112
  v_mfma_f32_16x16x32_bf16 v[84:87], v[72:75], v[56:59], v[84:87]
  ds_read_b128 v[36:39], v18 offset:17152
  v_mfma_f32_16x16x32_bf16 v[96:99], v[72:75], v[60:63], v[96:99]
  ds_read_b64_tr_b16 v[48:49], v25 offset:24576
  ds_read_b64_tr_b16 v[50:51], v25 offset:26112
  v_mfma_f32_16x16x32_bf16 v[88:91], v[76:79], v[56:59], v[88:91]
  ds_read_b64_tr_b16 v[52:53], v26 offset:24576
  ds_read_b64_tr_b16 v[54:55], v26 offset:26112
  v_mfma_f32_16x16x32_bf16 v[100:103], v[76:79], v[60:63], v[100:103]
  s_waitcnt lgkmcnt(0)
  v_mfma_f32_16x16x32_bf16 v[80:83], v[44:47], v[32:35], v[80:83]
  ds_read_b128 v[56:59], v19 offset:768
  v_mfma_f32_16x16x32_bf16 v[92:95], v[44:47], v[36:39], v[92:95]
  ds_read_b64_tr_b16 v[68:69], v24 offset:36864
  ds_read_b64_tr_b16 v[70:71], v24 offset:38400
  v_mfma_f32_16x16x32_bf16 v[84:87], v[48:51], v[32:35], v[84:87]
  ds_read_b128 v[60:63], v19 offset:17152
  v_mfma_f32_16x16x32_bf16 v[96:99], v[48:51], v[36:39], v[96:99]
  ds_read_b64_tr_b16 v[72:73], v25 offset:36864
  ds_read_b64_tr_b16 v[74:75], v25 offset:38400
  v_mfma_f32_16x16x32_bf16 v[88:91], v[52:55], v[32:35], v[88:91]
  ds_read_b64_tr_b16 v[76:77], v26 offset:36864
  ds_read_b64_tr_b16 v[78:79], v26 offset:38400
  v_mfma_f32_16x16x32_bf16 v[100:103], v[52:55], v[36:39], v[100:103]
  s_waitcnt lgkmcnt(0)
  v_mfma_f32_16x16x32_bf16 v[80:83], v[68:71], v[56:59], v[80:83]
  v_mfma_f32_16x16x32_bf16 v[92:95], v[68:71], v[60:63], v[92:95]
  v_mfma_f32_16x16x32_bf16 v[84:87], v[72:75], v[56:59], v[84:87]
  v_mfma_f32_16x16x32_bf16 v[96:99], v[72:75], v[60:63], v[96:99]
  v_mfma_f32_16x16x32_bf16 v[88:91], v[76:79], v[56:59], v[88:91]
  v_mfma_f32_16x16x32_bf16 v[100:103], v[76:79], v[60:63], v[100:103]
  s_nop 9
  s_mov_b32 s40, 0xbdd2d3e8
  v_mov_b32 v31, 0xc0135761
  s_lshl_b32 s22, s16, 6
  s_lshl_b32 s23, s19, 5
  s_add_u32 s22, s22, s23
  v_add_u32 v4, s22, v2
  s_mov_b32 s23, 2752
  v_mul_lo_u32 v4, v4, s23
  s_mul_i32 s22, s20, 3
  s_add_u32 s22, s22, s24
  s_lshl_b32 s22, s22, 5
  v_lshl_add_u32 v4, v3, 3, v4
  v_add_u32 v4, s22, v4
  s_mov_b32 s23, 44032
  v_cvt_pk_bf16_f32 v32, v80, v81
  v_cvt_pk_bf16_f32 v33, v82, v83
  v_lshlrev_b32 v80, 16, v32
  v_and_b32 v81, 0xffff0000, v32
  v_lshlrev_b32 v82, 16, v33
  v_and_b32 v83, 0xffff0000, v33
  v_mul_f32 v8, v80, v80
  v_mul_f32 v9, v81, v81
  v_mul_f32 v10, v82, v82
  v_mul_f32 v11, v83, v83
  v_fma_f32 v8, v8, s40, v31
  v_fma_f32 v9, v9, s40, v31
  v_fma_f32 v10, v10, s40, v31
  v_fma_f32 v11, v11, s40, v31
  v_mul_f32 v8, v8, v80
  v_mul_f32 v9, v9, v81
  v_mul_f32 v10, v10, v82
  v_mul_f32 v11, v11, v83
  v_exp_f32 v8, v8
  v_exp_f32 v9, v9
  v_exp_f32 v10, v10
  v_exp_f32 v11, v11
  v_add_f32 v8, 1.0, v8
  v_add_f32 v9, 1.0, v9
  v_add_f32 v10, 1.0, v10
  v_add_f32 v11, 1.0, v11
  v_rcp_f32 v8, v8
  v_rcp_f32 v9, v9
  v_rcp_f32 v10, v10
  v_rcp_f32 v11, v11
  v_mul_f32 v80, v80, v8
  v_mul_f32 v81, v81, v9
  v_mul_f32 v82, v82, v10
  v_mul_f32 v83, v83, v11
  v_cvt_pk_bf16_f32 v32, v80, v81
  v_cvt_pk_bf16_f32 v33, v82, v83
  buffer_store_dwordx2 v[32:33], v4, s[12:15], 0 offen offset:0
  v_cvt_pk_bf16_f32 v34, v84, v85
  v_cvt_pk_bf16_f32 v35, v86, v87
  v_lshlrev_b32 v84, 16, v34
  v_and_b32 v85, 0xffff0000, v34
  v_lshlrev_b32 v86, 16, v35
  v_and_b32 v87, 0xffff0000, v35
  v_mul_f32 v8, v84, v84
  v_mul_f32 v9, v85, v85
  v_mul_f32 v10, v86, v86
  v_mul_f32 v11, v87, v87
  v_fma_f32 v8, v8, s40, v31
  v_fma_f32 v9, v9, s40, v31
  v_fma_f32 v10, v10, s40, v31
  v_fma_f32 v11, v11, s40, v31
  v_mul_f32 v8, v8, v84
  v_mul_f32 v9, v9, v85
  v_mul_f32 v10, v10, v86
  v_mul_f32 v11, v11, v87
  v_exp_f32 v8, v8
  v_exp_f32 v9, v9
  v_exp_f32 v10, v10
  v_exp_f32 v11, v11
  v_add_f32 v8, 1.0, v8
  v_add_f32 v9, 1.0, v9
  v_add_f32 v10, 1.0, v10
  v_add_f32 v11, 1.0, v11
  v_rcp_f32 v8, v8
  v_rcp_f32 v9, v9
  v_rcp_f32 v10, v10
  v_rcp_f32 v11, v11
  v_mul_f32 v84, v84, v8
  v_mul_f32 v85, v85, v9
  v_mul_f32 v86, v86, v10
  v_mul_f32 v87, v87, v11
  v_cvt_pk_bf16_f32 v34, v84, v85
  v_cvt_pk_bf16_f32 v35, v86, v87
  buffer_store_dwordx2 v[34:35], v4, s[12:15], 0 offen offset:32
  v_cvt_pk_bf16_f32 v36, v88, v89
  v_cvt_pk_bf16_f32 v37, v90, v91
  v_lshlrev_b32 v88, 16, v36
  v_and_b32 v89, 0xffff0000, v36
  v_lshlrev_b32 v90, 16, v37
  v_and_b32 v91, 0xffff0000, v37
  v_mul_f32 v8, v88, v88
  v_mul_f32 v9, v89, v89
  v_mul_f32 v10, v90, v90
  v_mul_f32 v11, v91, v91
  v_fma_f32 v8, v8, s40, v31
  v_fma_f32 v9, v9, s40, v31
  v_fma_f32 v10, v10, s40, v31
  v_fma_f32 v11, v11, s40, v31
  v_mul_f32 v8, v8, v88
  v_mul_f32 v9, v9, v89
  v_mul_f32 v10, v10, v90
  v_mul_f32 v11, v11, v91
  v_exp_f32 v8, v8
  v_exp_f32 v9, v9
  v_exp_f32 v10, v10
  v_exp_f32 v11, v11
  v_add_f32 v8, 1.0, v8
  v_add_f32 v9, 1.0, v9
  v_add_f32 v10, 1.0, v10
  v_add_f32 v11, 1.0, v11
  v_rcp_f32 v8, v8
  v_rcp_f32 v9, v9
  v_rcp_f32 v10, v10
  v_rcp_f32 v11, v11
  v_mul_f32 v88, v88, v8
  v_mul_f32 v89, v89, v9
  v_mul_f32 v90, v90, v10
  v_mul_f32 v91, v91, v11
  v_cvt_pk_bf16_f32 v36, v88, v89
  v_cvt_pk_bf16_f32 v37, v90, v91
  buffer_store_dwordx2 v[36:37], v4, s[12:15], 0 offen offset:64
  v_cvt_pk_bf16_f32 v38, v92, v93
  v_cvt_pk_bf16_f32 v39, v94, v95
  v_lshlrev_b32 v92, 16, v38
  v_and_b32 v93, 0xffff0000, v38
  v_lshlrev_b32 v94, 16, v39
  v_and_b32 v95, 0xffff0000, v39
  v_mul_f32 v8, v92, v92
  v_mul_f32 v9, v93, v93
  v_mul_f32 v10, v94, v94
  v_mul_f32 v11, v95, v95
  v_fma_f32 v8, v8, s40, v31
  v_fma_f32 v9, v9, s40, v31
  v_fma_f32 v10, v10, s40, v31
  v_fma_f32 v11, v11, s40, v31
  v_mul_f32 v8, v8, v92
  v_mul_f32 v9, v9, v93
  v_mul_f32 v10, v10, v94
  v_mul_f32 v11, v11, v95
  v_exp_f32 v8, v8
  v_exp_f32 v9, v9
  v_exp_f32 v10, v10
  v_exp_f32 v11, v11
  v_add_f32 v8, 1.0, v8
  v_add_f32 v9, 1.0, v9
  v_add_f32 v10, 1.0, v10
  v_add_f32 v11, 1.0, v11
  v_rcp_f32 v8, v8
  v_rcp_f32 v9, v9
  v_rcp_f32 v10, v10
  v_rcp_f32 v11, v11
  v_mul_f32 v92, v92, v8
  v_mul_f32 v93, v93, v9
  v_mul_f32 v94, v94, v10
  v_mul_f32 v95, v95, v11
  v_cvt_pk_bf16_f32 v38, v92, v93
  v_cvt_pk_bf16_f32 v39, v94, v95
  buffer_store_dwordx2 v[38:39], v4, s[12:15], s23 offen offset:0
  v_cvt_pk_bf16_f32 v40, v96, v97
  v_cvt_pk_bf16_f32 v41, v98, v99
  v_lshlrev_b32 v96, 16, v40
  v_and_b32 v97, 0xffff0000, v40
  v_lshlrev_b32 v98, 16, v41
  v_and_b32 v99, 0xffff0000, v41
  v_mul_f32 v8, v96, v96
  v_mul_f32 v9, v97, v97
  v_mul_f32 v10, v98, v98
  v_mul_f32 v11, v99, v99
  v_fma_f32 v8, v8, s40, v31
  v_fma_f32 v9, v9, s40, v31
  v_fma_f32 v10, v10, s40, v31
  v_fma_f32 v11, v11, s40, v31
  v_mul_f32 v8, v8, v96
  v_mul_f32 v9, v9, v97
  v_mul_f32 v10, v10, v98
  v_mul_f32 v11, v11, v99
  v_exp_f32 v8, v8
  v_exp_f32 v9, v9
  v_exp_f32 v10, v10
  v_exp_f32 v11, v11
  v_add_f32 v8, 1.0, v8
  v_add_f32 v9, 1.0, v9
  v_add_f32 v10, 1.0, v10
  v_add_f32 v11, 1.0, v11
  v_rcp_f32 v8, v8
  v_rcp_f32 v9, v9
  v_rcp_f32 v10, v10
  v_rcp_f32 v11, v11
  v_mul_f32 v96, v96, v8
  v_mul_f32 v97, v97, v9
  v_mul_f32 v98, v98, v10
  v_mul_f32 v99, v99, v11
  v_cvt_pk_bf16_f32 v40, v96, v97
  v_cvt_pk_bf16_f32 v41, v98, v99
  buffer_store_dwordx2 v[40:41], v4, s[12:15], s23 offen offset:32
  v_cvt_pk_bf16_f32 v42, v100, v101
  v_cvt_pk_bf16_f32 v43, v102, v103
  v_lshlrev_b32 v100, 16, v42
  v_and_b32 v101, 0xffff0000, v42
  v_lshlrev_b32 v102, 16, v43
  v_and_b32 v103, 0xffff0000, v43
  v_mul_f32 v8, v100, v100
  v_mul_f32 v9, v101, v101
  v_mul_f32 v10, v102, v102
  v_mul_f32 v11, v103, v103
  v_fma_f32 v8, v8, s40, v31
  v_fma_f32 v9, v9, s40, v31
  v_fma_f32 v10, v10, s40, v31
  v_fma_f32 v11, v11, s40, v31
  v_mul_f32 v8, v8, v100
  v_mul_f32 v9, v9, v101
  v_mul_f32 v10, v10, v102
  v_mul_f32 v11, v11, v103
  v_exp_f32 v8, v8
  v_exp_f32 v9, v9
  v_exp_f32 v10, v10
  v_exp_f32 v11, v11
  v_add_f32 v8, 1.0, v8
  v_add_f32 v9, 1.0, v9
  v_add_f32 v10, 1.0, v10
  v_add_f32 v11, 1.0, v11
  v_rcp_f32 v8, v8
  v_rcp_f32 v9, v9
  v_rcp_f32 v10, v10
  v_rcp_f32 v11, v11
  v_mul_f32 v100, v100, v8
  v_mul_f32 v101, v101, v9
  v_mul_f32 v102, v102, v10
  v_mul_f32 v103, v103, v11
  v_cvt_pk_bf16_f32 v42, v100, v101
  v_cvt_pk_bf16_f32 v43, v102, v103
  buffer_store_dwordx2 v[42:43], v4, s[12:15], s23 offen offset:64
  s_branch .Lend_k3_kernel
.Lloader_k3_kernel_1:
  s_sub_u32 s18, s18, 8
  s_mul_i32 s22, s18, 768
  s_mov_b32 s23, 43691
  s_lshl_b32 s21, s24, 5
  s_mov_b32 s24, 2752
  v_add_u32 v32, s22, v1
  v_mul_lo_u32 v33, v32, s23
  v_lshrrev_b32 v33, 20, v33
  v_mul_u32_u24 v34, 24, v33
  v_sub_u32 v34, v32, v34
  v_bfe_u32 v36, v33, 1, 1
  v_bfe_u32 v35, v33, 3, 1
  v_lshl_add_u32 v36, v35, 1, v36
  v_lshlrev_b32 v36, 1, v36
  v_xor_b32 v34, v34, v36
  v_lshlrev_b32 v32, 4, v34
  v_add_u32 v32, s21, v32
  v_mul_lo_u32 v33, v33, s24
  v_add_u32 v8, v33, v32
  v_add_u32 v32, s22, v1
  v_add_u32 v32, 64, v32
  v_mul_lo_u32 v33, v32, s23
  v_lshrrev_b32 v33, 20, v33
  v_mul_u32_u24 v34, 24, v33
  v_sub_u32 v34, v32, v34
  v_bfe_u32 v36, v33, 1, 1
  v_bfe_u32 v35, v33, 3, 1
  v_lshl_add_u32 v36, v35, 1, v36
  v_lshlrev_b32 v36, 1, v36
  v_xor_b32 v34, v34, v36
  v_lshlrev_b32 v32, 4, v34
  v_add_u32 v32, s21, v32
  v_mul_lo_u32 v33, v33, s24
  v_add_u32 v9, v33, v32
  v_add_u32 v32, s22, v1
  v_add_u32 v32, 128, v32
  v_mul_lo_u32 v33, v32, s23
  v_lshrrev_b32 v33, 20, v33
  v_mul_u32_u24 v34, 24, v33
  v_sub_u32 v34, v32, v34
  v_bfe_u32 v36, v33, 1, 1
  v_bfe_u32 v35, v33, 3, 1
  v_lshl_add_u32 v36, v35, 1, v36
  v_lshlrev_b32 v36, 1, v36
  v_xor_b32 v34, v34, v36
  v_lshlrev_b32 v32, 4, v34
  v_add_u32 v32, s21, v32
  v_mul_lo_u32 v33, v33, s24
  v_add_u32 v10, v33, v32
  v_add_u32 v32, s22, v1
  v_add_u32 v32, 192, v32
  v_mul_lo_u32 v33, v32, s23
  v_lshrrev_b32 v33, 20, v33
  v_mul_u32_u24 v34, 24, v33
  v_sub_u32 v34, v32, v34
  v_bfe_u32 v36, v33, 1, 1
  v_bfe_u32 v35, v33, 3, 1
  v_lshl_add_u32 v36, v35, 1, v36
  v_lshlrev_b32 v36, 1, v36
  v_xor_b32 v34, v34, v36
  v_lshlrev_b32 v32, 4, v34
  v_add_u32 v32, s21, v32
  v_mul_lo_u32 v33, v33, s24
  v_add_u32 v11, v33, v32
  v_add_u32 v32, s22, v1
  v_add_u32 v32, 256, v32
  v_mul_lo_u32 v33, v32, s23
  v_lshrrev_b32 v33, 20, v33
  v_mul_u32_u24 v34, 24, v33
  v_sub_u32 v34, v32, v34
  v_bfe_u32 v36, v33, 1, 1
  v_bfe_u32 v35, v33, 3, 1
  v_lshl_add_u32 v36, v35, 1, v36
  v_lshlrev_b32 v36, 1, v36
  v_xor_b32 v34, v34, v36
  v_lshlrev_b32 v32, 4, v34
  v_add_u32 v32, s21, v32
  v_mul_lo_u32 v33, v33, s24
  v_add_u32 v12, v33, v32
  v_add_u32 v32, s22, v1
  v_add_u32 v32, 320, v32
  v_mul_lo_u32 v33, v32, s23
  v_lshrrev_b32 v33, 20, v33
  v_mul_u32_u24 v34, 24, v33
  v_sub_u32 v34, v32, v34
  v_bfe_u32 v36, v33, 1, 1
  v_bfe_u32 v35, v33, 3, 1
  v_lshl_add_u32 v36, v35, 1, v36
  v_lshlrev_b32 v36, 1, v36
  v_xor_b32 v34, v34, v36
  v_lshlrev_b32 v32, 4, v34
  v_add_u32 v32, s21, v32
  v_mul_lo_u32 v33, v33, s24
  v_add_u32 v13, v33, v32
  v_add_u32 v32, s22, v1
  v_add_u32 v32, 384, v32
  v_mul_lo_u32 v33, v32, s23
  v_lshrrev_b32 v33, 20, v33
  v_mul_u32_u24 v34, 24, v33
  v_sub_u32 v34, v32, v34
  v_bfe_u32 v36, v33, 1, 1
  v_bfe_u32 v35, v33, 3, 1
  v_lshl_add_u32 v36, v35, 1, v36
  v_lshlrev_b32 v36, 1, v36
  v_xor_b32 v34, v34, v36
  v_lshlrev_b32 v32, 4, v34
  v_add_u32 v32, s21, v32
  v_mul_lo_u32 v33, v33, s24
  v_add_u32 v14, v33, v32
  v_add_u32 v32, s22, v1
  v_add_u32 v32, 448, v32
  v_mul_lo_u32 v33, v32, s23
  v_lshrrev_b32 v33, 20, v33
  v_mul_u32_u24 v34, 24, v33
  v_sub_u32 v34, v32, v34
  v_bfe_u32 v36, v33, 1, 1
  v_bfe_u32 v35, v33, 3, 1
  v_lshl_add_u32 v36, v35, 1, v36
  v_lshlrev_b32 v36, 1, v36
  v_xor_b32 v34, v34, v36
  v_lshlrev_b32 v32, 4, v34
  v_add_u32 v32, s21, v32
  v_mul_lo_u32 v33, v33, s24
  v_add_u32 v15, v33, v32
  v_add_u32 v32, s22, v1
  v_add_u32 v32, 512, v32
  v_mul_lo_u32 v33, v32, s23
  v_lshrrev_b32 v33, 20, v33
  v_mul_u32_u24 v34, 24, v33
  v_sub_u32 v34, v32, v34
  v_bfe_u32 v36, v33, 1, 1
  v_bfe_u32 v35, v33, 3, 1
  v_lshl_add_u32 v36, v35, 1, v36
  v_lshlrev_b32 v36, 1, v36
  v_xor_b32 v34, v34, v36
  v_lshlrev_b32 v32, 4, v34
  v_add_u32 v32, s21, v32
  v_mul_lo_u32 v33, v33, s24
  v_add_u32 v16, v33, v32
  v_add_u32 v32, s22, v1
  v_add_u32 v32, 576, v32
  v_mul_lo_u32 v33, v32, s23
  v_lshrrev_b32 v33, 20, v33
  v_mul_u32_u24 v34, 24, v33
  v_sub_u32 v34, v32, v34
  v_bfe_u32 v36, v33, 1, 1
  v_bfe_u32 v35, v33, 3, 1
  v_lshl_add_u32 v36, v35, 1, v36
  v_lshlrev_b32 v36, 1, v36
  v_xor_b32 v34, v34, v36
  v_lshlrev_b32 v32, 4, v34
  v_add_u32 v32, s21, v32
  v_mul_lo_u32 v33, v33, s24
  v_add_u32 v17, v33, v32
  v_add_u32 v32, s22, v1
  v_add_u32 v32, 640, v32
  v_mul_lo_u32 v33, v32, s23
  v_lshrrev_b32 v33, 20, v33
  v_mul_u32_u24 v34, 24, v33
  v_sub_u32 v34, v32, v34
  v_bfe_u32 v36, v33, 1, 1
  v_bfe_u32 v35, v33, 3, 1
  v_lshl_add_u32 v36, v35, 1, v36
  v_lshlrev_b32 v36, 1, v36
  v_xor_b32 v34, v34, v36
  v_lshlrev_b32 v32, 4, v34
  v_add_u32 v32, s21, v32
  v_mul_lo_u32 v33, v33, s24
  v_add_u32 v18, v33, v32
  v_add_u32 v32, s22, v1
  v_add_u32 v32, 704, v32
  v_mul_lo_u32 v33, v32, s23
  v_lshrrev_b32 v33, 20, v33
  v_mul_u32_u24 v34, 24, v33
  v_sub_u32 v34, v32, v34
  v_bfe_u32 v36, v33, 1, 1
  v_bfe_u32 v35, v33, 3, 1
  v_lshl_add_u32 v36, v35, 1, v36
  v_lshlrev_b32 v36, 1, v36
  v_xor_b32 v34, v34, v36
  v_lshlrev_b32 v32, 4, v34
  v_add_u32 v32, s21, v32
  v_mul_lo_u32 v33, v33, s24
  v_add_u32 v19, v33, v32
  s_mul_i32 s21, s18, 12288
  s_add_u32 s21, s21, 65536
  s_waitcnt lgkmcnt(0)
  s_mov_b32 s10, 0x158000
  s_mov_b32 s11, 0x00020000
  s_barrier
  s_mov_b32 s22, 0
  s_add_u32 m0, s21, 0
  s_nop 0
  buffer_load_dwordx4 v8, s[8:11], s22 offen lds
  s_add_u32 m0, s21, 1024
  s_nop 0
  buffer_load_dwordx4 v9, s[8:11], s22 offen lds
  s_add_u32 m0, s21, 2048
  s_nop 0
  buffer_load_dwordx4 v10, s[8:11], s22 offen lds
  s_add_u32 m0, s21, 3072
  s_nop 0
  buffer_load_dwordx4 v11, s[8:11], s22 offen lds
  s_add_u32 m0, s21, 4096
  s_nop 0
  buffer_load_dwordx4 v12, s[8:11], s22 offen lds
  s_add_u32 m0, s21, 5120
  s_nop 0
  buffer_load_dwordx4 v13, s[8:11], s22 offen lds
  s_add_u32 m0, s21, 6144
  s_nop 0
  buffer_load_dwordx4 v14, s[8:11], s22 offen lds
  s_add_u32 m0, s21, 7168
  s_nop 0
  buffer_load_dwordx4 v15, s[8:11], s22 offen lds
  s_add_u32 m0, s21, 8192
  s_nop 0
  buffer_load_dwordx4 v16, s[8:11], s22 offen lds
  s_add_u32 m0, s21, 9216
  s_nop 0
  buffer_load_dwordx4 v17, s[8:11], s22 offen lds
  s_add_u32 m0, s21, 10240
  s_nop 0
  buffer_load_dwordx4 v18, s[8:11], s22 offen lds
  s_add_u32 m0, s21, 11264
  s_nop 0
  buffer_load_dwordx4 v19, s[8:11], s22 offen lds
  s_mov_b32 s22, 176128
  s_add_u32 m0, s21, 24576
  s_nop 0
  buffer_load_dwordx4 v8, s[8:11], s22 offen lds
  s_add_u32 m0, s21, 25600
  s_nop 0
  buffer_load_dwordx4 v9, s[8:11], s22 offen lds
  s_add_u32 m0, s21, 26624
  s_nop 0
  buffer_load_dwordx4 v10, s[8:11], s22 offen lds
  s_add_u32 m0, s21, 27648
  s_nop 0
  buffer_load_dwordx4 v11, s[8:11], s22 offen lds
  s_add_u32 m0, s21, 28672
  s_nop 0
  buffer_load_dwordx4 v12, s[8:11], s22 offen lds
  s_add_u32 m0, s21, 29696
  s_nop 0
  buffer_load_dwordx4 v13, s[8:11], s22 offen lds
  s_add_u32 m0, s21, 30720
  s_nop 0
  buffer_load_dwordx4 v14, s[8:11], s22 offen lds
  s_add_u32 m0, s21, 31744
  s_nop 0
  buffer_load_dwordx4 v15, s[8:11], s22 offen lds
  s_add_u32 m0, s21, 32768
  s_nop 0
  buffer_load_dwordx4 v16, s[8:11], s22 offen lds
  s_add_u32 m0, s21, 33792
  s_nop 0
  buffer_load_dwordx4 v17, s[8:11], s22 offen lds
  s_add_u32 m0, s21, 34816
  s_nop 0
  buffer_load_dwordx4 v18, s[8:11], s22 offen lds
  s_add_u32 m0, s21, 35840
  s_nop 0
  buffer_load_dwordx4 v19, s[8:11], s22 offen lds
  s_mov_b32 s22, 352256
  s_add_u32 m0, s21, 49152
  s_nop 0
  buffer_load_dwordx4 v8, s[8:11], s22 offen lds
  s_add_u32 m0, s21, 50176
  s_nop 0
  buffer_load_dwordx4 v9, s[8:11], s22 offen lds
  s_add_u32 m0, s21, 51200
  s_nop 0
  buffer_load_dwordx4 v10, s[8:11], s22 offen lds
  s_add_u32 m0, s21, 52224
  s_nop 0
  buffer_load_dwordx4 v11, s[8:11], s22 offen lds
  s_add_u32 m0, s21, 53248
  s_nop 0
  buffer_load_dwordx4 v12, s[8:11], s22 offen lds
  s_add_u32 m0, s21, 54272
  s_nop 0
  buffer_load_dwordx4 v13, s[8:11], s22 offen lds
  s_add_u32 m0, s21, 55296
  s_nop 0
  buffer_load_dwordx4 v14, s[8:11], s22 offen lds
  s_add_u32 m0, s21, 56320
  s_nop 0
  buffer_load_dwordx4 v15, s[8:11], s22 offen lds
  s_add_u32 m0, s21, 57344
  s_nop 0
  buffer_load_dwordx4 v16, s[8:11], s22 offen lds
  s_add_u32 m0, s21, 58368
  s_nop 0
  buffer_load_dwordx4 v17, s[8:11], s22 offen lds
  s_add_u32 m0, s21, 59392
  s_nop 0
  buffer_load_dwordx4 v18, s[8:11], s22 offen lds
  s_add_u32 m0, s21, 60416
  s_nop 0
  buffer_load_dwordx4 v19, s[8:11], s22 offen lds
  s_waitcnt vmcnt(24)
  s_barrier
  s_waitcnt vmcnt(12)
  s_barrier
  s_mov_b32 s22, 528384
  s_add_u32 m0, s21, 0
  s_nop 0
  buffer_load_dwordx4 v8, s[8:11], s22 offen lds
  s_add_u32 m0, s21, 1024
  s_nop 0
  buffer_load_dwordx4 v9, s[8:11], s22 offen lds
  s_add_u32 m0, s21, 2048
  s_nop 0
  buffer_load_dwordx4 v10, s[8:11], s22 offen lds
  s_add_u32 m0, s21, 3072
  s_nop 0
  buffer_load_dwordx4 v11, s[8:11], s22 offen lds
  s_add_u32 m0, s21, 4096
  s_nop 0
  buffer_load_dwordx4 v12, s[8:11], s22 offen lds
  s_add_u32 m0, s21, 5120
  s_nop 0
  buffer_load_dwordx4 v13, s[8:11], s22 offen lds
  s_add_u32 m0, s21, 6144
  s_nop 0
  buffer_load_dwordx4 v14, s[8:11], s22 offen lds
  s_add_u32 m0, s21, 7168
  s_nop 0
  buffer_load_dwordx4 v15, s[8:11], s22 offen lds
  s_add_u32 m0, s21, 8192
  s_nop 0
  buffer_load_dwordx4 v16, s[8:11], s22 offen lds
  s_add_u32 m0, s21, 9216
  s_nop 0
  buffer_load_dwordx4 v17, s[8:11], s22 offen lds
  s_add_u32 m0, s21, 10240
  s_nop 0
  buffer_load_dwordx4 v18, s[8:11], s22 offen lds
  s_add_u32 m0, s21, 11264
  s_nop 0
  buffer_load_dwordx4 v19, s[8:11], s22 offen lds
  s_waitcnt vmcnt(12)
  s_barrier
  s_mov_b32 s22, 704512
  s_add_u32 m0, s21, 24576
  s_nop 0
  buffer_load_dwordx4 v8, s[8:11], s22 offen lds
  s_add_u32 m0, s21, 25600
  s_nop 0
  buffer_load_dwordx4 v9, s[8:11], s22 offen lds
  s_add_u32 m0, s21, 26624
  s_nop 0
  buffer_load_dwordx4 v10, s[8:11], s22 offen lds
  s_add_u32 m0, s21, 27648
  s_nop 0
  buffer_load_dwordx4 v11, s[8:11], s22 offen lds
  s_add_u32 m0, s21, 28672
  s_nop 0
  buffer_load_dwordx4 v12, s[8:11], s22 offen lds
  s_add_u32 m0, s21, 29696
  s_nop 0
  buffer_load_dwordx4 v13, s[8:11], s22 offen lds
  s_add_u32 m0, s21, 30720
  s_nop 0
  buffer_load_dwordx4 v14, s[8:11], s22 offen lds
  s_add_u32 m0, s21, 31744
  s_nop 0
  buffer_load_dwordx4 v15, s[8:11], s22 offen lds
  s_add_u32 m0, s21, 32768
  s_nop 0
  buffer_load_dwordx4 v16, s[8:11], s22 offen lds
  s_add_u32 m0, s21, 33792
  s_nop 0
  buffer_load_dwordx4 v17, s[8:11], s22 offen lds
  s_add_u32 m0, s21, 34816
  s_nop 0
  buffer_load_dwordx4 v18, s[8:11], s22 offen lds
  s_add_u32 m0, s21, 35840
  s_nop 0
  buffer_load_dwordx4 v19, s[8:11], s22 offen lds
  s_waitcnt vmcnt(12)
  s_barrier
  s_mov_b32 s22, 880640
  s_add_u32 m0, s21, 49152
  s_nop 0
  buffer_load_dwordx4 v8, s[8:11], s22 offen lds
  s_add_u32 m0, s21, 50176
  s_nop 0
  buffer_load_dwordx4 v9, s[8:11], s22 offen lds
  s_add_u32 m0, s21, 51200
  s_nop 0
  buffer_load_dwordx4 v10, s[8:11], s22 offen lds
  s_add_u32 m0, s21, 52224
  s_nop 0
  buffer_load_dwordx4 v11, s[8:11], s22 offen lds
  s_add_u32 m0, s21, 53248
  s_nop 0
  buffer_load_dwordx4 v12, s[8:11], s22 offen lds
  s_add_u32 m0, s21, 54272
  s_nop 0
  buffer_load_dwordx4 v13, s[8:11], s22 offen lds
  s_add_u32 m0, s21, 55296
  s_nop 0
  buffer_load_dwordx4 v14, s[8:11], s22 offen lds
  s_add_u32 m0, s21, 56320
  s_nop 0
  buffer_load_dwordx4 v15, s[8:11], s22 offen lds
  s_add_u32 m0, s21, 57344
  s_nop 0
  buffer_load_dwordx4 v16, s[8:11], s22 offen lds
  s_add_u32 m0, s21, 58368
  s_nop 0
  buffer_load_dwordx4 v17, s[8:11], s22 offen lds
  s_add_u32 m0, s21, 59392
  s_nop 0
  buffer_load_dwordx4 v18, s[8:11], s22 offen lds
  s_add_u32 m0, s21, 60416
  s_nop 0
  buffer_load_dwordx4 v19, s[8:11], s22 offen lds
  s_waitcnt vmcnt(12)
  s_barrier
  s_mov_b32 s22, 1056768
  s_add_u32 m0, s21, 0
  s_nop 0
  buffer_load_dwordx4 v8, s[8:11], s22 offen lds
  s_add_u32 m0, s21, 1024
  s_nop 0
  buffer_load_dwordx4 v9, s[8:11], s22 offen lds
  s_add_u32 m0, s21, 2048
  s_nop 0
  buffer_load_dwordx4 v10, s[8:11], s22 offen lds
  s_add_u32 m0, s21, 3072
  s_nop 0
  buffer_load_dwordx4 v11, s[8:11], s22 offen lds
  s_add_u32 m0, s21, 4096
  s_nop 0
  buffer_load_dwordx4 v12, s[8:11], s22 offen lds
  s_add_u32 m0, s21, 5120
  s_nop 0
  buffer_load_dwordx4 v13, s[8:11], s22 offen lds
  s_add_u32 m0, s21, 6144
  s_nop 0
  buffer_load_dwordx4 v14, s[8:11], s22 offen lds
  s_add_u32 m0, s21, 7168
  s_nop 0
  buffer_load_dwordx4 v15, s[8:11], s22 offen lds
  s_add_u32 m0, s21, 8192
  s_nop 0
  buffer_load_dwordx4 v16, s[8:11], s22 offen lds
  s_add_u32 m0, s21, 9216
  s_nop 0
  buffer_load_dwordx4 v17, s[8:11], s22 offen lds
  s_add_u32 m0, s21, 10240
  s_nop 0
  buffer_load_dwordx4 v18, s[8:11], s22 offen lds
  s_add_u32 m0, s21, 11264
  s_nop 0
  buffer_load_dwordx4 v19, s[8:11], s22 offen lds
  s_waitcnt vmcnt(12)
  s_barrier
  s_mov_b32 s22, 1232896
  s_add_u32 m0, s21, 24576
  s_nop 0
  buffer_load_dwordx4 v8, s[8:11], s22 offen lds
  s_add_u32 m0, s21, 25600
  s_nop 0
  buffer_load_dwordx4 v9, s[8:11], s22 offen lds
  s_add_u32 m0, s21, 26624
  s_nop 0
  buffer_load_dwordx4 v10, s[8:11], s22 offen lds
  s_add_u32 m0, s21, 27648
  s_nop 0
  buffer_load_dwordx4 v11, s[8:11], s22 offen lds
  s_add_u32 m0, s21, 28672
  s_nop 0
  buffer_load_dwordx4 v12, s[8:11], s22 offen lds
  s_add_u32 m0, s21, 29696
  s_nop 0
  buffer_load_dwordx4 v13, s[8:11], s22 offen lds
  s_add_u32 m0, s21, 30720
  s_nop 0
  buffer_load_dwordx4 v14, s[8:11], s22 offen lds
  s_add_u32 m0, s21, 31744
  s_nop 0
  buffer_load_dwordx4 v15, s[8:11], s22 offen lds
  s_add_u32 m0, s21, 32768
  s_nop 0
  buffer_load_dwordx4 v16, s[8:11], s22 offen lds
  s_add_u32 m0, s21, 33792
  s_nop 0
  buffer_load_dwordx4 v17, s[8:11], s22 offen lds
  s_add_u32 m0, s21, 34816
  s_nop 0
  buffer_load_dwordx4 v18, s[8:11], s22 offen lds
  s_add_u32 m0, s21, 35840
  s_nop 0
  buffer_load_dwordx4 v19, s[8:11], s22 offen lds
  s_waitcnt vmcnt(12)
  s_barrier
  s_waitcnt vmcnt(0)
  s_barrier
.Lend_k3_kernel:
  s_endpgm

.globl k3b_kernel
.p2align 8
.type k3b_kernel,@function
k3b_kernel:
  s_cmp_ge_u32 s2, 512
  s_cbranch_scc1 .Lend_k3b_kernel
  s_load_dwordx2 s[4:5], s[0:1], 80
  s_load_dwordx2 s[8:9], s[0:1], 80
  v_and_b32 v1, 63, v0
  v_lshrrev_b32 v2, 6, v0
  s_lshl_b32 s16, s2, 2
  v_add_u32 v2, s16, v2
  s_mov_b32 s17, 2752
  v_mul_lo_u32 v3, v2, s17
  v_lshl_add_u32 v3, v1, 5, v3
  v_add_u32 v3, 1376, v3
  v_mov_b32 v5, 0x7ffff000
  v_cmp_gt_u32 vcc, 43, v1
  s_nop 1
  v_cndmask_b32 v3, v5, v3, vcc
  s_waitcnt lgkmcnt(0)
  s_add_u32 s4, s4, 0x600000
  s_addc_u32 s5, s5, 0
  s_mov_b32 s6, 0x560000
  s_mov_b32 s7, 0x00020000
  s_add_u32 s8, s8, 0xc00000
  s_addc_u32 s9, s9, 0
  s_mov_b32 s10, 0x300000
  s_mov_b32 s11, 0x00020000
  buffer_load_dwordx4 v[8:11], v3, s[4:7], 0 offen
  buffer_load_dwordx4 v[12:15], v3, s[4:7], 0 offen offset:16
  v_mul_u32_u24 v4, 7, v1
  v_add_u32 v4, 6, v4
  v_mul_u32_u24 v4, 1772, v4
  v_lshrrev_b32 v4, 16, v4
  v_min_u32 v4, 7, v4
  v_mul_u32_u24 v6, 192, v2
  v_bfe_u32 v7, v2, 3, 1
  v_add_u32 v7, v7, v1
  s_mov_b32 s17, 346431
  s_mov_b32 s18, 393216
  v_mul_lo_u32 v44, v4, s17
  v_lshrrev_b32 v44, 16, v44
  v_sub_u32 v45, v7, v44
  v_sub_u32 v46, v1, v44
  v_subrev_u32 v47, 6, v45
  v_cmp_le_u32 vcc, 6, v45
  s_nop 1
  v_cndmask_b32 v45, v45, v47, vcc
  v_mul_lo_u32 v47, v4, s18
  v_add_u32 v47, v47, v6
  v_lshl_add_u32 v42, v45, 5, v47
  v_cmp_gt_u32 vcc, 6, v46
  s_nop 1
  v_cndmask_b32 v42, v5, v42, vcc
  v_subrev_u32 v4, 1, v4
  v_mul_lo_u32 v44, v4, s17
  v_lshrrev_b32 v44, 16, v44
  v_sub_u32 v45, v7, v44
  v_sub_u32 v46, v1, v44
  v_subrev_u32 v47, 6, v45
  v_cmp_le_u32 vcc, 6, v45
  s_nop 1
  v_cndmask_b32 v45, v45, v47, vcc
  v_mul_lo_u32 v47, v4, s18
  v_add_u32 v47, v47, v6
  v_lshl_add_u32 v43, v45, 5, v47
  v_cmp_gt_u32 vcc, 6, v46
  s_nop 1
  v_cndmask_b32 v43, v5, v43, vcc
  v_cmp_gt_u32 vcc, 8, v4
  s_nop 1
  v_cndmask_b32 v43, v5, v43, vcc
  v_cmp_gt_u32 vcc, 43, v1
  s_nop 1
  v_cndmask_b32 v42, v5, v42, vcc
  v_cndmask_b32 v43, v5, v43, vcc
  s_waitcnt vmcnt(0)
  v_lshlrev_b32 v16, 16, v8
  v_and_b32 v17, 0xffff0000, v8
  v_lshlrev_b32 v18, 16, v9
  v_and_b32 v19, 0xffff0000, v9
  v_lshlrev_b32 v20, 16, v10
  v_and_b32 v21, 0xffff0000, v10
  v_lshlrev_b32 v22, 16, v11
  v_and_b32 v23, 0xffff0000, v11
  v_lshlrev_b32 v24, 16, v12
  v_and_b32 v25, 0xffff0000, v12
  v_lshlrev_b32 v26, 16, v13
  v_and_b32 v27, 0xffff0000, v13
  v_lshlrev_b32 v28, 16, v14
  v_and_b32 v29, 0xffff0000, v14
  v_lshlrev_b32 v30, 16, v15
  v_and_b32 v31, 0xffff0000, v15
  v_pk_add_f32 v[32:33], v[16:17], v[18:19]
  v_pk_mul_f32 v[34:35], v[16:17], v[16:17]
  v_pk_fma_f32 v[34:35], v[18:19], v[18:19], v[34:35]
  v_pk_add_f32 v[32:33], v[32:33], v[20:21]
  v_pk_fma_f32 v[34:35], v[20:21], v[20:21], v[34:35]
  v_pk_add_f32 v[32:33], v[32:33], v[22:23]
  v_pk_fma_f32 v[34:35], v[22:23], v[22:23], v[34:35]
  v_pk_add_f32 v[32:33], v[32:33], v[24:25]
  v_pk_fma_f32 v[34:35], v[24:25], v[24:25], v[34:35]
  v_pk_add_f32 v[32:33], v[32:33], v[26:27]
  v_pk_fma_f32 v[34:35], v[26:27], v[26:27], v[34:35]
  v_pk_add_f32 v[32:33], v[32:33], v[28:29]
  v_pk_fma_f32 v[34:35], v[28:29], v[28:29], v[34:35]
  v_pk_add_f32 v[32:33], v[32:33], v[30:31]
  v_pk_fma_f32 v[34:35], v[30:31], v[30:31], v[34:35]
  v_add_f32 v32, v32, v33
  v_add_f32 v34, v34, v35
  s_nop 1
  v_add_f32_dpp v32, v32, v32 row_ror:8 row_mask:0xf bank_mask:0xf
  v_add_f32_dpp v34, v34, v34 row_ror:8 row_mask:0xf bank_mask:0xf
  s_nop 1
  v_add_f32_dpp v32, v32, v32 row_ror:4 row_mask:0xf bank_mask:0xf
  v_add_f32_dpp v34, v34, v34 row_ror:4 row_mask:0xf bank_mask:0xf
  s_nop 1
  v_add_f32_dpp v32, v32, v32 row_ror:2 row_mask:0xf bank_mask:0xf
  v_add_f32_dpp v34, v34, v34 row_ror:2 row_mask:0xf bank_mask:0xf
  s_nop 1
  v_add_f32_dpp v32, v32, v32 row_ror:1 row_mask:0xf bank_mask:0xf
  v_add_f32_dpp v34, v34, v34 row_ror:1 row_mask:0xf bank_mask:0xf
  s_nop 1
  v_readlane_b32 s20, v32, 0
  v_readlane_b32 s24, v34, 0
  v_readlane_b32 s21, v32, 16
  v_readlane_b32 s25, v34, 16
  v_readlane_b32 s22, v32, 32
  v_readlane_b32 s26, v34, 32
  s_nop 1
  v_mov_b32 v32, s20
  v_mov_b32 v34, s24
  v_add_f32 v32, s21, v32
  v_add_f32 v34, s25, v34
  v_add_f32 v32, s22, v32
  v_add_f32 v34, s26, v34
  v_mul_f32 v32, 0x3abe82fa, v32
  v_mul_f32 v34, 0x3abe82fa, v34
  v_fma_f32 v34, -v32, v32, v34
  v_max_f32 v34, 0, v34
  v_cvt_pk_bf16_f32 v36, v32, v32
  v_lshlrev_b32 v36, 16, v36
  v_cvt_pk_bf16_f32 v40, v34, v34
  v_lshlrev_b32 v40, 16, v40
  v_add_f32 v40, 0x3727c5ac, v40
  v_cvt_pk_bf16_f32 v40, v40, v40
  v_lshlrev_b32 v40, 16, v40
  v_sqrt_f32 v41, v40
  s_nop 0
  v_cvt_pk_bf16_f32 v41, v41, v41
  v_lshlrev_b32 v41, 16, v41
  v_rcp_f32 v38, v41
  s_nop 0
  v_sub_f32 v36, 0, v36
  v_mov_b32 v37, v36
  v_mov_b32 v39, v38
  v_pk_add_f32 v[16:17], v[16:17], v[36:37]
  v_cvt_pk_bf16_f32 v8, v16, v17
  v_lshlrev_b32 v16, 16, v8
  v_and_b32 v17, 0xffff0000, v8
  v_pk_mul_f32 v[16:17], v[16:17], v[38:39]
  v_cvt_pk_bf16_f32 v8, v16, v17
  v_pk_add_f32 v[18:19], v[18:19], v[36:37]
  v_cvt_pk_bf16_f32 v9, v18, v19
  v_lshlrev_b32 v18, 16, v9
  v_and_b32 v19, 0xffff0000, v9
  v_pk_mul_f32 v[18:19], v[18:19], v[38:39]
  v_cvt_pk_bf16_f32 v9, v18, v19
  v_pk_add_f32 v[20:21], v[20:21], v[36:37]
  v_cvt_pk_bf16_f32 v10, v20, v21
  v_lshlrev_b32 v20, 16, v10
  v_and_b32 v21, 0xffff0000, v10
  v_pk_mul_f32 v[20:21], v[20:21], v[38:39]
  v_cvt_pk_bf16_f32 v10, v20, v21
  v_pk_add_f32 v[22:23], v[22:23], v[36:37]
  v_cvt_pk_bf16_f32 v11, v22, v23
  v_lshlrev_b32 v22, 16, v11
  v_and_b32 v23, 0xffff0000, v11
  v_pk_mul_f32 v[22:23], v[22:23], v[38:39]
  v_cvt_pk_bf16_f32 v11, v22, v23
  v_pk_add_f32 v[24:25], v[24:25], v[36:37]
  v_cvt_pk_bf16_f32 v12, v24, v25
  v_lshlrev_b32 v24, 16, v12
  v_and_b32 v25, 0xffff0000, v12
  v_pk_mul_f32 v[24:25], v[24:25], v[38:39]
  v_cvt_pk_bf16_f32 v12, v24, v25
  v_pk_add_f32 v[26:27], v[26:27], v[36:37]
  v_cvt_pk_bf16_f32 v13, v26, v27
  v_lshlrev_b32 v26, 16, v13
  v_and_b32 v27, 0xffff0000, v13
  v_pk_mul_f32 v[26:27], v[26:27], v[38:39]
  v_cvt_pk_bf16_f32 v13, v26, v27
  v_pk_add_f32 v[28:29], v[28:29], v[36:37]
  v_cvt_pk_bf16_f32 v14, v28, v29
  v_lshlrev_b32 v28, 16, v14
  v_and_b32 v29, 0xffff0000, v14
  v_pk_mul_f32 v[28:29], v[28:29], v[38:39]
  v_cvt_pk_bf16_f32 v14, v28, v29
  v_pk_add_f32 v[30:31], v[30:31], v[36:37]
  v_cvt_pk_bf16_f32 v15, v30, v31
  v_lshlrev_b32 v30, 16, v15
  v_and_b32 v31, 0xffff0000, v15
  v_pk_mul_f32 v[30:31], v[30:31], v[38:39]
  v_cvt_pk_bf16_f32 v15, v30, v31
  buffer_store_dwordx4 v[8:11], v42, s[8:11], 0 offen
  buffer_store_dwordx4 v[12:15], v42, s[8:11], 0 offen offset:16
  buffer_store_dwordx4 v[8:11], v43, s[8:11], 0 offen
  buffer_store_dwordx4 v[12:15], v43, s[8:11], 0 offen offset:16
.Lend_k3b_kernel:
  s_endpgm

.globl k4_kernel
.p2align 8
.type k4_kernel,@function
k4_kernel:
  s_cmp_ge_u32 s2, 256
  s_cbranch_scc1 .Lend_k4_kernel
  s_load_dwordx2 s[4:5], s[0:1], 40
  s_load_dwordx2 s[8:9], s[0:1], 80
  s_load_dwordx2 s[12:13], s[0:1], 80
  s_load_dwordx2 s[16:17], s[0:1], 80
  s_load_dwordx2 s[20:21], s[0:1], 48
  s_and_b32 s24, s2, 7
  s_lshl_b32 s24, s24, 2
  s_lshr_b32 s25, s2, 3
  s_and_b32 s25, s25, 3
  s_add_u32 s24, s24, s25
  s_lshr_b32 s25, s2, 5
  v_and_b32 v1, 63, v0
  v_lshrrev_b32 v4, 6, v0
  v_and_b32 v2, 15, v0
  v_readfirstlane_b32 s26, v4
  v_bfe_u32 v3, v0, 4, 2
  s_mul_i32 s33, s25, 346431
  s_lshr_b32 s33, s33, 16
  s_cmp_ge_u32 s26, 4
  s_cbranch_scc1 .Lloader_k4_kernel_1
  s_and_b32 s27, s26, 1
  s_lshr_b32 s28, s26, 1
  s_lshl_b32 s31, s24, 6
  s_lshl_b32 s32, s27, 5
  s_add_u32 s31, s31, s32
  v_add_u32 v4, s31, v2
  s_mul_i32 s34, s28, 3
  s_add_u32 s34, s34, s33
  s_lshl_b32 s34, s34, 5
  s_mov_b32 s32, 1408
  v_mul_lo_u32 v16, v4, s32
  v_lshl_add_u32 v16, v3, 3, v16
  v_add_u32 v16, s34, v16
  s_mov_b32 s32, 2752
  v_mul_lo_u32 v17, v4, s32
  v_lshl_add_u32 v17, v3, 3, v17
  v_add_u32 v17, s34, v17
  v_lshlrev_b32 v18, 1, v4
  s_mov_b32 s35, 44032
  s_mov_b32 s36, 22528
  s_lshl_b32 s31, s27, 12
  v_lshrrev_b32 v4, 1, v2
  v_xor_b32 v5, v3, v4
  v_and_b32 v5, 3, v5
  v_and_b32 v4, 4, v4
  v_xor_b32 v6, 0, v4
  v_or_b32 v6, v6, v5
  v_lshlrev_b32 v6, 4, v6
  v_lshl_add_u32 v6, v2, 7, v6
  v_add_u32 v20, s31, v6
  v_xor_b32 v6, 4, v4
  v_or_b32 v6, v6, v5
  v_lshlrev_b32 v6, 4, v6
  v_lshl_add_u32 v6, v2, 7, v6
  v_add_u32 v21, s31, v6
  v_lshrrev_b32 v4, 2, v2
  v_lshl_add_u32 v4, v3, 3, v4
  v_mul_u32_u24 v4, 192, v4
  v_and_b32 v5, 3, v2
  v_lshl_add_u32 v4, v5, 3, v4
  v_add_u32 v4, 0x2000, v4
  v_and_b32 v6, 1, v3
  s_mul_i32 s31, s28, 3
  s_add_u32 s32, s31, 0
  v_add_u32 v7, s32, v6
  v_subrev_u32 v13, 6, v7
  v_cmp_le_u32 vcc, 6, v7
  s_nop 1
  v_cndmask_b32 v7, v7, v13, vcc
  v_lshl_add_u32 v22, v7, 5, v4
  s_add_u32 s32, s31, 1
  v_add_u32 v7, s32, v6
  v_subrev_u32 v13, 6, v7
  v_cmp_le_u32 vcc, 6, v7
  s_nop 1
  v_cndmask_b32 v7, v7, v13, vcc
  v_lshl_add_u32 v23, v7, 5, v4
  s_add_u32 s32, s31, 2
  v_add_u32 v7, s32, v6
  v_subrev_u32 v13, 6, v7
  v_cmp_le_u32 vcc, 6, v7
  s_nop 1
  v_cndmask_b32 v7, v7, v13, vcc
  v_lshl_add_u32 v24, v7, 5, v4
  v_mov_b32 v144, 0
  v_mov_b32 v145, 0
  v_mov_b32 v146, 0
  v_mov_b32 v147, 0
  v_mov_b32 v148, 0
  v_mov_b32 v149, 0
  v_mov_b32 v150, 0
  v_mov_b32 v151, 0
  v_mov_b32 v152, 0
  v_mov_b32 v153, 0
  v_mov_b32 v154, 0
  v_mov_b32 v155, 0
  v_mov_b32 v156, 0
  v_mov_b32 v157, 0
  v_mov_b32 v158, 0
  v_mov_b32 v159, 0
  v_mov_b32 v160, 0
  v_mov_b32 v161, 0
  v_mov_b32 v162, 0
  v_mov_b32 v163, 0
  v_mov_b32 v164, 0
  v_mov_b32 v165, 0
  v_mov_b32 v166, 0
  v_mov_b32 v167, 0
  s_waitcnt lgkmcnt(0)
  s_add_u32 s12, s12, 0x1000000
  s_addc_u32 s13, s13, 0
  s_mov_b32 s14, 0x2c0000
  s_mov_b32 s15, 0x00020000
  s_add_u32 s16, s16, 0x600000
  s_addc_u32 s17, s17, 0
  s_mov_b32 s18, 0x560000
  s_mov_b32 s19, 0x00020000
  s_mov_b32 s22, 0x1000
  s_mov_b32 s23, 0x00020000
  s_barrier
  ds_read_b128 v[64:67], v20 offset:0
  ds_read_b128 v[68:71], v20 offset:2048
  ds_read_b64_tr_b16 v[80:81], v22 offset:0
  ds_read_b64_tr_b16 v[82:83], v22 offset:768
  ds_read_b64_tr_b16 v[84:85], v23 offset:0
  ds_read_b64_tr_b16 v[86:87], v23 offset:768
  ds_read_b64_tr_b16 v[88:89], v24 offset:0
  ds_read_b64_tr_b16 v[90:91], v24 offset:768
  ds_read_b128 v[72:75], v21 offset:0
  ds_read_b128 v[76:79], v21 offset:2048
  ds_read_b64_tr_b16 v[92:93], v22 offset:6144
  ds_read_b64_tr_b16 v[94:95], v22 offset:6912
  ds_read_b64_tr_b16 v[96:97], v23 offset:6144
  ds_read_b64_tr_b16 v[98:99], v23 offset:6912
  ds_read_b64_tr_b16 v[100:101], v24 offset:6144
  ds_read_b64_tr_b16 v[102:103], v24 offset:6912
  s_waitcnt lgkmcnt(0)
  s_barrier
  v_add_u32 v26, 0x5000, v20
  v_add_u32 v27, 0x5000, v21
  v_add_u32 v28, 0x5000, v22
  v_add_u32 v29, 0x5000, v23
  v_add_u32 v30, 0x5000, v24
  v_mfma_f32_16x16x32_bf16 v[144:147], v[80:83], v[64:67], v[144:147]
  ds_read_b128 v[104:107], v26 offset:0
  v_mfma_f32_16x16x32_bf16 v[156:159], v[80:83], v[68:71], v[156:159]
  ds_read_b128 v[108:111], v26 offset:2048
  ds_read_b64_tr_b16 v[120:121], v28 offset:0
  v_mfma_f32_16x16x32_bf16 v[148:151], v[84:87], v[64:67], v[148:151]
  ds_read_b64_tr_b16 v[122:123], v28 offset:768
  v_mfma_f32_16x16x32_bf16 v[160:163], v[84:87], v[68:71], v[160:163]
  ds_read_b64_tr_b16 v[124:125], v29 offset:0
  ds_read_b64_tr_b16 v[126:127], v29 offset:768
  v_mfma_f32_16x16x32_bf16 v[152:155], v[88:91], v[64:67], v[152:155]
  ds_read_b64_tr_b16 v[128:129], v30 offset:0
  ds_read_b64_tr_b16 v[130:131], v30 offset:768
  v_mfma_f32_16x16x32_bf16 v[164:167], v[88:91], v[68:71], v[164:167]
  ds_read_b128 v[112:115], v27 offset:0
  v_mfma_f32_16x16x32_bf16 v[144:147], v[92:95], v[72:75], v[144:147]
  ds_read_b128 v[116:119], v27 offset:2048
  ds_read_b64_tr_b16 v[132:133], v28 offset:6144
  v_mfma_f32_16x16x32_bf16 v[156:159], v[92:95], v[76:79], v[156:159]
  ds_read_b64_tr_b16 v[134:135], v28 offset:6912
  v_mfma_f32_16x16x32_bf16 v[148:151], v[96:99], v[72:75], v[148:151]
  ds_read_b64_tr_b16 v[136:137], v29 offset:6144
  ds_read_b64_tr_b16 v[138:139], v29 offset:6912
  v_mfma_f32_16x16x32_bf16 v[160:163], v[96:99], v[76:79], v[160:163]
  ds_read_b64_tr_b16 v[140:141], v30 offset:6144
  ds_read_b64_tr_b16 v[142:143], v30 offset:6912
  v_mfma_f32_16x16x32_bf16 v[152:155], v[100:103], v[72:75], v[152:155]
  v_mfma_f32_16x16x32_bf16 v[164:167], v[100:103], v[76:79], v[164:167]
  s_waitcnt lgkmcnt(0)
  s_barrier
  v_add_u32 v26, 0xa000, v20
  v_add_u32 v27, 0xa000, v21
  v_add_u32 v28, 0xa000, v22
  v_add_u32 v29, 0xa000, v23
  v_add_u32 v30, 0xa000, v24
  v_mfma_f32_16x16x32_bf16 v[144:147], v[120:123], v[104:107], v[144:147]
  ds_read_b128 v[64:67], v26 offset:0
  v_mfma_f32_16x16x32_bf16 v[156:159], v[120:123], v[108:111], v[156:159]
  ds_read_b128 v[68:71], v26 offset:2048
  ds_read_b64_tr_b16 v[80:81], v28 offset:0
  v_mfma_f32_16x16x32_bf16 v[148:151], v[124:127], v[104:107], v[148:151]
  ds_read_b64_tr_b16 v[82:83], v28 offset:768
  v_mfma_f32_16x16x32_bf16 v[160:163], v[124:127], v[108:111], v[160:163]
  ds_read_b64_tr_b16 v[84:85], v29 offset:0
  ds_read_b64_tr_b16 v[86:87], v29 offset:768
  v_mfma_f32_16x16x32_bf16 v[152:155], v[128:131], v[104:107], v[152:155]
  ds_read_b64_tr_b16 v[88:89], v30 offset:0
  ds_read_b64_tr_b16 v[90:91], v30 offset:768
  v_mfma_f32_16x16x32_bf16 v[164:167], v[128:131], v[108:111], v[164:167]
  ds_read_b128 v[72:75], v27 offset:0
  v_mfma_f32_16x16x32_bf16 v[144:147], v[132:135], v[112:115], v[144:147]
  ds_read_b128 v[76:79], v27 offset:2048
  ds_read_b64_tr_b16 v[92:93], v28 offset:6144
  v_mfma_f32_16x16x32_bf16 v[156:159], v[132:135], v[116:119], v[156:159]
  ds_read_b64_tr_b16 v[94:95], v28 offset:6912
  v_mfma_f32_16x16x32_bf16 v[148:151], v[136:139], v[112:115], v[148:151]
  ds_read_b64_tr_b16 v[96:97], v29 offset:6144
  ds_read_b64_tr_b16 v[98:99], v29 offset:6912
  v_mfma_f32_16x16x32_bf16 v[160:163], v[136:139], v[116:119], v[160:163]
  ds_read_b64_tr_b16 v[100:101], v30 offset:6144
  ds_read_b64_tr_b16 v[102:103], v30 offset:6912
  v_mfma_f32_16x16x32_bf16 v[152:155], v[140:143], v[112:115], v[152:155]
  v_mfma_f32_16x16x32_bf16 v[164:167], v[140:143], v[116:119], v[164:167]
  s_waitcnt lgkmcnt(0)
  s_barrier
  v_add_u32 v26, 0xf000, v20
  v_add_u32 v27, 0xf000, v21
  v_add_u32 v28, 0xf000, v22
  v_add_u32 v29, 0xf000, v23
  v_add_u32 v30, 0xf000, v24
  v_mfma_f32_16x16x32_bf16 v[144:147], v[80:83], v[64:67], v[144:147]
  ds_read_b128 v[104:107], v26 offset:0
  v_mfma_f32_16x16x32_bf16 v[156:159], v[80:83], v[68:71], v[156:159]
  ds_read_b128 v[108:111], v26 offset:2048
  ds_read_b64_tr_b16 v[120:121], v28 offset:0
  v_mfma_f32_16x16x32_bf16 v[148:151], v[84:87], v[64:67], v[148:151]
  ds_read_b64_tr_b16 v[122:123], v28 offset:768
  v_mfma_f32_16x16x32_bf16 v[160:163], v[84:87], v[68:71], v[160:163]
  ds_read_b64_tr_b16 v[124:125], v29 offset:0
  ds_read_b64_tr_b16 v[126:127], v29 offset:768
  v_mfma_f32_16x16x32_bf16 v[152:155], v[88:91], v[64:67], v[152:155]
  ds_read_b64_tr_b16 v[128:129], v30 offset:0
  ds_read_b64_tr_b16 v[130:131], v30 offset:768
  v_mfma_f32_16x16x32_bf16 v[164:167], v[88:91], v[68:71], v[164:167]
  ds_read_b128 v[112:115], v27 offset:0
  v_mfma_f32_16x16x32_bf16 v[144:147], v[92:95], v[72:75], v[144:147]
  ds_read_b128 v[116:119], v27 offset:2048
  ds_read_b64_tr_b16 v[132:133], v28 offset:6144
  v_mfma_f32_16x16x32_bf16 v[156:159], v[92:95], v[76:79], v[156:159]
  ds_read_b64_tr_b16 v[134:135], v28 offset:6912
  v_mfma_f32_16x16x32_bf16 v[148:151], v[96:99], v[72:75], v[148:151]
  ds_read_b64_tr_b16 v[136:137], v29 offset:6144
  ds_read_b64_tr_b16 v[138:139], v29 offset:6912
  v_mfma_f32_16x16x32_bf16 v[160:163], v[96:99], v[76:79], v[160:163]
  ds_read_b64_tr_b16 v[140:141], v30 offset:6144
  ds_read_b64_tr_b16 v[142:143], v30 offset:6912
  v_mfma_f32_16x16x32_bf16 v[152:155], v[100:103], v[72:75], v[152:155]
  v_mfma_f32_16x16x32_bf16 v[164:167], v[100:103], v[76:79], v[164:167]
  s_waitcnt lgkmcnt(0)
  s_barrier
  v_add_u32 v26, 0x14000, v20
  v_add_u32 v27, 0x14000, v21
  v_add_u32 v28, 0x14000, v22
  v_add_u32 v29, 0x14000, v23
  v_add_u32 v30, 0x14000, v24
  v_mfma_f32_16x16x32_bf16 v[144:147], v[120:123], v[104:107], v[144:147]
  ds_read_b128 v[64:67], v26 offset:0
  v_mfma_f32_16x16x32_bf16 v[156:159], v[120:123], v[108:111], v[156:159]
  ds_read_b128 v[68:71], v26 offset:2048
  ds_read_b64_tr_b16 v[80:81], v28 offset:0
  v_mfma_f32_16x16x32_bf16 v[148:151], v[124:127], v[104:107], v[148:151]
  ds_read_b64_tr_b16 v[82:83], v28 offset:768
  v_mfma_f32_16x16x32_bf16 v[160:163], v[124:127], v[108:111], v[160:163]
  ds_read_b64_tr_b16 v[84:85], v29 offset:0
  ds_read_b64_tr_b16 v[86:87], v29 offset:768
  v_mfma_f32_16x16x32_bf16 v[152:155], v[128:131], v[104:107], v[152:155]
  ds_read_b64_tr_b16 v[88:89], v30 offset:0
  ds_read_b64_tr_b16 v[90:91], v30 offset:768
  v_mfma_f32_16x16x32_bf16 v[164:167], v[128:131], v[108:111], v[164:167]
  ds_read_b128 v[72:75], v27 offset:0
  v_mfma_f32_16x16x32_bf16 v[144:147], v[132:135], v[112:115], v[144:147]
  ds_read_b128 v[76:79], v27 offset:2048
  ds_read_b64_tr_b16 v[92:93], v28 offset:6144
  v_mfma_f32_16x16x32_bf16 v[156:159], v[132:135], v[116:119], v[156:159]
  ds_read_b64_tr_b16 v[94:95], v28 offset:6912
  v_mfma_f32_16x16x32_bf16 v[148:151], v[136:139], v[112:115], v[148:151]
  ds_read_b64_tr_b16 v[96:97], v29 offset:6144
  ds_read_b64_tr_b16 v[98:99], v29 offset:6912
  v_mfma_f32_16x16x32_bf16 v[160:163], v[136:139], v[116:119], v[160:163]
  ds_read_b64_tr_b16 v[100:101], v30 offset:6144
  ds_read_b64_tr_b16 v[102:103], v30 offset:6912
  v_mfma_f32_16x16x32_bf16 v[152:155], v[140:143], v[112:115], v[152:155]
  v_mfma_f32_16x16x32_bf16 v[164:167], v[140:143], v[116:119], v[164:167]
  s_waitcnt lgkmcnt(0)
  s_barrier
  v_add_u32 v26, 0x19000, v20
  v_add_u32 v27, 0x19000, v21
  v_add_u32 v28, 0x19000, v22
  v_add_u32 v29, 0x19000, v23
  v_add_u32 v30, 0x19000, v24
  v_mfma_f32_16x16x32_bf16 v[144:147], v[80:83], v[64:67], v[144:147]
  ds_read_b128 v[104:107], v26 offset:0
  v_mfma_f32_16x16x32_bf16 v[156:159], v[80:83], v[68:71], v[156:159]
  ds_read_b128 v[108:111], v26 offset:2048
  ds_read_b64_tr_b16 v[120:121], v28 offset:0
  v_mfma_f32_16x16x32_bf16 v[148:151], v[84:87], v[64:67], v[148:151]
  ds_read_b64_tr_b16 v[122:123], v28 offset:768
  v_mfma_f32_16x16x32_bf16 v[160:163], v[84:87], v[68:71], v[160:163]
  ds_read_b64_tr_b16 v[124:125], v29 offset:0
  ds_read_b64_tr_b16 v[126:127], v29 offset:768
  v_mfma_f32_16x16x32_bf16 v[152:155], v[88:91], v[64:67], v[152:155]
  ds_read_b64_tr_b16 v[128:129], v30 offset:0
  ds_read_b64_tr_b16 v[130:131], v30 offset:768
  v_mfma_f32_16x16x32_bf16 v[164:167], v[88:91], v[68:71], v[164:167]
  ds_read_b128 v[112:115], v27 offset:0
  v_mfma_f32_16x16x32_bf16 v[144:147], v[92:95], v[72:75], v[144:147]
  ds_read_b128 v[116:119], v27 offset:2048
  ds_read_b64_tr_b16 v[132:133], v28 offset:6144
  v_mfma_f32_16x16x32_bf16 v[156:159], v[92:95], v[76:79], v[156:159]
  ds_read_b64_tr_b16 v[134:135], v28 offset:6912
  v_mfma_f32_16x16x32_bf16 v[148:151], v[96:99], v[72:75], v[148:151]
  ds_read_b64_tr_b16 v[136:137], v29 offset:6144
  ds_read_b64_tr_b16 v[138:139], v29 offset:6912
  v_mfma_f32_16x16x32_bf16 v[160:163], v[96:99], v[76:79], v[160:163]
  ds_read_b64_tr_b16 v[140:141], v30 offset:6144
  ds_read_b64_tr_b16 v[142:143], v30 offset:6912
  v_mfma_f32_16x16x32_bf16 v[152:155], v[100:103], v[72:75], v[152:155]
  v_mfma_f32_16x16x32_bf16 v[164:167], v[100:103], v[76:79], v[164:167]
  s_waitcnt lgkmcnt(0)
  s_barrier
  v_add_u32 v26, 0x1e000, v20
  v_add_u32 v27, 0x1e000, v21
  v_add_u32 v28, 0x1e000, v22
  v_add_u32 v29, 0x1e000, v23
  v_add_u32 v30, 0x1e000, v24
  v_mfma_f32_16x16x32_bf16 v[144:147], v[120:123], v[104:107], v[144:147]
  ds_read_b128 v[64:67], v26 offset:0
  v_mfma_f32_16x16x32_bf16 v[156:159], v[120:123], v[108:111], v[156:159]
  ds_read_b128 v[68:71], v26 offset:2048
  ds_read_b64_tr_b16 v[80:81], v28 offset:0
  v_mfma_f32_16x16x32_bf16 v[148:151], v[124:127], v[104:107], v[148:151]
  ds_read_b64_tr_b16 v[82:83], v28 offset:768
  v_mfma_f32_16x16x32_bf16 v[160:163], v[124:127], v[108:111], v[160:163]
  ds_read_b64_tr_b16 v[84:85], v29 offset:0
  ds_read_b64_tr_b16 v[86:87], v29 offset:768
  v_mfma_f32_16x16x32_bf16 v[152:155], v[128:131], v[104:107], v[152:155]
  ds_read_b64_tr_b16 v[88:89], v30 offset:0
  ds_read_b64_tr_b16 v[90:91], v30 offset:768
  v_mfma_f32_16x16x32_bf16 v[164:167], v[128:131], v[108:111], v[164:167]
  ds_read_b128 v[72:75], v27 offset:0
  v_mfma_f32_16x16x32_bf16 v[144:147], v[132:135], v[112:115], v[144:147]
  ds_read_b128 v[76:79], v27 offset:2048
  ds_read_b64_tr_b16 v[92:93], v28 offset:6144
  v_mfma_f32_16x16x32_bf16 v[156:159], v[132:135], v[116:119], v[156:159]
  ds_read_b64_tr_b16 v[94:95], v28 offset:6912
  v_mfma_f32_16x16x32_bf16 v[148:151], v[136:139], v[112:115], v[148:151]
  ds_read_b64_tr_b16 v[96:97], v29 offset:6144
  ds_read_b64_tr_b16 v[98:99], v29 offset:6912
  v_mfma_f32_16x16x32_bf16 v[160:163], v[136:139], v[116:119], v[160:163]
  ds_read_b64_tr_b16 v[100:101], v30 offset:6144
  ds_read_b64_tr_b16 v[102:103], v30 offset:6912
  v_mfma_f32_16x16x32_bf16 v[152:155], v[140:143], v[112:115], v[152:155]
  v_mfma_f32_16x16x32_bf16 v[164:167], v[140:143], v[116:119], v[164:167]
  s_waitcnt lgkmcnt(0)
  s_barrier
  v_add_u32 v26, 0x23000, v20
  v_add_u32 v27, 0x23000, v21
  v_add_u32 v28, 0x23000, v22
  v_add_u32 v29, 0x23000, v23
  v_add_u32 v30, 0x23000, v24
  v_mfma_f32_16x16x32_bf16 v[144:147], v[80:83], v[64:67], v[144:147]
  ds_read_b128 v[104:107], v26 offset:0
  v_mfma_f32_16x16x32_bf16 v[156:159], v[80:83], v[68:71], v[156:159]
  ds_read_b128 v[108:111], v26 offset:2048
  ds_read_b64_tr_b16 v[120:121], v28 offset:0
  v_mfma_f32_16x16x32_bf16 v[148:151], v[84:87], v[64:67], v[148:151]
  ds_read_b64_tr_b16 v[122:123], v28 offset:768
  v_mfma_f32_16x16x32_bf16 v[160:163], v[84:87], v[68:71], v[160:163]
  ds_read_b64_tr_b16 v[124:125], v29 offset:0
  ds_read_b64_tr_b16 v[126:127], v29 offset:768
  v_mfma_f32_16x16x32_bf16 v[152:155], v[88:91], v[64:67], v[152:155]
  ds_read_b64_tr_b16 v[128:129], v30 offset:0
  ds_read_b64_tr_b16 v[130:131], v30 offset:768
  v_mfma_f32_16x16x32_bf16 v[164:167], v[88:91], v[68:71], v[164:167]
  ds_read_b128 v[112:115], v27 offset:0
  v_mfma_f32_16x16x32_bf16 v[144:147], v[92:95], v[72:75], v[144:147]
  ds_read_b128 v[116:119], v27 offset:2048
  ds_read_b64_tr_b16 v[132:133], v28 offset:6144
  v_mfma_f32_16x16x32_bf16 v[156:159], v[92:95], v[76:79], v[156:159]
  ds_read_b64_tr_b16 v[134:135], v28 offset:6912
  v_mfma_f32_16x16x32_bf16 v[148:151], v[96:99], v[72:75], v[148:151]
  ds_read_b64_tr_b16 v[136:137], v29 offset:6144
  ds_read_b64_tr_b16 v[138:139], v29 offset:6912
  v_mfma_f32_16x16x32_bf16 v[160:163], v[96:99], v[76:79], v[160:163]
  ds_read_b64_tr_b16 v[140:141], v30 offset:6144
  ds_read_b64_tr_b16 v[142:143], v30 offset:6912
  v_mfma_f32_16x16x32_bf16 v[152:155], v[100:103], v[72:75], v[152:155]
  v_mfma_f32_16x16x32_bf16 v[164:167], v[100:103], v[76:79], v[164:167]
  s_waitcnt lgkmcnt(0)
  s_barrier
  v_mfma_f32_16x16x32_bf16 v[144:147], v[120:123], v[104:107], v[144:147]
  ds_read_b128 v[64:67], v20 offset:0
  v_mfma_f32_16x16x32_bf16 v[156:159], v[120:123], v[108:111], v[156:159]
  ds_read_b128 v[68:71], v20 offset:2048
  ds_read_b64_tr_b16 v[80:81], v22 offset:0
  v_mfma_f32_16x16x32_bf16 v[148:151], v[124:127], v[104:107], v[148:151]
  ds_read_b64_tr_b16 v[82:83], v22 offset:768
  v_mfma_f32_16x16x32_bf16 v[160:163], v[124:127], v[108:111], v[160:163]
  ds_read_b64_tr_b16 v[84:85], v23 offset:0
  ds_read_b64_tr_b16 v[86:87], v23 offset:768
  v_mfma_f32_16x16x32_bf16 v[152:155], v[128:131], v[104:107], v[152:155]
  ds_read_b64_tr_b16 v[88:89], v24 offset:0
  ds_read_b64_tr_b16 v[90:91], v24 offset:768
  v_mfma_f32_16x16x32_bf16 v[164:167], v[128:131], v[108:111], v[164:167]
  ds_read_b128 v[72:75], v21 offset:0
  v_mfma_f32_16x16x32_bf16 v[144:147], v[132:135], v[112:115], v[144:147]
  ds_read_b128 v[76:79], v21 offset:2048
  ds_read_b64_tr_b16 v[92:93], v22 offset:6144
  v_mfma_f32_16x16x32_bf16 v[156:159], v[132:135], v[116:119], v[156:159]
  ds_read_b64_tr_b16 v[94:95], v22 offset:6912
  v_mfma_f32_16x16x32_bf16 v[148:151], v[136:139], v[112:115], v[148:151]
  ds_read_b64_tr_b16 v[96:97], v23 offset:6144
  ds_read_b64_tr_b16 v[98:99], v23 offset:6912
  v_mfma_f32_16x16x32_bf16 v[160:163], v[136:139], v[116:119], v[160:163]
  ds_read_b64_tr_b16 v[100:101], v24 offset:6144
  ds_read_b64_tr_b16 v[102:103], v24 offset:6912
  v_mfma_f32_16x16x32_bf16 v[152:155], v[140:143], v[112:115], v[152:155]
  v_mfma_f32_16x16x32_bf16 v[164:167], v[140:143], v[116:119], v[164:167]
  s_waitcnt lgkmcnt(0)
  s_barrier
  v_add_u32 v26, 0x5000, v20
  v_add_u32 v27, 0x5000, v21
  v_add_u32 v28, 0x5000, v22
  v_add_u32 v29, 0x5000, v23
  v_add_u32 v30, 0x5000, v24
  v_mfma_f32_16x16x32_bf16 v[144:147], v[80:83], v[64:67], v[144:147]
  ds_read_b128 v[104:107], v26 offset:0
  v_mfma_f32_16x16x32_bf16 v[156:159], v[80:83], v[68:71], v[156:159]
  ds_read_b128 v[108:111], v26 offset:2048
  ds_read_b64_tr_b16 v[120:121], v28 offset:0
  v_mfma_f32_16x16x32_bf16 v[148:151], v[84:87], v[64:67], v[148:151]
  ds_read_b64_tr_b16 v[122:123], v28 offset:768
  v_mfma_f32_16x16x32_bf16 v[160:163], v[84:87], v[68:71], v[160:163]
  ds_read_b64_tr_b16 v[124:125], v29 offset:0
  ds_read_b64_tr_b16 v[126:127], v29 offset:768
  v_mfma_f32_16x16x32_bf16 v[152:155], v[88:91], v[64:67], v[152:155]
  ds_read_b64_tr_b16 v[128:129], v30 offset:0
  ds_read_b64_tr_b16 v[130:131], v30 offset:768
  v_mfma_f32_16x16x32_bf16 v[164:167], v[88:91], v[68:71], v[164:167]
  ds_read_b128 v[112:115], v27 offset:0
  v_mfma_f32_16x16x32_bf16 v[144:147], v[92:95], v[72:75], v[144:147]
  ds_read_b128 v[116:119], v27 offset:2048
  ds_read_b64_tr_b16 v[132:133], v28 offset:6144
  v_mfma_f32_16x16x32_bf16 v[156:159], v[92:95], v[76:79], v[156:159]
  ds_read_b64_tr_b16 v[134:135], v28 offset:6912
  v_mfma_f32_16x16x32_bf16 v[148:151], v[96:99], v[72:75], v[148:151]
  ds_read_b64_tr_b16 v[136:137], v29 offset:6144
  ds_read_b64_tr_b16 v[138:139], v29 offset:6912
  v_mfma_f32_16x16x32_bf16 v[160:163], v[96:99], v[76:79], v[160:163]
  ds_read_b64_tr_b16 v[140:141], v30 offset:6144
  ds_read_b64_tr_b16 v[142:143], v30 offset:6912
  v_mfma_f32_16x16x32_bf16 v[152:155], v[100:103], v[72:75], v[152:155]
  v_mfma_f32_16x16x32_bf16 v[164:167], v[100:103], v[76:79], v[164:167]
  s_waitcnt lgkmcnt(0)
  s_barrier
  v_add_u32 v26, 0xa000, v20
  v_add_u32 v27, 0xa000, v21
  v_add_u32 v28, 0xa000, v22
  v_add_u32 v29, 0xa000, v23
  v_add_u32 v30, 0xa000, v24
  v_mfma_f32_16x16x32_bf16 v[144:147], v[120:123], v[104:107], v[144:147]
  ds_read_b128 v[64:67], v26 offset:0
  v_mfma_f32_16x16x32_bf16 v[156:159], v[120:123], v[108:111], v[156:159]
  ds_read_b128 v[68:71], v26 offset:2048
  ds_read_b64_tr_b16 v[80:81], v28 offset:0
  v_mfma_f32_16x16x32_bf16 v[148:151], v[124:127], v[104:107], v[148:151]
  ds_read_b64_tr_b16 v[82:83], v28 offset:768
  v_mfma_f32_16x16x32_bf16 v[160:163], v[124:127], v[108:111], v[160:163]
  ds_read_b64_tr_b16 v[84:85], v29 offset:0
  ds_read_b64_tr_b16 v[86:87], v29 offset:768
  v_mfma_f32_16x16x32_bf16 v[152:155], v[128:131], v[104:107], v[152:155]
  ds_read_b64_tr_b16 v[88:89], v30 offset:0
  ds_read_b64_tr_b16 v[90:91], v30 offset:768
  v_mfma_f32_16x16x32_bf16 v[164:167], v[128:131], v[108:111], v[164:167]
  ds_read_b128 v[72:75], v27 offset:0
  v_mfma_f32_16x16x32_bf16 v[144:147], v[132:135], v[112:115], v[144:147]
  ds_read_b128 v[76:79], v27 offset:2048
  ds_read_b64_tr_b16 v[92:93], v28 offset:6144
  v_mfma_f32_16x16x32_bf16 v[156:159], v[132:135], v[116:119], v[156:159]
  ds_read_b64_tr_b16 v[94:95], v28 offset:6912
  v_mfma_f32_16x16x32_bf16 v[148:151], v[136:139], v[112:115], v[148:151]
  ds_read_b64_tr_b16 v[96:97], v29 offset:6144
  ds_read_b64_tr_b16 v[98:99], v29 offset:6912
  v_mfma_f32_16x16x32_bf16 v[160:163], v[136:139], v[116:119], v[160:163]
  ds_read_b64_tr_b16 v[100:101], v30 offset:6144
  ds_read_b64_tr_b16 v[102:103], v30 offset:6912
  v_mfma_f32_16x16x32_bf16 v[152:155], v[140:143], v[112:115], v[152:155]
  v_mfma_f32_16x16x32_bf16 v[164:167], v[140:143], v[116:119], v[164:167]
  s_waitcnt lgkmcnt(0)
  s_barrier
  v_add_u32 v26, 0xf000, v20
  v_add_u32 v27, 0xf000, v21
  v_add_u32 v28, 0xf000, v22
  v_add_u32 v29, 0xf000, v23
  v_add_u32 v30, 0xf000, v24
  v_mfma_f32_16x16x32_bf16 v[144:147], v[80:83], v[64:67], v[144:147]
  ds_read_b128 v[104:107], v26 offset:0
  v_mfma_f32_16x16x32_bf16 v[156:159], v[80:83], v[68:71], v[156:159]
  ds_read_b128 v[108:111], v26 offset:2048
  ds_read_b64_tr_b16 v[120:121], v28 offset:0
  v_mfma_f32_16x16x32_bf16 v[148:151], v[84:87], v[64:67], v[148:151]
  ds_read_b64_tr_b16 v[122:123], v28 offset:768
  v_mfma_f32_16x16x32_bf16 v[160:163], v[84:87], v[68:71], v[160:163]
  ds_read_b64_tr_b16 v[124:125], v29 offset:0
  ds_read_b64_tr_b16 v[126:127], v29 offset:768
  v_mfma_f32_16x16x32_bf16 v[152:155], v[88:91], v[64:67], v[152:155]
  ds_read_b64_tr_b16 v[128:129], v30 offset:0
  ds_read_b64_tr_b16 v[130:131], v30 offset:768
  v_mfma_f32_16x16x32_bf16 v[164:167], v[88:91], v[68:71], v[164:167]
  ds_read_b128 v[112:115], v27 offset:0
  v_mfma_f32_16x16x32_bf16 v[144:147], v[92:95], v[72:75], v[144:147]
  ds_read_b128 v[116:119], v27 offset:2048
  ds_read_b64_tr_b16 v[132:133], v28 offset:6144
  v_mfma_f32_16x16x32_bf16 v[156:159], v[92:95], v[76:79], v[156:159]
  ds_read_b64_tr_b16 v[134:135], v28 offset:6912
  v_mfma_f32_16x16x32_bf16 v[148:151], v[96:99], v[72:75], v[148:151]
  ds_read_b64_tr_b16 v[136:137], v29 offset:6144
  ds_read_b64_tr_b16 v[138:139], v29 offset:6912
  v_mfma_f32_16x16x32_bf16 v[160:163], v[96:99], v[76:79], v[160:163]
  ds_read_b64_tr_b16 v[140:141], v30 offset:6144
  ds_read_b64_tr_b16 v[142:143], v30 offset:6912
  v_mfma_f32_16x16x32_bf16 v[152:155], v[100:103], v[72:75], v[152:155]
  v_mfma_f32_16x16x32_bf16 v[164:167], v[100:103], v[76:79], v[164:167]
  s_waitcnt lgkmcnt(0)
  s_barrier
  v_add_u32 v26, 0x14000, v20
  v_add_u32 v27, 0x14000, v21
  v_add_u32 v28, 0x14000, v22
  v_add_u32 v29, 0x14000, v23
  v_add_u32 v30, 0x14000, v24
  v_mfma_f32_16x16x32_bf16 v[144:147], v[120:123], v[104:107], v[144:147]
  ds_read_b128 v[64:67], v26 offset:0
  v_mfma_f32_16x16x32_bf16 v[156:159], v[120:123], v[108:111], v[156:159]
  ds_read_b128 v[68:71], v26 offset:2048
  ds_read_b64_tr_b16 v[80:81], v28 offset:0
  v_mfma_f32_16x16x32_bf16 v[148:151], v[124:127], v[104:107], v[148:151]
  ds_read_b64_tr_b16 v[82:83], v28 offset:768
  v_mfma_f32_16x16x32_bf16 v[160:163], v[124:127], v[108:111], v[160:163]
  ds_read_b64_tr_b16 v[84:85], v29 offset:0
  ds_read_b64_tr_b16 v[86:87], v29 offset:768
  v_mfma_f32_16x16x32_bf16 v[152:155], v[128:131], v[104:107], v[152:155]
  ds_read_b64_tr_b16 v[88:89], v30 offset:0
  ds_read_b64_tr_b16 v[90:91], v30 offset:768
  v_mfma_f32_16x16x32_bf16 v[164:167], v[128:131], v[108:111], v[164:167]
  ds_read_b128 v[72:75], v27 offset:0
  v_mfma_f32_16x16x32_bf16 v[144:147], v[132:135], v[112:115], v[144:147]
  ds_read_b128 v[76:79], v27 offset:2048
  ds_read_b64_tr_b16 v[92:93], v28 offset:6144
  v_mfma_f32_16x16x32_bf16 v[156:159], v[132:135], v[116:119], v[156:159]
  ds_read_b64_tr_b16 v[94:95], v28 offset:6912
  v_mfma_f32_16x16x32_bf16 v[148:151], v[136:139], v[112:115], v[148:151]
  ds_read_b64_tr_b16 v[96:97], v29 offset:6144
  ds_read_b64_tr_b16 v[98:99], v29 offset:6912
  v_mfma_f32_16x16x32_bf16 v[160:163], v[136:139], v[116:119], v[160:163]
  ds_read_b64_tr_b16 v[100:101], v30 offset:6144
  ds_read_b64_tr_b16 v[102:103], v30 offset:6912
  v_mfma_f32_16x16x32_bf16 v[152:155], v[140:143], v[112:115], v[152:155]
  v_mfma_f32_16x16x32_bf16 v[164:167], v[140:143], v[116:119], v[164:167]
  s_waitcnt lgkmcnt(0)
  s_barrier
  v_add_u32 v26, 0x19000, v20
  v_add_u32 v27, 0x19000, v21
  v_add_u32 v28, 0x19000, v22
  v_add_u32 v29, 0x19000, v23
  v_add_u32 v30, 0x19000, v24
  v_mfma_f32_16x16x32_bf16 v[144:147], v[80:83], v[64:67], v[144:147]
  ds_read_b128 v[104:107], v26 offset:0
  v_mfma_f32_16x16x32_bf16 v[156:159], v[80:83], v[68:71], v[156:159]
  ds_read_b128 v[108:111], v26 offset:2048
  ds_read_b64_tr_b16 v[120:121], v28 offset:0
  v_mfma_f32_16x16x32_bf16 v[148:151], v[84:87], v[64:67], v[148:151]
  ds_read_b64_tr_b16 v[122:123], v28 offset:768
  v_mfma_f32_16x16x32_bf16 v[160:163], v[84:87], v[68:71], v[160:163]
  ds_read_b64_tr_b16 v[124:125], v29 offset:0
  ds_read_b64_tr_b16 v[126:127], v29 offset:768
  v_mfma_f32_16x16x32_bf16 v[152:155], v[88:91], v[64:67], v[152:155]
  ds_read_b64_tr_b16 v[128:129], v30 offset:0
  ds_read_b64_tr_b16 v[130:131], v30 offset:768
  v_mfma_f32_16x16x32_bf16 v[164:167], v[88:91], v[68:71], v[164:167]
  ds_read_b128 v[112:115], v27 offset:0
  v_mfma_f32_16x16x32_bf16 v[144:147], v[92:95], v[72:75], v[144:147]
  ds_read_b128 v[116:119], v27 offset:2048
  ds_read_b64_tr_b16 v[132:133], v28 offset:6144
  v_mfma_f32_16x16x32_bf16 v[156:159], v[92:95], v[76:79], v[156:159]
  ds_read_b64_tr_b16 v[134:135], v28 offset:6912
  v_mfma_f32_16x16x32_bf16 v[148:151], v[96:99], v[72:75], v[148:151]
  ds_read_b64_tr_b16 v[136:137], v29 offset:6144
  ds_read_b64_tr_b16 v[138:139], v29 offset:6912
  v_mfma_f32_16x16x32_bf16 v[160:163], v[96:99], v[76:79], v[160:163]
  ds_read_b64_tr_b16 v[140:141], v30 offset:6144
  ds_read_b64_tr_b16 v[142:143], v30 offset:6912
  v_mfma_f32_16x16x32_bf16 v[152:155], v[100:103], v[72:75], v[152:155]
  v_mfma_f32_16x16x32_bf16 v[164:167], v[100:103], v[76:79], v[164:167]
  s_waitcnt lgkmcnt(0)
  s_barrier
  v_add_u32 v26, 0x1e000, v20
  v_add_u32 v27, 0x1e000, v21
  v_add_u32 v28, 0x1e000, v22
  v_add_u32 v29, 0x1e000, v23
  v_add_u32 v30, 0x1e000, v24
  v_mfma_f32_16x16x32_bf16 v[144:147], v[120:123], v[104:107], v[144:147]
  ds_read_b128 v[64:67], v26 offset:0
  v_mfma_f32_16x16x32_bf16 v[156:159], v[120:123], v[108:111], v[156:159]
  ds_read_b128 v[68:71], v26 offset:2048
  ds_read_b64_tr_b16 v[80:81], v28 offset:0
  v_mfma_f32_16x16x32_bf16 v[148:151], v[124:127], v[104:107], v[148:151]
  ds_read_b64_tr_b16 v[82:83], v28 offset:768
  v_mfma_f32_16x16x32_bf16 v[160:163], v[124:127], v[108:111], v[160:163]
  ds_read_b64_tr_b16 v[84:85], v29 offset:0
  ds_read_b64_tr_b16 v[86:87], v29 offset:768
  v_mfma_f32_16x16x32_bf16 v[152:155], v[128:131], v[104:107], v[152:155]
  ds_read_b64_tr_b16 v[88:89], v30 offset:0
  ds_read_b64_tr_b16 v[90:91], v30 offset:768
  v_mfma_f32_16x16x32_bf16 v[164:167], v[128:131], v[108:111], v[164:167]
  ds_read_b128 v[72:75], v27 offset:0
  v_mfma_f32_16x16x32_bf16 v[144:147], v[132:135], v[112:115], v[144:147]
  ds_read_b128 v[76:79], v27 offset:2048
  ds_read_b64_tr_b16 v[92:93], v28 offset:6144
  v_mfma_f32_16x16x32_bf16 v[156:159], v[132:135], v[116:119], v[156:159]
  ds_read_b64_tr_b16 v[94:95], v28 offset:6912
  v_mfma_f32_16x16x32_bf16 v[148:151], v[136:139], v[112:115], v[148:151]
  ds_read_b64_tr_b16 v[96:97], v29 offset:6144
  ds_read_b64_tr_b16 v[98:99], v29 offset:6912
  v_mfma_f32_16x16x32_bf16 v[160:163], v[136:139], v[116:119], v[160:163]
  ds_read_b64_tr_b16 v[100:101], v30 offset:6144
  ds_read_b64_tr_b16 v[102:103], v30 offset:6912
  v_mfma_f32_16x16x32_bf16 v[152:155], v[140:143], v[112:115], v[152:155]
  v_mfma_f32_16x16x32_bf16 v[164:167], v[140:143], v[116:119], v[164:167]
  s_waitcnt lgkmcnt(0)
  s_barrier
  v_add_u32 v26, 0x23000, v20
  v_add_u32 v27, 0x23000, v21
  v_add_u32 v28, 0x23000, v22
  v_add_u32 v29, 0x23000, v23
  v_add_u32 v30, 0x23000, v24
  v_mfma_f32_16x16x32_bf16 v[144:147], v[80:83], v[64:67], v[144:147]
  ds_read_b128 v[104:107], v26 offset:0
  v_mfma_f32_16x16x32_bf16 v[156:159], v[80:83], v[68:71], v[156:159]
  ds_read_b128 v[108:111], v26 offset:2048
  ds_read_b64_tr_b16 v[120:121], v28 offset:0
  v_mfma_f32_16x16x32_bf16 v[148:151], v[84:87], v[64:67], v[148:151]
  ds_read_b64_tr_b16 v[122:123], v28 offset:768
  v_mfma_f32_16x16x32_bf16 v[160:163], v[84:87], v[68:71], v[160:163]
  ds_read_b64_tr_b16 v[124:125], v29 offset:0
  ds_read_b64_tr_b16 v[126:127], v29 offset:768
  v_mfma_f32_16x16x32_bf16 v[152:155], v[88:91], v[64:67], v[152:155]
  ds_read_b64_tr_b16 v[128:129], v30 offset:0
  ds_read_b64_tr_b16 v[130:131], v30 offset:768
  v_mfma_f32_16x16x32_bf16 v[164:167], v[88:91], v[68:71], v[164:167]
  ds_read_b128 v[112:115], v27 offset:0
  v_mfma_f32_16x16x32_bf16 v[144:147], v[92:95], v[72:75], v[144:147]
  ds_read_b128 v[116:119], v27 offset:2048
  ds_read_b64_tr_b16 v[132:133], v28 offset:6144
  v_mfma_f32_16x16x32_bf16 v[156:159], v[92:95], v[76:79], v[156:159]
  ds_read_b64_tr_b16 v[134:135], v28 offset:6912
  v_mfma_f32_16x16x32_bf16 v[148:151], v[96:99], v[72:75], v[148:151]
  ds_read_b64_tr_b16 v[136:137], v29 offset:6144
  ds_read_b64_tr_b16 v[138:139], v29 offset:6912
  v_mfma_f32_16x16x32_bf16 v[160:163], v[96:99], v[76:79], v[160:163]
  ds_read_b64_tr_b16 v[140:141], v30 offset:6144
  ds_read_b64_tr_b16 v[142:143], v30 offset:6912
  v_mfma_f32_16x16x32_bf16 v[152:155], v[100:103], v[72:75], v[152:155]
  v_mfma_f32_16x16x32_bf16 v[164:167], v[100:103], v[76:79], v[164:167]
  s_waitcnt lgkmcnt(0)
  s_barrier
  v_mfma_f32_16x16x32_bf16 v[144:147], v[120:123], v[104:107], v[144:147]
  ds_read_b128 v[64:67], v20 offset:0
  v_mfma_f32_16x16x32_bf16 v[156:159], v[120:123], v[108:111], v[156:159]
  ds_read_b128 v[68:71], v20 offset:2048
  ds_read_b64_tr_b16 v[80:81], v22 offset:0
  v_mfma_f32_16x16x32_bf16 v[148:151], v[124:127], v[104:107], v[148:151]
  ds_read_b64_tr_b16 v[82:83], v22 offset:768
  v_mfma_f32_16x16x32_bf16 v[160:163], v[124:127], v[108:111], v[160:163]
  ds_read_b64_tr_b16 v[84:85], v23 offset:0
  ds_read_b64_tr_b16 v[86:87], v23 offset:768
  v_mfma_f32_16x16x32_bf16 v[152:155], v[128:131], v[104:107], v[152:155]
  ds_read_b64_tr_b16 v[88:89], v24 offset:0
  ds_read_b64_tr_b16 v[90:91], v24 offset:768
  v_mfma_f32_16x16x32_bf16 v[164:167], v[128:131], v[108:111], v[164:167]
  ds_read_b128 v[72:75], v21 offset:0
  v_mfma_f32_16x16x32_bf16 v[144:147], v[132:135], v[112:115], v[144:147]
  ds_read_b128 v[76:79], v21 offset:2048
  ds_read_b64_tr_b16 v[92:93], v22 offset:6144
  v_mfma_f32_16x16x32_bf16 v[156:159], v[132:135], v[116:119], v[156:159]
  ds_read_b64_tr_b16 v[94:95], v22 offset:6912
  v_mfma_f32_16x16x32_bf16 v[148:151], v[136:139], v[112:115], v[148:151]
  ds_read_b64_tr_b16 v[96:97], v23 offset:6144
  ds_read_b64_tr_b16 v[98:99], v23 offset:6912
  v_mfma_f32_16x16x32_bf16 v[160:163], v[136:139], v[116:119], v[160:163]
  ds_read_b64_tr_b16 v[100:101], v24 offset:6144
  ds_read_b64_tr_b16 v[102:103], v24 offset:6912
  v_mfma_f32_16x16x32_bf16 v[152:155], v[140:143], v[112:115], v[152:155]
  v_mfma_f32_16x16x32_bf16 v[164:167], v[140:143], v[116:119], v[164:167]
  s_waitcnt lgkmcnt(0)
  s_barrier
  v_add_u32 v26, 0x5000, v20
  v_add_u32 v27, 0x5000, v21
  v_add_u32 v28, 0x5000, v22
  v_add_u32 v29, 0x5000, v23
  v_add_u32 v30, 0x5000, v24
  v_mfma_f32_16x16x32_bf16 v[144:147], v[80:83], v[64:67], v[144:147]
  ds_read_b128 v[104:107], v26 offset:0
  v_mfma_f32_16x16x32_bf16 v[156:159], v[80:83], v[68:71], v[156:159]
  ds_read_b128 v[108:111], v26 offset:2048
  ds_read_b64_tr_b16 v[120:121], v28 offset:0
  v_mfma_f32_16x16x32_bf16 v[148:151], v[84:87], v[64:67], v[148:151]
  ds_read_b64_tr_b16 v[122:123], v28 offset:768
  v_mfma_f32_16x16x32_bf16 v[160:163], v[84:87], v[68:71], v[160:163]
  ds_read_b64_tr_b16 v[124:125], v29 offset:0
  ds_read_b64_tr_b16 v[126:127], v29 offset:768
  v_mfma_f32_16x16x32_bf16 v[152:155], v[88:91], v[64:67], v[152:155]
  ds_read_b64_tr_b16 v[128:129], v30 offset:0
  ds_read_b64_tr_b16 v[130:131], v30 offset:768
  v_mfma_f32_16x16x32_bf16 v[164:167], v[88:91], v[68:71], v[164:167]
  ds_read_b128 v[112:115], v27 offset:0
  v_mfma_f32_16x16x32_bf16 v[144:147], v[92:95], v[72:75], v[144:147]
  ds_read_b128 v[116:119], v27 offset:2048
  ds_read_b64_tr_b16 v[132:133], v28 offset:6144
  v_mfma_f32_16x16x32_bf16 v[156:159], v[92:95], v[76:79], v[156:159]
  ds_read_b64_tr_b16 v[134:135], v28 offset:6912
  v_mfma_f32_16x16x32_bf16 v[148:151], v[96:99], v[72:75], v[148:151]
  ds_read_b64_tr_b16 v[136:137], v29 offset:6144
  ds_read_b64_tr_b16 v[138:139], v29 offset:6912
  v_mfma_f32_16x16x32_bf16 v[160:163], v[96:99], v[76:79], v[160:163]
  ds_read_b64_tr_b16 v[140:141], v30 offset:6144
  ds_read_b64_tr_b16 v[142:143], v30 offset:6912
  v_mfma_f32_16x16x32_bf16 v[152:155], v[100:103], v[72:75], v[152:155]
  v_mfma_f32_16x16x32_bf16 v[164:167], v[100:103], v[76:79], v[164:167]
  s_waitcnt lgkmcnt(0)
  s_barrier
  v_add_u32 v26, 0xa000, v20
  v_add_u32 v27, 0xa000, v21
  v_add_u32 v28, 0xa000, v22
  v_add_u32 v29, 0xa000, v23
  v_add_u32 v30, 0xa000, v24
  v_mfma_f32_16x16x32_bf16 v[144:147], v[120:123], v[104:107], v[144:147]
  ds_read_b128 v[64:67], v26 offset:0
  v_mfma_f32_16x16x32_bf16 v[156:159], v[120:123], v[108:111], v[156:159]
  ds_read_b128 v[68:71], v26 offset:2048
  ds_read_b64_tr_b16 v[80:81], v28 offset:0
  v_mfma_f32_16x16x32_bf16 v[148:151], v[124:127], v[104:107], v[148:151]
  ds_read_b64_tr_b16 v[82:83], v28 offset:768
  v_mfma_f32_16x16x32_bf16 v[160:163], v[124:127], v[108:111], v[160:163]
  ds_read_b64_tr_b16 v[84:85], v29 offset:0
  ds_read_b64_tr_b16 v[86:87], v29 offset:768
  v_mfma_f32_16x16x32_bf16 v[152:155], v[128:131], v[104:107], v[152:155]
  ds_read_b64_tr_b16 v[88:89], v30 offset:0
  ds_read_b64_tr_b16 v[90:91], v30 offset:768
  v_mfma_f32_16x16x32_bf16 v[164:167], v[128:131], v[108:111], v[164:167]
  ds_read_b128 v[72:75], v27 offset:0
  v_mfma_f32_16x16x32_bf16 v[144:147], v[132:135], v[112:115], v[144:147]
  ds_read_b128 v[76:79], v27 offset:2048
  ds_read_b64_tr_b16 v[92:93], v28 offset:6144
  v_mfma_f32_16x16x32_bf16 v[156:159], v[132:135], v[116:119], v[156:159]
  ds_read_b64_tr_b16 v[94:95], v28 offset:6912
  v_mfma_f32_16x16x32_bf16 v[148:151], v[136:139], v[112:115], v[148:151]
  ds_read_b64_tr_b16 v[96:97], v29 offset:6144
  ds_read_b64_tr_b16 v[98:99], v29 offset:6912
  v_mfma_f32_16x16x32_bf16 v[160:163], v[136:139], v[116:119], v[160:163]
  ds_read_b64_tr_b16 v[100:101], v30 offset:6144
  ds_read_b64_tr_b16 v[102:103], v30 offset:6912
  v_mfma_f32_16x16x32_bf16 v[152:155], v[140:143], v[112:115], v[152:155]
  v_mfma_f32_16x16x32_bf16 v[164:167], v[140:143], v[116:119], v[164:167]
  s_waitcnt lgkmcnt(0)
  s_barrier
  v_add_u32 v26, 0xf000, v20
  v_add_u32 v27, 0xf000, v21
  v_add_u32 v28, 0xf000, v22
  v_add_u32 v29, 0xf000, v23
  v_add_u32 v30, 0xf000, v24
  v_mfma_f32_16x16x32_bf16 v[144:147], v[80:83], v[64:67], v[144:147]
  ds_read_b128 v[104:107], v26 offset:0
  v_mfma_f32_16x16x32_bf16 v[156:159], v[80:83], v[68:71], v[156:159]
  ds_read_b128 v[108:111], v26 offset:2048
  ds_read_b64_tr_b16 v[120:121], v28 offset:0
  v_mfma_f32_16x16x32_bf16 v[148:151], v[84:87], v[64:67], v[148:151]
  ds_read_b64_tr_b16 v[122:123], v28 offset:768
  v_mfma_f32_16x16x32_bf16 v[160:163], v[84:87], v[68:71], v[160:163]
  ds_read_b64_tr_b16 v[124:125], v29 offset:0
  ds_read_b64_tr_b16 v[126:127], v29 offset:768
  v_mfma_f32_16x16x32_bf16 v[152:155], v[88:91], v[64:67], v[152:155]
  ds_read_b64_tr_b16 v[128:129], v30 offset:0
  ds_read_b64_tr_b16 v[130:131], v30 offset:768
  v_mfma_f32_16x16x32_bf16 v[164:167], v[88:91], v[68:71], v[164:167]
  ds_read_b128 v[112:115], v27 offset:0
  v_mfma_f32_16x16x32_bf16 v[144:147], v[92:95], v[72:75], v[144:147]
  ds_read_b128 v[116:119], v27 offset:2048
  ds_read_b64_tr_b16 v[132:133], v28 offset:6144
  v_mfma_f32_16x16x32_bf16 v[156:159], v[92:95], v[76:79], v[156:159]
  ds_read_b64_tr_b16 v[134:135], v28 offset:6912
  v_mfma_f32_16x16x32_bf16 v[148:151], v[96:99], v[72:75], v[148:151]
  ds_read_b64_tr_b16 v[136:137], v29 offset:6144
  ds_read_b64_tr_b16 v[138:139], v29 offset:6912
  v_mfma_f32_16x16x32_bf16 v[160:163], v[96:99], v[76:79], v[160:163]
  ds_read_b64_tr_b16 v[140:141], v30 offset:6144
  ds_read_b64_tr_b16 v[142:143], v30 offset:6912
  v_mfma_f32_16x16x32_bf16 v[152:155], v[100:103], v[72:75], v[152:155]
  v_mfma_f32_16x16x32_bf16 v[164:167], v[100:103], v[76:79], v[164:167]
  s_waitcnt lgkmcnt(0)
  s_barrier
  v_add_u32 v26, 0x14000, v20
  v_add_u32 v27, 0x14000, v21
  v_add_u32 v28, 0x14000, v22
  v_add_u32 v29, 0x14000, v23
  v_add_u32 v30, 0x14000, v24
  v_mfma_f32_16x16x32_bf16 v[144:147], v[120:123], v[104:107], v[144:147]
  ds_read_b128 v[64:67], v26 offset:0
  v_mfma_f32_16x16x32_bf16 v[156:159], v[120:123], v[108:111], v[156:159]
  ds_read_b128 v[68:71], v26 offset:2048
  ds_read_b64_tr_b16 v[80:81], v28 offset:0
  v_mfma_f32_16x16x32_bf16 v[148:151], v[124:127], v[104:107], v[148:151]
  ds_read_b64_tr_b16 v[82:83], v28 offset:768
  v_mfma_f32_16x16x32_bf16 v[160:163], v[124:127], v[108:111], v[160:163]
  ds_read_b64_tr_b16 v[84:85], v29 offset:0
  ds_read_b64_tr_b16 v[86:87], v29 offset:768
  v_mfma_f32_16x16x32_bf16 v[152:155], v[128:131], v[104:107], v[152:155]
  ds_read_b64_tr_b16 v[88:89], v30 offset:0
  ds_read_b64_tr_b16 v[90:91], v30 offset:768
  v_mfma_f32_16x16x32_bf16 v[164:167], v[128:131], v[108:111], v[164:167]
  ds_read_b128 v[72:75], v27 offset:0
  v_mfma_f32_16x16x32_bf16 v[144:147], v[132:135], v[112:115], v[144:147]
  ds_read_b128 v[76:79], v27 offset:2048
  ds_read_b64_tr_b16 v[92:93], v28 offset:6144
  v_mfma_f32_16x16x32_bf16 v[156:159], v[132:135], v[116:119], v[156:159]
  ds_read_b64_tr_b16 v[94:95], v28 offset:6912
  v_mfma_f32_16x16x32_bf16 v[148:151], v[136:139], v[112:115], v[148:151]
  ds_read_b64_tr_b16 v[96:97], v29 offset:6144
  ds_read_b64_tr_b16 v[98:99], v29 offset:6912
  v_mfma_f32_16x16x32_bf16 v[160:163], v[136:139], v[116:119], v[160:163]
  ds_read_b64_tr_b16 v[100:101], v30 offset:6144
  ds_read_b64_tr_b16 v[102:103], v30 offset:6912
  v_mfma_f32_16x16x32_bf16 v[152:155], v[140:143], v[112:115], v[152:155]
  v_mfma_f32_16x16x32_bf16 v[164:167], v[140:143], v[116:119], v[164:167]
  s_waitcnt lgkmcnt(0)
  s_barrier
  v_add_u32 v26, 0x19000, v20
  v_add_u32 v27, 0x19000, v21
  v_add_u32 v28, 0x19000, v22
  v_add_u32 v29, 0x19000, v23
  v_add_u32 v30, 0x19000, v24
  v_mfma_f32_16x16x32_bf16 v[144:147], v[80:83], v[64:67], v[144:147]
  ds_read_b128 v[104:107], v26 offset:0
  v_mfma_f32_16x16x32_bf16 v[156:159], v[80:83], v[68:71], v[156:159]
  ds_read_b128 v[108:111], v26 offset:2048
  ds_read_b64_tr_b16 v[120:121], v28 offset:0
  v_mfma_f32_16x16x32_bf16 v[148:151], v[84:87], v[64:67], v[148:151]
  ds_read_b64_tr_b16 v[122:123], v28 offset:768
  v_mfma_f32_16x16x32_bf16 v[160:163], v[84:87], v[68:71], v[160:163]
  ds_read_b64_tr_b16 v[124:125], v29 offset:0
  ds_read_b64_tr_b16 v[126:127], v29 offset:768
  v_mfma_f32_16x16x32_bf16 v[152:155], v[88:91], v[64:67], v[152:155]
  ds_read_b64_tr_b16 v[128:129], v30 offset:0
  ds_read_b64_tr_b16 v[130:131], v30 offset:768
  v_mfma_f32_16x16x32_bf16 v[164:167], v[88:91], v[68:71], v[164:167]
  ds_read_b128 v[112:115], v27 offset:0
  v_mfma_f32_16x16x32_bf16 v[144:147], v[92:95], v[72:75], v[144:147]
  ds_read_b128 v[116:119], v27 offset:2048
  ds_read_b64_tr_b16 v[132:133], v28 offset:6144
  v_mfma_f32_16x16x32_bf16 v[156:159], v[92:95], v[76:79], v[156:159]
  ds_read_b64_tr_b16 v[134:135], v28 offset:6912
  v_mfma_f32_16x16x32_bf16 v[148:151], v[96:99], v[72:75], v[148:151]
  ds_read_b64_tr_b16 v[136:137], v29 offset:6144
  ds_read_b64_tr_b16 v[138:139], v29 offset:6912
  v_mfma_f32_16x16x32_bf16 v[160:163], v[96:99], v[76:79], v[160:163]
  ds_read_b64_tr_b16 v[140:141], v30 offset:6144
  ds_read_b64_tr_b16 v[142:143], v30 offset:6912
  v_mfma_f32_16x16x32_bf16 v[152:155], v[100:103], v[72:75], v[152:155]
  v_mfma_f32_16x16x32_bf16 v[164:167], v[100:103], v[76:79], v[164:167]
  s_waitcnt lgkmcnt(0)
  s_barrier
  v_add_u32 v26, 0x1e000, v20
  v_add_u32 v27, 0x1e000, v21
  v_add_u32 v28, 0x1e000, v22
  v_add_u32 v29, 0x1e000, v23
  v_add_u32 v30, 0x1e000, v24
  v_mfma_f32_16x16x32_bf16 v[144:147], v[120:123], v[104:107], v[144:147]
  ds_read_b128 v[64:67], v26 offset:0
  v_mfma_f32_16x16x32_bf16 v[156:159], v[120:123], v[108:111], v[156:159]
  ds_read_b128 v[68:71], v26 offset:2048
  ds_read_b64_tr_b16 v[80:81], v28 offset:0
  v_mfma_f32_16x16x32_bf16 v[148:151], v[124:127], v[104:107], v[148:151]
  ds_read_b64_tr_b16 v[82:83], v28 offset:768
  v_mfma_f32_16x16x32_bf16 v[160:163], v[124:127], v[108:111], v[160:163]
  ds_read_b64_tr_b16 v[84:85], v29 offset:0
  ds_read_b64_tr_b16 v[86:87], v29 offset:768
  v_mfma_f32_16x16x32_bf16 v[152:155], v[128:131], v[104:107], v[152:155]
  ds_read_b64_tr_b16 v[88:89], v30 offset:0
  ds_read_b64_tr_b16 v[90:91], v30 offset:768
  v_mfma_f32_16x16x32_bf16 v[164:167], v[128:131], v[108:111], v[164:167]
  ds_read_b128 v[72:75], v27 offset:0
  v_mfma_f32_16x16x32_bf16 v[144:147], v[132:135], v[112:115], v[144:147]
  ds_read_b128 v[76:79], v27 offset:2048
  ds_read_b64_tr_b16 v[92:93], v28 offset:6144
  v_mfma_f32_16x16x32_bf16 v[156:159], v[132:135], v[116:119], v[156:159]
  ds_read_b64_tr_b16 v[94:95], v28 offset:6912
  v_mfma_f32_16x16x32_bf16 v[148:151], v[136:139], v[112:115], v[148:151]
  ds_read_b64_tr_b16 v[96:97], v29 offset:6144
  ds_read_b64_tr_b16 v[98:99], v29 offset:6912
  v_mfma_f32_16x16x32_bf16 v[160:163], v[136:139], v[116:119], v[160:163]
  ds_read_b64_tr_b16 v[100:101], v30 offset:6144
  ds_read_b64_tr_b16 v[102:103], v30 offset:6912
  v_mfma_f32_16x16x32_bf16 v[152:155], v[140:143], v[112:115], v[152:155]
  v_mfma_f32_16x16x32_bf16 v[164:167], v[140:143], v[116:119], v[164:167]
  s_waitcnt lgkmcnt(0)
  s_barrier
  v_add_u32 v26, 0x23000, v20
  v_add_u32 v27, 0x23000, v21
  v_add_u32 v28, 0x23000, v22
  v_add_u32 v29, 0x23000, v23
  v_add_u32 v30, 0x23000, v24
  v_mfma_f32_16x16x32_bf16 v[144:147], v[80:83], v[64:67], v[144:147]
  ds_read_b128 v[104:107], v26 offset:0
  v_mfma_f32_16x16x32_bf16 v[156:159], v[80:83], v[68:71], v[156:159]
  ds_read_b128 v[108:111], v26 offset:2048
  ds_read_b64_tr_b16 v[120:121], v28 offset:0
  v_mfma_f32_16x16x32_bf16 v[148:151], v[84:87], v[64:67], v[148:151]
  ds_read_b64_tr_b16 v[122:123], v28 offset:768
  v_mfma_f32_16x16x32_bf16 v[160:163], v[84:87], v[68:71], v[160:163]
  ds_read_b64_tr_b16 v[124:125], v29 offset:0
  ds_read_b64_tr_b16 v[126:127], v29 offset:768
  v_mfma_f32_16x16x32_bf16 v[152:155], v[88:91], v[64:67], v[152:155]
  ds_read_b64_tr_b16 v[128:129], v30 offset:0
  ds_read_b64_tr_b16 v[130:131], v30 offset:768
  v_mfma_f32_16x16x32_bf16 v[164:167], v[88:91], v[68:71], v[164:167]
  ds_read_b128 v[112:115], v27 offset:0
  v_mfma_f32_16x16x32_bf16 v[144:147], v[92:95], v[72:75], v[144:147]
  ds_read_b128 v[116:119], v27 offset:2048
  ds_read_b64_tr_b16 v[132:133], v28 offset:6144
  v_mfma_f32_16x16x32_bf16 v[156:159], v[92:95], v[76:79], v[156:159]
  ds_read_b64_tr_b16 v[134:135], v28 offset:6912
  v_mfma_f32_16x16x32_bf16 v[148:151], v[96:99], v[72:75], v[148:151]
  ds_read_b64_tr_b16 v[136:137], v29 offset:6144
  ds_read_b64_tr_b16 v[138:139], v29 offset:6912
  v_mfma_f32_16x16x32_bf16 v[160:163], v[96:99], v[76:79], v[160:163]
  ds_read_b64_tr_b16 v[140:141], v30 offset:6144
  ds_read_b64_tr_b16 v[142:143], v30 offset:6912
  v_mfma_f32_16x16x32_bf16 v[152:155], v[100:103], v[72:75], v[152:155]
  v_mfma_f32_16x16x32_bf16 v[164:167], v[100:103], v[76:79], v[164:167]
  s_waitcnt lgkmcnt(0)
  s_barrier
  v_mfma_f32_16x16x32_bf16 v[144:147], v[120:123], v[104:107], v[144:147]
  ds_read_b128 v[64:67], v20 offset:0
  v_mfma_f32_16x16x32_bf16 v[156:159], v[120:123], v[108:111], v[156:159]
  ds_read_b128 v[68:71], v20 offset:2048
  ds_read_b64_tr_b16 v[80:81], v22 offset:0
  v_mfma_f32_16x16x32_bf16 v[148:151], v[124:127], v[104:107], v[148:151]
  ds_read_b64_tr_b16 v[82:83], v22 offset:768
  v_mfma_f32_16x16x32_bf16 v[160:163], v[124:127], v[108:111], v[160:163]
  ds_read_b64_tr_b16 v[84:85], v23 offset:0
  ds_read_b64_tr_b16 v[86:87], v23 offset:768
  v_mfma_f32_16x16x32_bf16 v[152:155], v[128:131], v[104:107], v[152:155]
  ds_read_b64_tr_b16 v[88:89], v24 offset:0
  ds_read_b64_tr_b16 v[90:91], v24 offset:768
  v_mfma_f32_16x16x32_bf16 v[164:167], v[128:131], v[108:111], v[164:167]
  ds_read_b128 v[72:75], v21 offset:0
  v_mfma_f32_16x16x32_bf16 v[144:147], v[132:135], v[112:115], v[144:147]
  ds_read_b128 v[76:79], v21 offset:2048
  ds_read_b64_tr_b16 v[92:93], v22 offset:6144
  v_mfma_f32_16x16x32_bf16 v[156:159], v[132:135], v[116:119], v[156:159]
  ds_read_b64_tr_b16 v[94:95], v22 offset:6912
  v_mfma_f32_16x16x32_bf16 v[148:151], v[136:139], v[112:115], v[148:151]
  ds_read_b64_tr_b16 v[96:97], v23 offset:6144
  ds_read_b64_tr_b16 v[98:99], v23 offset:6912
  v_mfma_f32_16x16x32_bf16 v[160:163], v[136:139], v[116:119], v[160:163]
  ds_read_b64_tr_b16 v[100:101], v24 offset:6144
  ds_read_b64_tr_b16 v[102:103], v24 offset:6912
  v_mfma_f32_16x16x32_bf16 v[152:155], v[140:143], v[112:115], v[152:155]
  v_mfma_f32_16x16x32_bf16 v[164:167], v[140:143], v[116:119], v[164:167]
  s_waitcnt lgkmcnt(0)
  s_barrier
  v_add_u32 v26, 0x5000, v20
  v_add_u32 v27, 0x5000, v21
  v_add_u32 v28, 0x5000, v22
  v_add_u32 v29, 0x5000, v23
  v_add_u32 v30, 0x5000, v24
  v_mfma_f32_16x16x32_bf16 v[144:147], v[80:83], v[64:67], v[144:147]
  ds_read_b128 v[104:107], v26 offset:0
  v_mfma_f32_16x16x32_bf16 v[156:159], v[80:83], v[68:71], v[156:159]
  ds_read_b128 v[108:111], v26 offset:2048
  ds_read_b64_tr_b16 v[120:121], v28 offset:0
  v_mfma_f32_16x16x32_bf16 v[148:151], v[84:87], v[64:67], v[148:151]
  ds_read_b64_tr_b16 v[122:123], v28 offset:768
  v_mfma_f32_16x16x32_bf16 v[160:163], v[84:87], v[68:71], v[160:163]
  ds_read_b64_tr_b16 v[124:125], v29 offset:0
  ds_read_b64_tr_b16 v[126:127], v29 offset:768
  v_mfma_f32_16x16x32_bf16 v[152:155], v[88:91], v[64:67], v[152:155]
  ds_read_b64_tr_b16 v[128:129], v30 offset:0
  ds_read_b64_tr_b16 v[130:131], v30 offset:768
  v_mfma_f32_16x16x32_bf16 v[164:167], v[88:91], v[68:71], v[164:167]
  ds_read_b128 v[112:115], v27 offset:0
  v_mfma_f32_16x16x32_bf16 v[144:147], v[92:95], v[72:75], v[144:147]
  ds_read_b128 v[116:119], v27 offset:2048
  ds_read_b64_tr_b16 v[132:133], v28 offset:6144
  v_mfma_f32_16x16x32_bf16 v[156:159], v[92:95], v[76:79], v[156:159]
  ds_read_b64_tr_b16 v[134:135], v28 offset:6912
  v_mfma_f32_16x16x32_bf16 v[148:151], v[96:99], v[72:75], v[148:151]
  ds_read_b64_tr_b16 v[136:137], v29 offset:6144
  ds_read_b64_tr_b16 v[138:139], v29 offset:6912
  v_mfma_f32_16x16x32_bf16 v[160:163], v[96:99], v[76:79], v[160:163]
  ds_read_b64_tr_b16 v[140:141], v30 offset:6144
  ds_read_b64_tr_b16 v[142:143], v30 offset:6912
  v_mfma_f32_16x16x32_bf16 v[152:155], v[100:103], v[72:75], v[152:155]
  v_mfma_f32_16x16x32_bf16 v[164:167], v[100:103], v[76:79], v[164:167]
  s_waitcnt lgkmcnt(0)
  s_barrier
  v_add_u32 v26, 0xa000, v20
  v_add_u32 v27, 0xa000, v21
  v_add_u32 v28, 0xa000, v22
  v_add_u32 v29, 0xa000, v23
  v_add_u32 v30, 0xa000, v24
  v_mfma_f32_16x16x32_bf16 v[144:147], v[120:123], v[104:107], v[144:147]
  ds_read_b128 v[64:67], v26 offset:0
  v_mfma_f32_16x16x32_bf16 v[156:159], v[120:123], v[108:111], v[156:159]
  ds_read_b128 v[68:71], v26 offset:2048
  ds_read_b64_tr_b16 v[80:81], v28 offset:0
  v_mfma_f32_16x16x32_bf16 v[148:151], v[124:127], v[104:107], v[148:151]
  ds_read_b64_tr_b16 v[82:83], v28 offset:768
  v_mfma_f32_16x16x32_bf16 v[160:163], v[124:127], v[108:111], v[160:163]
  ds_read_b64_tr_b16 v[84:85], v29 offset:0
  ds_read_b64_tr_b16 v[86:87], v29 offset:768
  v_mfma_f32_16x16x32_bf16 v[152:155], v[128:131], v[104:107], v[152:155]
  ds_read_b64_tr_b16 v[88:89], v30 offset:0
  ds_read_b64_tr_b16 v[90:91], v30 offset:768
  v_mfma_f32_16x16x32_bf16 v[164:167], v[128:131], v[108:111], v[164:167]
  ds_read_b128 v[72:75], v27 offset:0
  v_mfma_f32_16x16x32_bf16 v[144:147], v[132:135], v[112:115], v[144:147]
  ds_read_b128 v[76:79], v27 offset:2048
  ds_read_b64_tr_b16 v[92:93], v28 offset:6144
  v_mfma_f32_16x16x32_bf16 v[156:159], v[132:135], v[116:119], v[156:159]
  ds_read_b64_tr_b16 v[94:95], v28 offset:6912
  v_mfma_f32_16x16x32_bf16 v[148:151], v[136:139], v[112:115], v[148:151]
  ds_read_b64_tr_b16 v[96:97], v29 offset:6144
  ds_read_b64_tr_b16 v[98:99], v29 offset:6912
  v_mfma_f32_16x16x32_bf16 v[160:163], v[136:139], v[116:119], v[160:163]
  ds_read_b64_tr_b16 v[100:101], v30 offset:6144
  ds_read_b64_tr_b16 v[102:103], v30 offset:6912
  v_mfma_f32_16x16x32_bf16 v[152:155], v[140:143], v[112:115], v[152:155]
  v_mfma_f32_16x16x32_bf16 v[164:167], v[140:143], v[116:119], v[164:167]
  s_waitcnt lgkmcnt(0)
  s_barrier
  v_add_u32 v26, 0xf000, v20
  v_add_u32 v27, 0xf000, v21
  v_add_u32 v28, 0xf000, v22
  v_add_u32 v29, 0xf000, v23
  v_add_u32 v30, 0xf000, v24
  v_mfma_f32_16x16x32_bf16 v[144:147], v[80:83], v[64:67], v[144:147]
  ds_read_b128 v[104:107], v26 offset:0
  v_mfma_f32_16x16x32_bf16 v[156:159], v[80:83], v[68:71], v[156:159]
  ds_read_b128 v[108:111], v26 offset:2048
  ds_read_b64_tr_b16 v[120:121], v28 offset:0
  v_mfma_f32_16x16x32_bf16 v[148:151], v[84:87], v[64:67], v[148:151]
  ds_read_b64_tr_b16 v[122:123], v28 offset:768
  v_mfma_f32_16x16x32_bf16 v[160:163], v[84:87], v[68:71], v[160:163]
  ds_read_b64_tr_b16 v[124:125], v29 offset:0
  ds_read_b64_tr_b16 v[126:127], v29 offset:768
  v_mfma_f32_16x16x32_bf16 v[152:155], v[88:91], v[64:67], v[152:155]
  ds_read_b64_tr_b16 v[128:129], v30 offset:0
  ds_read_b64_tr_b16 v[130:131], v30 offset:768
  v_mfma_f32_16x16x32_bf16 v[164:167], v[88:91], v[68:71], v[164:167]
  ds_read_b128 v[112:115], v27 offset:0
  v_mfma_f32_16x16x32_bf16 v[144:147], v[92:95], v[72:75], v[144:147]
  ds_read_b128 v[116:119], v27 offset:2048
  ds_read_b64_tr_b16 v[132:133], v28 offset:6144
  v_mfma_f32_16x16x32_bf16 v[156:159], v[92:95], v[76:79], v[156:159]
  ds_read_b64_tr_b16 v[134:135], v28 offset:6912
  v_mfma_f32_16x16x32_bf16 v[148:151], v[96:99], v[72:75], v[148:151]
  ds_read_b64_tr_b16 v[136:137], v29 offset:6144
  ds_read_b64_tr_b16 v[138:139], v29 offset:6912
  v_mfma_f32_16x16x32_bf16 v[160:163], v[96:99], v[76:79], v[160:163]
  ds_read_b64_tr_b16 v[140:141], v30 offset:6144
  ds_read_b64_tr_b16 v[142:143], v30 offset:6912
  v_mfma_f32_16x16x32_bf16 v[152:155], v[100:103], v[72:75], v[152:155]
  v_mfma_f32_16x16x32_bf16 v[164:167], v[100:103], v[76:79], v[164:167]
  s_waitcnt lgkmcnt(0)
  s_barrier
  v_add_u32 v26, 0x14000, v20
  v_add_u32 v27, 0x14000, v21
  v_add_u32 v28, 0x14000, v22
  v_add_u32 v29, 0x14000, v23
  v_add_u32 v30, 0x14000, v24
  v_mfma_f32_16x16x32_bf16 v[144:147], v[120:123], v[104:107], v[144:147]
  ds_read_b128 v[64:67], v26 offset:0
  v_mfma_f32_16x16x32_bf16 v[156:159], v[120:123], v[108:111], v[156:159]
  ds_read_b128 v[68:71], v26 offset:2048
  ds_read_b64_tr_b16 v[80:81], v28 offset:0
  v_mfma_f32_16x16x32_bf16 v[148:151], v[124:127], v[104:107], v[148:151]
  ds_read_b64_tr_b16 v[82:83], v28 offset:768
  v_mfma_f32_16x16x32_bf16 v[160:163], v[124:127], v[108:111], v[160:163]
  ds_read_b64_tr_b16 v[84:85], v29 offset:0
  ds_read_b64_tr_b16 v[86:87], v29 offset:768
  v_mfma_f32_16x16x32_bf16 v[152:155], v[128:131], v[104:107], v[152:155]
  ds_read_b64_tr_b16 v[88:89], v30 offset:0
  ds_read_b64_tr_b16 v[90:91], v30 offset:768
  v_mfma_f32_16x16x32_bf16 v[164:167], v[128:131], v[108:111], v[164:167]
  ds_read_b128 v[72:75], v27 offset:0
  v_mfma_f32_16x16x32_bf16 v[144:147], v[132:135], v[112:115], v[144:147]
  ds_read_b128 v[76:79], v27 offset:2048
  ds_read_b64_tr_b16 v[92:93], v28 offset:6144
  v_mfma_f32_16x16x32_bf16 v[156:159], v[132:135], v[116:119], v[156:159]
  ds_read_b64_tr_b16 v[94:95], v28 offset:6912
  v_mfma_f32_16x16x32_bf16 v[148:151], v[136:139], v[112:115], v[148:151]
  ds_read_b64_tr_b16 v[96:97], v29 offset:6144
  ds_read_b64_tr_b16 v[98:99], v29 offset:6912
  v_mfma_f32_16x16x32_bf16 v[160:163], v[136:139], v[116:119], v[160:163]
  ds_read_b64_tr_b16 v[100:101], v30 offset:6144
  ds_read_b64_tr_b16 v[102:103], v30 offset:6912
  v_mfma_f32_16x16x32_bf16 v[152:155], v[140:143], v[112:115], v[152:155]
  v_mfma_f32_16x16x32_bf16 v[164:167], v[140:143], v[116:119], v[164:167]
  buffer_load_dwordx2 v[32:33], v17, s[16:19], 0 offen offset:0
  buffer_load_dwordx2 v[34:35], v17, s[16:19], 0 offen offset:32
  buffer_load_dwordx2 v[36:37], v17, s[16:19], 0 offen offset:64
  buffer_load_dwordx2 v[38:39], v17, s[16:19], s35 offen offset:0
  buffer_load_dwordx2 v[40:41], v17, s[16:19], s35 offen offset:32
  buffer_load_dwordx2 v[42:43], v17, s[16:19], s35 offen offset:64
  buffer_load_ushort v48, v18, s[20:23], 0 offen
  buffer_load_ushort v49, v18, s[20:23], 0 offen offset:32
  s_waitcnt lgkmcnt(0)
  s_barrier
  v_add_u32 v26, 0x19000, v20
  v_add_u32 v27, 0x19000, v21
  v_add_u32 v28, 0x19000, v22
  v_add_u32 v29, 0x19000, v23
  v_add_u32 v30, 0x19000, v24
  v_mfma_f32_16x16x32_bf16 v[144:147], v[80:83], v[64:67], v[144:147]
  ds_read_b128 v[104:107], v26 offset:0
  v_mfma_f32_16x16x32_bf16 v[156:159], v[80:83], v[68:71], v[156:159]
  ds_read_b128 v[108:111], v26 offset:2048
  ds_read_b64_tr_b16 v[120:121], v28 offset:0
  v_mfma_f32_16x16x32_bf16 v[148:151], v[84:87], v[64:67], v[148:151]
  ds_read_b64_tr_b16 v[122:123], v28 offset:768
  v_mfma_f32_16x16x32_bf16 v[160:163], v[84:87], v[68:71], v[160:163]
  ds_read_b64_tr_b16 v[124:125], v29 offset:0
  ds_read_b64_tr_b16 v[126:127], v29 offset:768
  v_mfma_f32_16x16x32_bf16 v[152:155], v[88:91], v[64:67], v[152:155]
  ds_read_b64_tr_b16 v[128:129], v30 offset:0
  ds_read_b64_tr_b16 v[130:131], v30 offset:768
  v_mfma_f32_16x16x32_bf16 v[164:167], v[88:91], v[68:71], v[164:167]
  ds_read_b128 v[112:115], v27 offset:0
  v_mfma_f32_16x16x32_bf16 v[144:147], v[92:95], v[72:75], v[144:147]
  ds_read_b128 v[116:119], v27 offset:2048
  ds_read_b64_tr_b16 v[132:133], v28 offset:6144
  v_mfma_f32_16x16x32_bf16 v[156:159], v[92:95], v[76:79], v[156:159]
  ds_read_b64_tr_b16 v[134:135], v28 offset:6912
  v_mfma_f32_16x16x32_bf16 v[148:151], v[96:99], v[72:75], v[148:151]
  ds_read_b64_tr_b16 v[136:137], v29 offset:6144
  ds_read_b64_tr_b16 v[138:139], v29 offset:6912
  v_mfma_f32_16x16x32_bf16 v[160:163], v[96:99], v[76:79], v[160:163]
  ds_read_b64_tr_b16 v[140:141], v30 offset:6144
  ds_read_b64_tr_b16 v[142:143], v30 offset:6912
  v_mfma_f32_16x16x32_bf16 v[152:155], v[100:103], v[72:75], v[152:155]
  v_mfma_f32_16x16x32_bf16 v[164:167], v[100:103], v[76:79], v[164:167]
  s_waitcnt lgkmcnt(0)
  s_barrier
  v_add_u32 v26, 0x1e000, v20
  v_add_u32 v27, 0x1e000, v21
  v_add_u32 v28, 0x1e000, v22
  v_add_u32 v29, 0x1e000, v23
  v_add_u32 v30, 0x1e000, v24
  v_mfma_f32_16x16x32_bf16 v[144:147], v[120:123], v[104:107], v[144:147]
  ds_read_b128 v[64:67], v26 offset:0
  v_mfma_f32_16x16x32_bf16 v[156:159], v[120:123], v[108:111], v[156:159]
  ds_read_b128 v[68:71], v26 offset:2048
  ds_read_b64_tr_b16 v[80:81], v28 offset:0
  v_mfma_f32_16x16x32_bf16 v[148:151], v[124:127], v[104:107], v[148:151]
  ds_read_b64_tr_b16 v[82:83], v28 offset:768
  v_mfma_f32_16x16x32_bf16 v[160:163], v[124:127], v[108:111], v[160:163]
  ds_read_b64_tr_b16 v[84:85], v29 offset:0
  ds_read_b64_tr_b16 v[86:87], v29 offset:768
  v_mfma_f32_16x16x32_bf16 v[152:155], v[128:131], v[104:107], v[152:155]
  ds_read_b64_tr_b16 v[88:89], v30 offset:0
  ds_read_b64_tr_b16 v[90:91], v30 offset:768
  v_mfma_f32_16x16x32_bf16 v[164:167], v[128:131], v[108:111], v[164:167]
  ds_read_b128 v[72:75], v27 offset:0
  v_mfma_f32_16x16x32_bf16 v[144:147], v[132:135], v[112:115], v[144:147]
  ds_read_b128 v[76:79], v27 offset:2048
  ds_read_b64_tr_b16 v[92:93], v28 offset:6144
  v_mfma_f32_16x16x32_bf16 v[156:159], v[132:135], v[116:119], v[156:159]
  ds_read_b64_tr_b16 v[94:95], v28 offset:6912
  v_mfma_f32_16x16x32_bf16 v[148:151], v[136:139], v[112:115], v[148:151]
  ds_read_b64_tr_b16 v[96:97], v29 offset:6144
  ds_read_b64_tr_b16 v[98:99], v29 offset:6912
  v_mfma_f32_16x16x32_bf16 v[160:163], v[136:139], v[116:119], v[160:163]
  ds_read_b64_tr_b16 v[100:101], v30 offset:6144
  ds_read_b64_tr_b16 v[102:103], v30 offset:6912
  v_mfma_f32_16x16x32_bf16 v[152:155], v[140:143], v[112:115], v[152:155]
  v_mfma_f32_16x16x32_bf16 v[164:167], v[140:143], v[116:119], v[164:167]
  s_waitcnt lgkmcnt(0)
  s_barrier
  v_add_u32 v26, 0x23000, v20
  v_add_u32 v27, 0x23000, v21
  v_add_u32 v28, 0x23000, v22
  v_add_u32 v29, 0x23000, v23
  v_add_u32 v30, 0x23000, v24
  v_mfma_f32_16x16x32_bf16 v[144:147], v[80:83], v[64:67], v[144:147]
  ds_read_b128 v[104:107], v26 offset:0
  v_mfma_f32_16x16x32_bf16 v[156:159], v[80:83], v[68:71], v[156:159]
  ds_read_b128 v[108:111], v26 offset:2048
  ds_read_b64_tr_b16 v[120:121], v28 offset:0
  v_mfma_f32_16x16x32_bf16 v[148:151], v[84:87], v[64:67], v[148:151]
  ds_read_b64_tr_b16 v[122:123], v28 offset:768
  v_mfma_f32_16x16x32_bf16 v[160:163], v[84:87], v[68:71], v[160:163]
  ds_read_b64_tr_b16 v[124:125], v29 offset:0
  ds_read_b64_tr_b16 v[126:127], v29 offset:768
  v_mfma_f32_16x16x32_bf16 v[152:155], v[88:91], v[64:67], v[152:155]
  ds_read_b64_tr_b16 v[128:129], v30 offset:0
  ds_read_b64_tr_b16 v[130:131], v30 offset:768
  v_mfma_f32_16x16x32_bf16 v[164:167], v[88:91], v[68:71], v[164:167]
  ds_read_b128 v[112:115], v27 offset:0
  v_mfma_f32_16x16x32_bf16 v[144:147], v[92:95], v[72:75], v[144:147]
  ds_read_b128 v[116:119], v27 offset:2048
  ds_read_b64_tr_b16 v[132:133], v28 offset:6144
  v_mfma_f32_16x16x32_bf16 v[156:159], v[92:95], v[76:79], v[156:159]
  ds_read_b64_tr_b16 v[134:135], v28 offset:6912
  v_mfma_f32_16x16x32_bf16 v[148:151], v[96:99], v[72:75], v[148:151]
  ds_read_b64_tr_b16 v[136:137], v29 offset:6144
  ds_read_b64_tr_b16 v[138:139], v29 offset:6912
  v_mfma_f32_16x16x32_bf16 v[160:163], v[96:99], v[76:79], v[160:163]
  ds_read_b64_tr_b16 v[140:141], v30 offset:6144
  ds_read_b64_tr_b16 v[142:143], v30 offset:6912
  v_mfma_f32_16x16x32_bf16 v[152:155], v[100:103], v[72:75], v[152:155]
  v_mfma_f32_16x16x32_bf16 v[164:167], v[100:103], v[76:79], v[164:167]
  s_waitcnt lgkmcnt(0)
  v_mfma_f32_16x16x32_bf16 v[144:147], v[120:123], v[104:107], v[144:147]
  v_mfma_f32_16x16x32_bf16 v[156:159], v[120:123], v[108:111], v[156:159]
  v_mfma_f32_16x16x32_bf16 v[148:151], v[124:127], v[104:107], v[148:151]
  v_mfma_f32_16x16x32_bf16 v[160:163], v[124:127], v[108:111], v[160:163]
  v_mfma_f32_16x16x32_bf16 v[152:155], v[128:131], v[104:107], v[152:155]
  v_mfma_f32_16x16x32_bf16 v[164:167], v[128:131], v[108:111], v[164:167]
  v_mfma_f32_16x16x32_bf16 v[144:147], v[132:135], v[112:115], v[144:147]
  v_mfma_f32_16x16x32_bf16 v[156:159], v[132:135], v[116:119], v[156:159]
  v_mfma_f32_16x16x32_bf16 v[148:151], v[136:139], v[112:115], v[148:151]
  v_mfma_f32_16x16x32_bf16 v[160:163], v[136:139], v[116:119], v[160:163]
  v_mfma_f32_16x16x32_bf16 v[152:155], v[140:143], v[112:115], v[152:155]
  v_mfma_f32_16x16x32_bf16 v[164:167], v[140:143], v[116:119], v[164:167]
  s_waitcnt vmcnt(0)
  s_nop 7
  v_lshlrev_b32 v48, 16, v48
  v_cvt_pk_bf16_f32 v8, v144, v145
  v_cvt_pk_bf16_f32 v9, v146, v147
  v_lshlrev_b32 v4, 16, v32
  v_and_b32 v5, 0xffff0000, v32
  v_lshlrev_b32 v6, 16, v33
  v_and_b32 v7, 0xffff0000, v33
  v_lshlrev_b32 v144, 16, v8
  v_and_b32 v145, 0xffff0000, v8
  v_lshlrev_b32 v146, 16, v9
  v_and_b32 v147, 0xffff0000, v9
  v_add_f32 v144, v144, v48
  v_add_f32 v145, v145, v48
  v_add_f32 v146, v146, v48
  v_add_f32 v147, v147, v48
  v_cvt_pk_bf16_f32 v8, v144, v145
  v_cvt_pk_bf16_f32 v9, v146, v147
  v_lshlrev_b32 v144, 16, v8
  v_and_b32 v145, 0xffff0000, v8
  v_lshlrev_b32 v146, 16, v9
  v_and_b32 v147, 0xffff0000, v9
  v_pk_mul_f32 v[144:145], v[144:145], v[4:5]
  v_pk_mul_f32 v[146:147], v[146:147], v[6:7]
  v_cvt_pk_bf16_f32 v32, v144, v145
  v_cvt_pk_bf16_f32 v33, v146, v147
  buffer_store_dwordx2 v[32:33], v16, s[12:15], 0 offen offset:0
  v_cvt_pk_bf16_f32 v8, v148, v149
  v_cvt_pk_bf16_f32 v9, v150, v151
  v_lshlrev_b32 v4, 16, v34
  v_and_b32 v5, 0xffff0000, v34
  v_lshlrev_b32 v6, 16, v35
  v_and_b32 v7, 0xffff0000, v35
  v_lshlrev_b32 v148, 16, v8
  v_and_b32 v149, 0xffff0000, v8
  v_lshlrev_b32 v150, 16, v9
  v_and_b32 v151, 0xffff0000, v9
  v_add_f32 v148, v148, v48
  v_add_f32 v149, v149, v48
  v_add_f32 v150, v150, v48
  v_add_f32 v151, v151, v48
  v_cvt_pk_bf16_f32 v8, v148, v149
  v_cvt_pk_bf16_f32 v9, v150, v151
  v_lshlrev_b32 v148, 16, v8
  v_and_b32 v149, 0xffff0000, v8
  v_lshlrev_b32 v150, 16, v9
  v_and_b32 v151, 0xffff0000, v9
  v_pk_mul_f32 v[148:149], v[148:149], v[4:5]
  v_pk_mul_f32 v[150:151], v[150:151], v[6:7]
  v_cvt_pk_bf16_f32 v34, v148, v149
  v_cvt_pk_bf16_f32 v35, v150, v151
  buffer_store_dwordx2 v[34:35], v16, s[12:15], 0 offen offset:32
  v_cvt_pk_bf16_f32 v8, v152, v153
  v_cvt_pk_bf16_f32 v9, v154, v155
  v_lshlrev_b32 v4, 16, v36
  v_and_b32 v5, 0xffff0000, v36
  v_lshlrev_b32 v6, 16, v37
  v_and_b32 v7, 0xffff0000, v37
  v_lshlrev_b32 v152, 16, v8
  v_and_b32 v153, 0xffff0000, v8
  v_lshlrev_b32 v154, 16, v9
  v_and_b32 v155, 0xffff0000, v9
  v_add_f32 v152, v152, v48
  v_add_f32 v153, v153, v48
  v_add_f32 v154, v154, v48
  v_add_f32 v155, v155, v48
  v_cvt_pk_bf16_f32 v8, v152, v153
  v_cvt_pk_bf16_f32 v9, v154, v155
  v_lshlrev_b32 v152, 16, v8
  v_and_b32 v153, 0xffff0000, v8
  v_lshlrev_b32 v154, 16, v9
  v_and_b32 v155, 0xffff0000, v9
  v_pk_mul_f32 v[152:153], v[152:153], v[4:5]
  v_pk_mul_f32 v[154:155], v[154:155], v[6:7]
  v_cvt_pk_bf16_f32 v36, v152, v153
  v_cvt_pk_bf16_f32 v37, v154, v155
  buffer_store_dwordx2 v[36:37], v16, s[12:15], 0 offen offset:64
  v_lshlrev_b32 v49, 16, v49
  v_cvt_pk_bf16_f32 v8, v156, v157
  v_cvt_pk_bf16_f32 v9, v158, v159
  v_lshlrev_b32 v4, 16, v38
  v_and_b32 v5, 0xffff0000, v38
  v_lshlrev_b32 v6, 16, v39
  v_and_b32 v7, 0xffff0000, v39
  v_lshlrev_b32 v156, 16, v8
  v_and_b32 v157, 0xffff0000, v8
  v_lshlrev_b32 v158, 16, v9
  v_and_b32 v159, 0xffff0000, v9
  v_add_f32 v156, v156, v49
  v_add_f32 v157, v157, v49
  v_add_f32 v158, v158, v49
  v_add_f32 v159, v159, v49
  v_cvt_pk_bf16_f32 v8, v156, v157
  v_cvt_pk_bf16_f32 v9, v158, v159
  v_lshlrev_b32 v156, 16, v8
  v_and_b32 v157, 0xffff0000, v8
  v_lshlrev_b32 v158, 16, v9
  v_and_b32 v159, 0xffff0000, v9
  v_pk_mul_f32 v[156:157], v[156:157], v[4:5]
  v_pk_mul_f32 v[158:159], v[158:159], v[6:7]
  v_cvt_pk_bf16_f32 v38, v156, v157
  v_cvt_pk_bf16_f32 v39, v158, v159
  buffer_store_dwordx2 v[38:39], v16, s[12:15], s36 offen offset:0
  v_cvt_pk_bf16_f32 v8, v160, v161
  v_cvt_pk_bf16_f32 v9, v162, v163
  v_lshlrev_b32 v4, 16, v40
  v_and_b32 v5, 0xffff0000, v40
  v_lshlrev_b32 v6, 16, v41
  v_and_b32 v7, 0xffff0000, v41
  v_lshlrev_b32 v160, 16, v8
  v_and_b32 v161, 0xffff0000, v8
  v_lshlrev_b32 v162, 16, v9
  v_and_b32 v163, 0xffff0000, v9
  v_add_f32 v160, v160, v49
  v_add_f32 v161, v161, v49
  v_add_f32 v162, v162, v49
  v_add_f32 v163, v163, v49
  v_cvt_pk_bf16_f32 v8, v160, v161
  v_cvt_pk_bf16_f32 v9, v162, v163
  v_lshlrev_b32 v160, 16, v8
  v_and_b32 v161, 0xffff0000, v8
  v_lshlrev_b32 v162, 16, v9
  v_and_b32 v163, 0xffff0000, v9
  v_pk_mul_f32 v[160:161], v[160:161], v[4:5]
  v_pk_mul_f32 v[162:163], v[162:163], v[6:7]
  v_cvt_pk_bf16_f32 v40, v160, v161
  v_cvt_pk_bf16_f32 v41, v162, v163
  buffer_store_dwordx2 v[40:41], v16, s[12:15], s36 offen offset:32
  v_cvt_pk_bf16_f32 v8, v164, v165
  v_cvt_pk_bf16_f32 v9, v166, v167
  v_lshlrev_b32 v4, 16, v42
  v_and_b32 v5, 0xffff0000, v42
  v_lshlrev_b32 v6, 16, v43
  v_and_b32 v7, 0xffff0000, v43
  v_lshlrev_b32 v164, 16, v8
  v_and_b32 v165, 0xffff0000, v8
  v_lshlrev_b32 v166, 16, v9
  v_and_b32 v167, 0xffff0000, v9
  v_add_f32 v164, v164, v49
  v_add_f32 v165, v165, v49
  v_add_f32 v166, v166, v49
  v_add_f32 v167, v167, v49
  v_cvt_pk_bf16_f32 v8, v164, v165
  v_cvt_pk_bf16_f32 v9, v166, v167
  v_lshlrev_b32 v164, 16, v8
  v_and_b32 v165, 0xffff0000, v8
  v_lshlrev_b32 v166, 16, v9
  v_and_b32 v167, 0xffff0000, v9
  v_pk_mul_f32 v[164:165], v[164:165], v[4:5]
  v_pk_mul_f32 v[166:167], v[166:167], v[6:7]
  v_cvt_pk_bf16_f32 v42, v164, v165
  v_cvt_pk_bf16_f32 v43, v166, v167
  buffer_store_dwordx2 v[42:43], v16, s[12:15], s36 offen offset:64
  s_cmp_eq_u32 s25, 7
  s_cbranch_scc0 .L_k4_kernel_2
  s_cmp_eq_u32 s28, 1
  s_cbranch_scc0 .L_k4_kernel_2
  v_mov_b32 v4, 0
  v_mov_b32 v5, 0
  buffer_store_dwordx2 v[4:5], v16, s[12:15], 0 offen offset:96
  buffer_store_dwordx2 v[4:5], v16, s[12:15], s36 offen offset:96
.L_k4_kernel_2:
  s_branch .Lend_k4_kernel
.Lloader_k4_kernel_1:
  s_sub_u32 s26, s26, 4
  v_lshrrev_b32 v4, 3, v1
  v_and_b32 v5, 7, v1
  s_lshl_b32 s31, s26, 4
  s_mov_b32 s32, 4096
  s_lshl_b32 s34, s24, 6
  v_add_u32 v6, s31, v4
  v_bfe_u32 v7, v6, 1, 3
  v_xor_b32 v7, v7, v5
  v_add_u32 v6, s34, v6
  v_mul_lo_u32 v6, v6, s32
  v_lshl_add_u32 v8, v7, 4, v6
  v_add_u32 v6, s31, v4
  v_add_u32 v6, 8, v6
  v_bfe_u32 v7, v6, 1, 3
  v_xor_b32 v7, v7, v5
  v_add_u32 v6, s34, v6
  v_mul_lo_u32 v6, v6, s32
  v_lshl_add_u32 v9, v7, 4, v6
  s_mov_b32 s32, 192
  s_mul_i32 s31, s26, 3072
  s_mul_i32 s34, s25, 393216
  s_add_u32 s31, s31, s34
  v_lshlrev_b32 v6, 4, v1
  v_add_u32 v10, s31, v6
  v_add_u32 v11, s31, v6
  v_add_u32 v11, 1024, v11
  v_add_u32 v12, s31, v6
  v_add_u32 v12, 2048, v12
  s_lshl_b32 s29, s26, 11
  s_mul_i32 s30, s26, 3072
  s_add_u32 s30, s30, 8192
  s_waitcnt lgkmcnt(0)
  s_mov_b32 s6, 0x800000
  s_mov_b32 s7, 0x00020000
  s_add_u32 s8, s8, 0xc00000
  s_addc_u32 s9, s9, 0
  s_mov_b32 s10, 0x300000
  s_mov_b32 s11, 0x00020000
  s_mov_b32 s31, 0
  s_mov_b32 s32, 0
  s_add_u32 m0, s29, 0
  s_nop 0
  buffer_load_dwordx4 v8, s[4:7], s31 offen lds
  s_add_u32 m0, s29, 1024
  s_nop 0
  buffer_load_dwordx4 v9, s[4:7], s31 offen lds
  s_add_u32 m0, s30, 0
  s_nop 0
  buffer_load_dwordx4 v10, s[8:11], s32 offen lds
  s_add_u32 m0, s30, 1024
  s_nop 0
  buffer_load_dwordx4 v11, s[8:11], s32 offen lds
  s_add_u32 m0, s30, 2048
  s_nop 0
  buffer_load_dwordx4 v12, s[8:11], s32 offen lds
  s_mov_b32 s31, 128
  s_mov_b32 s32, 12288
  s_add_u32 m0, s29, 20480
  s_nop 0
  buffer_load_dwordx4 v8, s[4:7], s31 offen lds
  s_add_u32 m0, s29, 21504
  s_nop 0
  buffer_load_dwordx4 v9, s[4:7], s31 offen lds
  s_add_u32 m0, s30, 20480
  s_nop 0
  buffer_load_dwordx4 v10, s[8:11], s32 offen lds
  s_add_u32 m0, s30, 21504
  s_nop 0
  buffer_load_dwordx4 v11, s[8:11], s32 offen lds
  s_add_u32 m0, s30, 22528
  s_nop 0
  buffer_load_dwordx4 v12, s[8:11], s32 offen lds
  s_mov_b32 s31, 256
  s_mov_b32 s32, 24576
  s_add_u32 m0, s29, 40960
  s_nop 0
  buffer_load_dwordx4 v8, s[4:7], s31 offen lds
  s_add_u32 m0, s29, 41984
  s_nop 0
  buffer_load_dwordx4 v9, s[4:7], s31 offen lds
  s_add_u32 m0, s30, 40960
  s_nop 0
  buffer_load_dwordx4 v10, s[8:11], s32 offen lds
  s_add_u32 m0, s30, 41984
  s_nop 0
  buffer_load_dwordx4 v11, s[8:11], s32 offen lds
  s_add_u32 m0, s30, 43008
  s_nop 0
  buffer_load_dwordx4 v12, s[8:11], s32 offen lds
  s_mov_b32 s31, 384
  s_mov_b32 s32, 36864
  s_add_u32 m0, s29, 61440
  s_nop 0
  buffer_load_dwordx4 v8, s[4:7], s31 offen lds
  s_add_u32 m0, s29, 62464
  s_nop 0
  buffer_load_dwordx4 v9, s[4:7], s31 offen lds
  s_add_u32 m0, s30, 61440
  s_nop 0
  buffer_load_dwordx4 v10, s[8:11], s32 offen lds
  s_add_u32 m0, s30, 62464
  s_nop 0
  buffer_load_dwordx4 v11, s[8:11], s32 offen lds
  s_add_u32 m0, s30, 63488
  s_nop 0
  buffer_load_dwordx4 v12, s[8:11], s32 offen lds
  s_waitcnt vmcnt(15)
  s_barrier
  s_mov_b32 s31, 512
  s_mov_b32 s32, 49152
  s_add_u32 m0, s29, 81920
  s_nop 0
  buffer_load_dwordx4 v8, s[4:7], s31 offen lds
  s_add_u32 m0, s29, 82944
  s_nop 0
  buffer_load_dwordx4 v9, s[4:7], s31 offen lds
  s_add_u32 m0, s30, 81920
  s_nop 0
  buffer_load_dwordx4 v10, s[8:11], s32 offen lds
  s_add_u32 m0, s30, 82944
  s_nop 0
  buffer_load_dwordx4 v11, s[8:11], s32 offen lds
  s_add_u32 m0, s30, 83968
  s_nop 0
  buffer_load_dwordx4 v12, s[8:11], s32 offen lds
  s_mov_b32 s31, 640
  s_mov_b32 s32, 61440
  s_add_u32 m0, s29, 102400
  s_nop 0
  buffer_load_dwordx4 v8, s[4:7], s31 offen lds
  s_add_u32 m0, s29, 103424
  s_nop 0
  buffer_load_dwordx4 v9, s[4:7], s31 offen lds
  s_add_u32 m0, s30, 102400
  s_nop 0
  buffer_load_dwordx4 v10, s[8:11], s32 offen lds
  s_add_u32 m0, s30, 103424
  s_nop 0
  buffer_load_dwordx4 v11, s[8:11], s32 offen lds
  s_add_u32 m0, s30, 104448
  s_nop 0
  buffer_load_dwordx4 v12, s[8:11], s32 offen lds
  s_waitcnt vmcnt(20)
  s_barrier
  s_mov_b32 s31, 768
  s_mov_b32 s32, 73728
  s_add_u32 m0, s29, 122880
  s_nop 0
  buffer_load_dwordx4 v8, s[4:7], s31 offen lds
  s_add_u32 m0, s29, 123904
  s_nop 0
  buffer_load_dwordx4 v9, s[4:7], s31 offen lds
  s_add_u32 m0, s30, 122880
  s_nop 0
  buffer_load_dwordx4 v10, s[8:11], s32 offen lds
  s_add_u32 m0, s30, 123904
  s_nop 0
  buffer_load_dwordx4 v11, s[8:11], s32 offen lds
  s_add_u32 m0, s30, 124928
  s_nop 0
  buffer_load_dwordx4 v12, s[8:11], s32 offen lds
  s_mov_b32 s31, 896
  s_mov_b32 s32, 86016
  s_add_u32 m0, s29, 143360
  s_nop 0
  buffer_load_dwordx4 v8, s[4:7], s31 offen lds
  s_add_u32 m0, s29, 144384
  s_nop 0
  buffer_load_dwordx4 v9, s[4:7], s31 offen lds
  s_add_u32 m0, s30, 143360
  s_nop 0
  buffer_load_dwordx4 v10, s[8:11], s32 offen lds
  s_add_u32 m0, s30, 144384
  s_nop 0
  buffer_load_dwordx4 v11, s[8:11], s32 offen lds
  s_add_u32 m0, s30, 145408
  s_nop 0
  buffer_load_dwordx4 v12, s[8:11], s32 offen lds
  s_waitcnt vmcnt(25)
  s_barrier
  s_mov_b32 s31, 1024
  s_mov_b32 s32, 98304
  s_add_u32 m0, s29, 0
  s_nop 0
  buffer_load_dwordx4 v8, s[4:7], s31 offen lds
  s_add_u32 m0, s29, 1024
  s_nop 0
  buffer_load_dwordx4 v9, s[4:7], s31 offen lds
  s_add_u32 m0, s30, 0
  s_nop 0
  buffer_load_dwordx4 v10, s[8:11], s32 offen lds
  s_add_u32 m0, s30, 1024
  s_nop 0
  buffer_load_dwordx4 v11, s[8:11], s32 offen lds
  s_add_u32 m0, s30, 2048
  s_nop 0
  buffer_load_dwordx4 v12, s[8:11], s32 offen lds
  s_mov_b32 s31, 1152
  s_mov_b32 s32, 110592
  s_add_u32 m0, s29, 20480
  s_nop 0
  buffer_load_dwordx4 v8, s[4:7], s31 offen lds
  s_add_u32 m0, s29, 21504
  s_nop 0
  buffer_load_dwordx4 v9, s[4:7], s31 offen lds
  s_add_u32 m0, s30, 20480
  s_nop 0
  buffer_load_dwordx4 v10, s[8:11], s32 offen lds
  s_add_u32 m0, s30, 21504
  s_nop 0
  buffer_load_dwordx4 v11, s[8:11], s32 offen lds
  s_add_u32 m0, s30, 22528
  s_nop 0
  buffer_load_dwordx4 v12, s[8:11], s32 offen lds
  s_waitcnt vmcnt(30)
  s_barrier
  s_mov_b32 s31, 1280
  s_mov_b32 s32, 122880
  s_add_u32 m0, s29, 40960
  s_nop 0
  buffer_load_dwordx4 v8, s[4:7], s31 offen lds
  s_add_u32 m0, s29, 41984
  s_nop 0
  buffer_load_dwordx4 v9, s[4:7], s31 offen lds
  s_add_u32 m0, s30, 40960
  s_nop 0
  buffer_load_dwordx4 v10, s[8:11], s32 offen lds
  s_add_u32 m0, s30, 41984
  s_nop 0
  buffer_load_dwordx4 v11, s[8:11], s32 offen lds
  s_add_u32 m0, s30, 43008
  s_nop 0
  buffer_load_dwordx4 v12, s[8:11], s32 offen lds
  s_waitcnt vmcnt(30)
  s_barrier
  s_mov_b32 s31, 1408
  s_mov_b32 s32, 135168
  s_add_u32 m0, s29, 61440
  s_nop 0
  buffer_load_dwordx4 v8, s[4:7], s31 offen lds
  s_add_u32 m0, s29, 62464
  s_nop 0
  buffer_load_dwordx4 v9, s[4:7], s31 offen lds
  s_add_u32 m0, s30, 61440
  s_nop 0
  buffer_load_dwordx4 v10, s[8:11], s32 offen lds
  s_add_u32 m0, s30, 62464
  s_nop 0
  buffer_load_dwordx4 v11, s[8:11], s32 offen lds
  s_add_u32 m0, s30, 63488
  s_nop 0
  buffer_load_dwordx4 v12, s[8:11], s32 offen lds
  s_waitcnt vmcnt(30)
  s_barrier
  s_mov_b32 s31, 1536
  s_mov_b32 s32, 147456
  s_add_u32 m0, s29, 81920
  s_nop 0
  buffer_load_dwordx4 v8, s[4:7], s31 offen lds
  s_add_u32 m0, s29, 82944
  s_nop 0
  buffer_load_dwordx4 v9, s[4:7], s31 offen lds
  s_add_u32 m0, s30, 81920
  s_nop 0
  buffer_load_dwordx4 v10, s[8:11], s32 offen lds
  s_add_u32 m0, s30, 82944
  s_nop 0
  buffer_load_dwordx4 v11, s[8:11], s32 offen lds
  s_add_u32 m0, s30, 83968
  s_nop 0
  buffer_load_dwordx4 v12, s[8:11], s32 offen lds
  s_waitcnt vmcnt(30)
  s_barrier
  s_mov_b32 s31, 1664
  s_mov_b32 s32, 159744
  s_add_u32 m0, s29, 102400
  s_nop 0
  buffer_load_dwordx4 v8, s[4:7], s31 offen lds
  s_add_u32 m0, s29, 103424
  s_nop 0
  buffer_load_dwordx4 v9, s[4:7], s31 offen lds
  s_add_u32 m0, s30, 102400
  s_nop 0
  buffer_load_dwordx4 v10, s[8:11], s32 offen lds
  s_add_u32 m0, s30, 103424
  s_nop 0
  buffer_load_dwordx4 v11, s[8:11], s32 offen lds
  s_add_u32 m0, s30, 104448
  s_nop 0
  buffer_load_dwordx4 v12, s[8:11], s32 offen lds
  s_waitcnt vmcnt(30)
  s_barrier
  s_mov_b32 s31, 1792
  s_mov_b32 s32, 172032
  s_add_u32 m0, s29, 122880
  s_nop 0
  buffer_load_dwordx4 v8, s[4:7], s31 offen lds
  s_add_u32 m0, s29, 123904
  s_nop 0
  buffer_load_dwordx4 v9, s[4:7], s31 offen lds
  s_add_u32 m0, s30, 122880
  s_nop 0
  buffer_load_dwordx4 v10, s[8:11], s32 offen lds
  s_add_u32 m0, s30, 123904
  s_nop 0
  buffer_load_dwordx4 v11, s[8:11], s32 offen lds
  s_add_u32 m0, s30, 124928
  s_nop 0
  buffer_load_dwordx4 v12, s[8:11], s32 offen lds
  s_waitcnt vmcnt(30)
  s_barrier
  s_mov_b32 s31, 1920
  s_mov_b32 s32, 184320
  s_add_u32 m0, s29, 143360
  s_nop 0
  buffer_load_dwordx4 v8, s[4:7], s31 offen lds
  s_add_u32 m0, s29, 144384
  s_nop 0
  buffer_load_dwordx4 v9, s[4:7], s31 offen lds
  s_add_u32 m0, s30, 143360
  s_nop 0
  buffer_load_dwordx4 v10, s[8:11], s32 offen lds
  s_add_u32 m0, s30, 144384
  s_nop 0
  buffer_load_dwordx4 v11, s[8:11], s32 offen lds
  s_add_u32 m0, s30, 145408
  s_nop 0
  buffer_load_dwordx4 v12, s[8:11], s32 offen lds
  s_waitcnt vmcnt(30)
  s_barrier
  s_mov_b32 s31, 2048
  s_mov_b32 s32, 196608
  s_add_u32 m0, s29, 0
  s_nop 0
  buffer_load_dwordx4 v8, s[4:7], s31 offen lds
  s_add_u32 m0, s29, 1024
  s_nop 0
  buffer_load_dwordx4 v9, s[4:7], s31 offen lds
  s_add_u32 m0, s30, 0
  s_nop 0
  buffer_load_dwordx4 v10, s[8:11], s32 offen lds
  s_add_u32 m0, s30, 1024
  s_nop 0
  buffer_load_dwordx4 v11, s[8:11], s32 offen lds
  s_add_u32 m0, s30, 2048
  s_nop 0
  buffer_load_dwordx4 v12, s[8:11], s32 offen lds
  s_waitcnt vmcnt(30)
  s_barrier
  s_mov_b32 s31, 2176
  s_mov_b32 s32, 208896
  s_add_u32 m0, s29, 20480
  s_nop 0
  buffer_load_dwordx4 v8, s[4:7], s31 offen lds
  s_add_u32 m0, s29, 21504
  s_nop 0
  buffer_load_dwordx4 v9, s[4:7], s31 offen lds
  s_add_u32 m0, s30, 20480
  s_nop 0
  buffer_load_dwordx4 v10, s[8:11], s32 offen lds
  s_add_u32 m0, s30, 21504
  s_nop 0
  buffer_load_dwordx4 v11, s[8:11], s32 offen lds
  s_add_u32 m0, s30, 22528
  s_nop 0
  buffer_load_dwordx4 v12, s[8:11], s32 offen lds
  s_waitcnt vmcnt(30)
  s_barrier
  s_mov_b32 s31, 2304
  s_mov_b32 s32, 221184
  s_add_u32 m0, s29, 40960
  s_nop 0
  buffer_load_dwordx4 v8, s[4:7], s31 offen lds
  s_add_u32 m0, s29, 41984
  s_nop 0
  buffer_load_dwordx4 v9, s[4:7], s31 offen lds
  s_add_u32 m0, s30, 40960
  s_nop 0
  buffer_load_dwordx4 v10, s[8:11], s32 offen lds
  s_add_u32 m0, s30, 41984
  s_nop 0
  buffer_load_dwordx4 v11, s[8:11], s32 offen lds
  s_add_u32 m0, s30, 43008
  s_nop 0
  buffer_load_dwordx4 v12, s[8:11], s32 offen lds
  s_waitcnt vmcnt(30)
  s_barrier
  s_mov_b32 s31, 2432
  s_mov_b32 s32, 233472
  s_add_u32 m0, s29, 61440
  s_nop 0
  buffer_load_dwordx4 v8, s[4:7], s31 offen lds
  s_add_u32 m0, s29, 62464
  s_nop 0
  buffer_load_dwordx4 v9, s[4:7], s31 offen lds
  s_add_u32 m0, s30, 61440
  s_nop 0
  buffer_load_dwordx4 v10, s[8:11], s32 offen lds
  s_add_u32 m0, s30, 62464
  s_nop 0
  buffer_load_dwordx4 v11, s[8:11], s32 offen lds
  s_add_u32 m0, s30, 63488
  s_nop 0
  buffer_load_dwordx4 v12, s[8:11], s32 offen lds
  s_waitcnt vmcnt(30)
  s_barrier
  s_mov_b32 s31, 2560
  s_mov_b32 s32, 245760
  s_add_u32 m0, s29, 81920
  s_nop 0
  buffer_load_dwordx4 v8, s[4:7], s31 offen lds
  s_add_u32 m0, s29, 82944
  s_nop 0
  buffer_load_dwordx4 v9, s[4:7], s31 offen lds
  s_add_u32 m0, s30, 81920
  s_nop 0
  buffer_load_dwordx4 v10, s[8:11], s32 offen lds
  s_add_u32 m0, s30, 82944
  s_nop 0
  buffer_load_dwordx4 v11, s[8:11], s32 offen lds
  s_add_u32 m0, s30, 83968
  s_nop 0
  buffer_load_dwordx4 v12, s[8:11], s32 offen lds
  s_waitcnt vmcnt(30)
  s_barrier
  s_mov_b32 s31, 2688
  s_mov_b32 s32, 258048
  s_add_u32 m0, s29, 102400
  s_nop 0
  buffer_load_dwordx4 v8, s[4:7], s31 offen lds
  s_add_u32 m0, s29, 103424
  s_nop 0
  buffer_load_dwordx4 v9, s[4:7], s31 offen lds
  s_add_u32 m0, s30, 102400
  s_nop 0
  buffer_load_dwordx4 v10, s[8:11], s32 offen lds
  s_add_u32 m0, s30, 103424
  s_nop 0
  buffer_load_dwordx4 v11, s[8:11], s32 offen lds
  s_add_u32 m0, s30, 104448
  s_nop 0
  buffer_load_dwordx4 v12, s[8:11], s32 offen lds
  s_waitcnt vmcnt(30)
  s_barrier
  s_mov_b32 s31, 2816
  s_mov_b32 s32, 270336
  s_add_u32 m0, s29, 122880
  s_nop 0
  buffer_load_dwordx4 v8, s[4:7], s31 offen lds
  s_add_u32 m0, s29, 123904
  s_nop 0
  buffer_load_dwordx4 v9, s[4:7], s31 offen lds
  s_add_u32 m0, s30, 122880
  s_nop 0
  buffer_load_dwordx4 v10, s[8:11], s32 offen lds
  s_add_u32 m0, s30, 123904
  s_nop 0
  buffer_load_dwordx4 v11, s[8:11], s32 offen lds
  s_add_u32 m0, s30, 124928
  s_nop 0
  buffer_load_dwordx4 v12, s[8:11], s32 offen lds
  s_waitcnt vmcnt(30)
  s_barrier
  s_mov_b32 s31, 2944
  s_mov_b32 s32, 282624
  s_add_u32 m0, s29, 143360
  s_nop 0
  buffer_load_dwordx4 v8, s[4:7], s31 offen lds
  s_add_u32 m0, s29, 144384
  s_nop 0
  buffer_load_dwordx4 v9, s[4:7], s31 offen lds
  s_add_u32 m0, s30, 143360
  s_nop 0
  buffer_load_dwordx4 v10, s[8:11], s32 offen lds
  s_add_u32 m0, s30, 144384
  s_nop 0
  buffer_load_dwordx4 v11, s[8:11], s32 offen lds
  s_add_u32 m0, s30, 145408
  s_nop 0
  buffer_load_dwordx4 v12, s[8:11], s32 offen lds
  s_waitcnt vmcnt(30)
  s_barrier
  s_mov_b32 s31, 3072
  s_mov_b32 s32, 294912
  s_add_u32 m0, s29, 0
  s_nop 0
  buffer_load_dwordx4 v8, s[4:7], s31 offen lds
  s_add_u32 m0, s29, 1024
  s_nop 0
  buffer_load_dwordx4 v9, s[4:7], s31 offen lds
  s_add_u32 m0, s30, 0
  s_nop 0
  buffer_load_dwordx4 v10, s[8:11], s32 offen lds
  s_add_u32 m0, s30, 1024
  s_nop 0
  buffer_load_dwordx4 v11, s[8:11], s32 offen lds
  s_add_u32 m0, s30, 2048
  s_nop 0
  buffer_load_dwordx4 v12, s[8:11], s32 offen lds
  s_waitcnt vmcnt(30)
  s_barrier
  s_mov_b32 s31, 3200
  s_mov_b32 s32, 307200
  s_add_u32 m0, s29, 20480
  s_nop 0
  buffer_load_dwordx4 v8, s[4:7], s31 offen lds
  s_add_u32 m0, s29, 21504
  s_nop 0
  buffer_load_dwordx4 v9, s[4:7], s31 offen lds
  s_add_u32 m0, s30, 20480
  s_nop 0
  buffer_load_dwordx4 v10, s[8:11], s32 offen lds
  s_add_u32 m0, s30, 21504
  s_nop 0
  buffer_load_dwordx4 v11, s[8:11], s32 offen lds
  s_add_u32 m0, s30, 22528
  s_nop 0
  buffer_load_dwordx4 v12, s[8:11], s32 offen lds
  s_waitcnt vmcnt(30)
  s_barrier
  s_mov_b32 s31, 3328
  s_mov_b32 s32, 319488
  s_add_u32 m0, s29, 40960
  s_nop 0
  buffer_load_dwordx4 v8, s[4:7], s31 offen lds
  s_add_u32 m0, s29, 41984
  s_nop 0
  buffer_load_dwordx4 v9, s[4:7], s31 offen lds
  s_add_u32 m0, s30, 40960
  s_nop 0
  buffer_load_dwordx4 v10, s[8:11], s32 offen lds
  s_add_u32 m0, s30, 41984
  s_nop 0
  buffer_load_dwordx4 v11, s[8:11], s32 offen lds
  s_add_u32 m0, s30, 43008
  s_nop 0
  buffer_load_dwordx4 v12, s[8:11], s32 offen lds
  s_waitcnt vmcnt(30)
  s_barrier
  s_mov_b32 s31, 3456
  s_mov_b32 s32, 331776
  s_add_u32 m0, s29, 61440
  s_nop 0
  buffer_load_dwordx4 v8, s[4:7], s31 offen lds
  s_add_u32 m0, s29, 62464
  s_nop 0
  buffer_load_dwordx4 v9, s[4:7], s31 offen lds
  s_add_u32 m0, s30, 61440
  s_nop 0
  buffer_load_dwordx4 v10, s[8:11], s32 offen lds
  s_add_u32 m0, s30, 62464
  s_nop 0
  buffer_load_dwordx4 v11, s[8:11], s32 offen lds
  s_add_u32 m0, s30, 63488
  s_nop 0
  buffer_load_dwordx4 v12, s[8:11], s32 offen lds
  s_waitcnt vmcnt(30)
  s_barrier
  s_mov_b32 s31, 3584
  s_mov_b32 s32, 344064
  s_add_u32 m0, s29, 81920
  s_nop 0
  buffer_load_dwordx4 v8, s[4:7], s31 offen lds
  s_add_u32 m0, s29, 82944
  s_nop 0
  buffer_load_dwordx4 v9, s[4:7], s31 offen lds
  s_add_u32 m0, s30, 81920
  s_nop 0
  buffer_load_dwordx4 v10, s[8:11], s32 offen lds
  s_add_u32 m0, s30, 82944
  s_nop 0
  buffer_load_dwordx4 v11, s[8:11], s32 offen lds
  s_add_u32 m0, s30, 83968
  s_nop 0
  buffer_load_dwordx4 v12, s[8:11], s32 offen lds
  s_waitcnt vmcnt(30)
  s_barrier
  s_mov_b32 s31, 3712
  s_mov_b32 s32, 356352
  s_add_u32 m0, s29, 102400
  s_nop 0
  buffer_load_dwordx4 v8, s[4:7], s31 offen lds
  s_add_u32 m0, s29, 103424
  s_nop 0
  buffer_load_dwordx4 v9, s[4:7], s31 offen lds
  s_add_u32 m0, s30, 102400
  s_nop 0
  buffer_load_dwordx4 v10, s[8:11], s32 offen lds
  s_add_u32 m0, s30, 103424
  s_nop 0
  buffer_load_dwordx4 v11, s[8:11], s32 offen lds
  s_add_u32 m0, s30, 104448
  s_nop 0
  buffer_load_dwordx4 v12, s[8:11], s32 offen lds
  s_waitcnt vmcnt(30)
  s_barrier
  s_mov_b32 s31, 3840
  s_mov_b32 s32, 368640
  s_add_u32 m0, s29, 122880
  s_nop 0
  buffer_load_dwordx4 v8, s[4:7], s31 offen lds
  s_add_u32 m0, s29, 123904
  s_nop 0
  buffer_load_dwordx4 v9, s[4:7], s31 offen lds
  s_add_u32 m0, s30, 122880
  s_nop 0
  buffer_load_dwordx4 v10, s[8:11], s32 offen lds
  s_add_u32 m0, s30, 123904
  s_nop 0
  buffer_load_dwordx4 v11, s[8:11], s32 offen lds
  s_add_u32 m0, s30, 124928
  s_nop 0
  buffer_load_dwordx4 v12, s[8:11], s32 offen lds
  s_waitcnt vmcnt(30)
  s_barrier
  s_mov_b32 s31, 3968
  s_mov_b32 s32, 380928
  s_add_u32 m0, s29, 143360
  s_nop 0
  buffer_load_dwordx4 v8, s[4:7], s31 offen lds
  s_add_u32 m0, s29, 144384
  s_nop 0
  buffer_load_dwordx4 v9, s[4:7], s31 offen lds
  s_add_u32 m0, s30, 143360
  s_nop 0
  buffer_load_dwordx4 v10, s[8:11], s32 offen lds
  s_add_u32 m0, s30, 144384
  s_nop 0
  buffer_load_dwordx4 v11, s[8:11], s32 offen lds
  s_add_u32 m0, s30, 145408
  s_nop 0
  buffer_load_dwordx4 v12, s[8:11], s32 offen lds
  s_waitcnt vmcnt(30)
  s_barrier
  s_waitcnt vmcnt(25)
  s_barrier
  s_waitcnt vmcnt(20)
  s_barrier
  s_waitcnt vmcnt(15)
  s_barrier
  s_waitcnt vmcnt(10)
  s_barrier
  s_waitcnt vmcnt(5)
  s_barrier
  s_waitcnt vmcnt(0)
  s_barrier
.Lend_k4_kernel:
  s_endpgm

.globl k5a_kernel
.p2align 8
.type k5a_kernel,@function
k5a_kernel:
  s_cmp_ge_u32 s2, 256
  s_cbranch_scc1 .Lend_k5a_kernel
  s_load_dwordx2 s[4:5], s[0:1], 80
  s_load_dwordx2 s[8:9], s[0:1], 56
  s_load_dwordx2 s[12:13], s[0:1], 80
  s_load_dwordx2 s[16:17], s[0:1], 80
  s_and_b32 s24, s2, 7
  s_lshl_b32 s24, s24, 2
  s_lshr_b32 s25, s2, 3
  s_and_b32 s25, s25, 3
  s_add_u32 s24, s24, s25
  s_lshr_b32 s25, s2, 5
  v_and_b32 v1, 63, v0
  v_lshrrev_b32 v4, 6, v0
  v_and_b32 v2, 15, v0
  v_readfirstlane_b32 s26, v4
  v_bfe_u32 v3, v0, 4, 2
  s_lshl_b32 s33, s25, 2
  s_cmp_ge_u32 s26, 4
  s_cbranch_scc1 .Lloader_k5a_kernel_1
  s_and_b32 s27, s26, 1
  s_lshr_b32 s28, s26, 1
  s_lshl_b32 s31, s24, 6
  s_lshl_b32 s32, s27, 5
  s_add_u32 s31, s31, s32
  v_add_u32 v4, s31, v2
  s_mul_i32 s34, s28, 2
  s_add_u32 s34, s34, s33
  s_lshl_b32 s34, s34, 5
  s_mov_b32 s32, 1024
  v_mul_lo_u32 v16, v4, s32
  v_lshl_add_u32 v16, v3, 3, v16
  v_add_u32 v16, s34, v16
  s_mov_b32 s32, 1024
  v_mul_lo_u32 v17, v4, s32
  v_lshl_add_u32 v17, v3, 3, v17
  v_add_u32 v17, s34, v17
  v_lshlrev_b32 v18, 1, v4
  s_mov_b32 s35, 16384
  s_mov_b32 s36, 16384
  s_lshl_b32 s31, s27, 12
  v_lshrrev_b32 v4, 1, v2
  v_xor_b32 v5, v3, v4
  v_and_b32 v5, 3, v5
  v_and_b32 v4, 4, v4
  v_xor_b32 v6, 0, v4
  v_or_b32 v6, v6, v5
  v_lshlrev_b32 v6, 4, v6
  v_lshl_add_u32 v6, v2, 7, v6
  v_add_u32 v20, s31, v6
  v_xor_b32 v6, 4, v4
  v_or_b32 v6, v6, v5
  v_lshlrev_b32 v6, 4, v6
  v_lshl_add_u32 v6, v2, 7, v6
  v_add_u32 v21, s31, v6
  v_lshrrev_b32 v4, 2, v2
  v_lshl_add_u32 v4, v3, 3, v4
  v_mul_u32_u24 v4, 128, v4
  v_and_b32 v5, 3, v2
  v_lshl_add_u32 v4, v5, 3, v4
  v_add_u32 v4, 0x2000, v4
  v_and_b32 v6, 1, v3
  s_mul_i32 s31, s28, 2
  v_bfe_u32 v5, v2, 3, 1
  v_lshl_add_u32 v5, v6, 1, v5
  s_add_u32 s32, s31, 0
  v_xor_b32 v7, s32, v5
  v_lshl_add_u32 v22, v7, 5, v4
  s_add_u32 s32, s31, 1
  v_xor_b32 v7, s32, v5
  v_lshl_add_u32 v23, v7, 5, v4
  v_mov_b32 v128, 0
  v_mov_b32 v129, 0
  v_mov_b32 v130, 0
  v_mov_b32 v131, 0
  v_mov_b32 v132, 0
  v_mov_b32 v133, 0
  v_mov_b32 v134, 0
  v_mov_b32 v135, 0
  v_mov_b32 v136, 0
  v_mov_b32 v137, 0
  v_mov_b32 v138, 0
  v_mov_b32 v139, 0
  v_mov_b32 v140, 0
  v_mov_b32 v141, 0
  v_mov_b32 v142, 0
  v_mov_b32 v143, 0
  s_waitcnt lgkmcnt(0)
  s_add_u32 s12, s12, 0x400000
  s_addc_u32 s13, s13, 0
  s_mov_b32 s14, 0x200000
  s_mov_b32 s15, 0x00020000
  s_add_u32 s16, s16, 0x200000
  s_addc_u32 s17, s17, 0
  s_mov_b32 s18, 0x200000
  s_mov_b32 s19, 0x00020000
  s_barrier
  ds_read_b128 v[64:67], v20 offset:0
  ds_read_b128 v[68:71], v20 offset:2048
  ds_read_b64_tr_b16 v[80:81], v22 offset:0
  ds_read_b64_tr_b16 v[82:83], v22 offset:512
  ds_read_b64_tr_b16 v[84:85], v23 offset:0
  ds_read_b64_tr_b16 v[86:87], v23 offset:512
  ds_read_b128 v[72:75], v21 offset:0
  ds_read_b128 v[76:79], v21 offset:2048
  ds_read_b64_tr_b16 v[88:89], v22 offset:4096
  ds_read_b64_tr_b16 v[90:91], v22 offset:4608
  ds_read_b64_tr_b16 v[92:93], v23 offset:4096
  ds_read_b64_tr_b16 v[94:95], v23 offset:4608
  s_waitcnt lgkmcnt(0)
  s_barrier
  v_add_u32 v26, 0x4000, v20
  v_add_u32 v27, 0x4000, v21
  v_add_u32 v28, 0x4000, v22
  v_add_u32 v29, 0x4000, v23
  v_mfma_f32_16x16x32_bf16 v[128:131], v[80:83], v[64:67], v[128:131]
  ds_read_b128 v[96:99], v26 offset:0
  ds_read_b128 v[100:103], v26 offset:2048
  v_mfma_f32_16x16x32_bf16 v[136:139], v[80:83], v[68:71], v[136:139]
  ds_read_b64_tr_b16 v[112:113], v28 offset:0
  ds_read_b64_tr_b16 v[114:115], v28 offset:512
  v_mfma_f32_16x16x32_bf16 v[132:135], v[84:87], v[64:67], v[132:135]
  ds_read_b64_tr_b16 v[116:117], v29 offset:0
  ds_read_b64_tr_b16 v[118:119], v29 offset:512
  v_mfma_f32_16x16x32_bf16 v[140:143], v[84:87], v[68:71], v[140:143]
  ds_read_b128 v[104:107], v27 offset:0
  ds_read_b128 v[108:111], v27 offset:2048
  v_mfma_f32_16x16x32_bf16 v[128:131], v[88:91], v[72:75], v[128:131]
  ds_read_b64_tr_b16 v[120:121], v28 offset:4096
  ds_read_b64_tr_b16 v[122:123], v28 offset:4608
  v_mfma_f32_16x16x32_bf16 v[136:139], v[88:91], v[76:79], v[136:139]
  ds_read_b64_tr_b16 v[124:125], v29 offset:4096
  ds_read_b64_tr_b16 v[126:127], v29 offset:4608
  v_mfma_f32_16x16x32_bf16 v[132:135], v[92:95], v[72:75], v[132:135]
  v_mfma_f32_16x16x32_bf16 v[140:143], v[92:95], v[76:79], v[140:143]
  s_waitcnt lgkmcnt(0)
  s_barrier
  v_add_u32 v26, 0x8000, v20
  v_add_u32 v27, 0x8000, v21
  v_add_u32 v28, 0x8000, v22
  v_add_u32 v29, 0x8000, v23
  v_mfma_f32_16x16x32_bf16 v[128:131], v[112:115], v[96:99], v[128:131]
  ds_read_b128 v[64:67], v26 offset:0
  ds_read_b128 v[68:71], v26 offset:2048
  v_mfma_f32_16x16x32_bf16 v[136:139], v[112:115], v[100:103], v[136:139]
  ds_read_b64_tr_b16 v[80:81], v28 offset:0
  ds_read_b64_tr_b16 v[82:83], v28 offset:512
  v_mfma_f32_16x16x32_bf16 v[132:135], v[116:119], v[96:99], v[132:135]
  ds_read_b64_tr_b16 v[84:85], v29 offset:0
  ds_read_b64_tr_b16 v[86:87], v29 offset:512
  v_mfma_f32_16x16x32_bf16 v[140:143], v[116:119], v[100:103], v[140:143]
  ds_read_b128 v[72:75], v27 offset:0
  ds_read_b128 v[76:79], v27 offset:2048
  v_mfma_f32_16x16x32_bf16 v[128:131], v[120:123], v[104:107], v[128:131]
  ds_read_b64_tr_b16 v[88:89], v28 offset:4096
  ds_read_b64_tr_b16 v[90:91], v28 offset:4608
  v_mfma_f32_16x16x32_bf16 v[136:139], v[120:123], v[108:111], v[136:139]
  ds_read_b64_tr_b16 v[92:93], v29 offset:4096
  ds_read_b64_tr_b16 v[94:95], v29 offset:4608
  v_mfma_f32_16x16x32_bf16 v[132:135], v[124:127], v[104:107], v[132:135]
  v_mfma_f32_16x16x32_bf16 v[140:143], v[124:127], v[108:111], v[140:143]
  s_waitcnt lgkmcnt(0)
  s_barrier
  v_add_u32 v26, 0xc000, v20
  v_add_u32 v27, 0xc000, v21
  v_add_u32 v28, 0xc000, v22
  v_add_u32 v29, 0xc000, v23
  v_mfma_f32_16x16x32_bf16 v[128:131], v[80:83], v[64:67], v[128:131]
  ds_read_b128 v[96:99], v26 offset:0
  ds_read_b128 v[100:103], v26 offset:2048
  v_mfma_f32_16x16x32_bf16 v[136:139], v[80:83], v[68:71], v[136:139]
  ds_read_b64_tr_b16 v[112:113], v28 offset:0
  ds_read_b64_tr_b16 v[114:115], v28 offset:512
  v_mfma_f32_16x16x32_bf16 v[132:135], v[84:87], v[64:67], v[132:135]
  ds_read_b64_tr_b16 v[116:117], v29 offset:0
  ds_read_b64_tr_b16 v[118:119], v29 offset:512
  v_mfma_f32_16x16x32_bf16 v[140:143], v[84:87], v[68:71], v[140:143]
  ds_read_b128 v[104:107], v27 offset:0
  ds_read_b128 v[108:111], v27 offset:2048
  v_mfma_f32_16x16x32_bf16 v[128:131], v[88:91], v[72:75], v[128:131]
  ds_read_b64_tr_b16 v[120:121], v28 offset:4096
  ds_read_b64_tr_b16 v[122:123], v28 offset:4608
  v_mfma_f32_16x16x32_bf16 v[136:139], v[88:91], v[76:79], v[136:139]
  ds_read_b64_tr_b16 v[124:125], v29 offset:4096
  ds_read_b64_tr_b16 v[126:127], v29 offset:4608
  v_mfma_f32_16x16x32_bf16 v[132:135], v[92:95], v[72:75], v[132:135]
  v_mfma_f32_16x16x32_bf16 v[140:143], v[92:95], v[76:79], v[140:143]
  s_waitcnt lgkmcnt(0)
  s_barrier
  v_add_u32 v26, 0x10000, v20
  v_add_u32 v27, 0x10000, v21
  v_add_u32 v28, 0x10000, v22
  v_add_u32 v29, 0x10000, v23
  v_mfma_f32_16x16x32_bf16 v[128:131], v[112:115], v[96:99], v[128:131]
  ds_read_b128 v[64:67], v26 offset:0
  ds_read_b128 v[68:71], v26 offset:2048
  v_mfma_f32_16x16x32_bf16 v[136:139], v[112:115], v[100:103], v[136:139]
  ds_read_b64_tr_b16 v[80:81], v28 offset:0
  ds_read_b64_tr_b16 v[82:83], v28 offset:512
  v_mfma_f32_16x16x32_bf16 v[132:135], v[116:119], v[96:99], v[132:135]
  ds_read_b64_tr_b16 v[84:85], v29 offset:0
  ds_read_b64_tr_b16 v[86:87], v29 offset:512
  v_mfma_f32_16x16x32_bf16 v[140:143], v[116:119], v[100:103], v[140:143]
  ds_read_b128 v[72:75], v27 offset:0
  ds_read_b128 v[76:79], v27 offset:2048
  v_mfma_f32_16x16x32_bf16 v[128:131], v[120:123], v[104:107], v[128:131]
  ds_read_b64_tr_b16 v[88:89], v28 offset:4096
  ds_read_b64_tr_b16 v[90:91], v28 offset:4608
  v_mfma_f32_16x16x32_bf16 v[136:139], v[120:123], v[108:111], v[136:139]
  ds_read_b64_tr_b16 v[92:93], v29 offset:4096
  ds_read_b64_tr_b16 v[94:95], v29 offset:4608
  v_mfma_f32_16x16x32_bf16 v[132:135], v[124:127], v[104:107], v[132:135]
  v_mfma_f32_16x16x32_bf16 v[140:143], v[124:127], v[108:111], v[140:143]
  s_waitcnt lgkmcnt(0)
  s_barrier
  v_add_u32 v26, 0x14000, v20
  v_add_u32 v27, 0x14000, v21
  v_add_u32 v28, 0x14000, v22
  v_add_u32 v29, 0x14000, v23
  v_mfma_f32_16x16x32_bf16 v[128:131], v[80:83], v[64:67], v[128:131]
  ds_read_b128 v[96:99], v26 offset:0
  ds_read_b128 v[100:103], v26 offset:2048
  v_mfma_f32_16x16x32_bf16 v[136:139], v[80:83], v[68:71], v[136:139]
  ds_read_b64_tr_b16 v[112:113], v28 offset:0
  ds_read_b64_tr_b16 v[114:115], v28 offset:512
  v_mfma_f32_16x16x32_bf16 v[132:135], v[84:87], v[64:67], v[132:135]
  ds_read_b64_tr_b16 v[116:117], v29 offset:0
  ds_read_b64_tr_b16 v[118:119], v29 offset:512
  v_mfma_f32_16x16x32_bf16 v[140:143], v[84:87], v[68:71], v[140:143]
  ds_read_b128 v[104:107], v27 offset:0
  ds_read_b128 v[108:111], v27 offset:2048
  v_mfma_f32_16x16x32_bf16 v[128:131], v[88:91], v[72:75], v[128:131]
  ds_read_b64_tr_b16 v[120:121], v28 offset:4096
  ds_read_b64_tr_b16 v[122:123], v28 offset:4608
  v_mfma_f32_16x16x32_bf16 v[136:139], v[88:91], v[76:79], v[136:139]
  ds_read_b64_tr_b16 v[124:125], v29 offset:4096
  ds_read_b64_tr_b16 v[126:127], v29 offset:4608
  v_mfma_f32_16x16x32_bf16 v[132:135], v[92:95], v[72:75], v[132:135]
  v_mfma_f32_16x16x32_bf16 v[140:143], v[92:95], v[76:79], v[140:143]
  s_waitcnt lgkmcnt(0)
  s_barrier
  v_add_u32 v26, 0x18000, v20
  v_add_u32 v27, 0x18000, v21
  v_add_u32 v28, 0x18000, v22
  v_add_u32 v29, 0x18000, v23
  v_mfma_f32_16x16x32_bf16 v[128:131], v[112:115], v[96:99], v[128:131]
  ds_read_b128 v[64:67], v26 offset:0
  ds_read_b128 v[68:71], v26 offset:2048
  v_mfma_f32_16x16x32_bf16 v[136:139], v[112:115], v[100:103], v[136:139]
  ds_read_b64_tr_b16 v[80:81], v28 offset:0
  ds_read_b64_tr_b16 v[82:83], v28 offset:512
  v_mfma_f32_16x16x32_bf16 v[132:135], v[116:119], v[96:99], v[132:135]
  ds_read_b64_tr_b16 v[84:85], v29 offset:0
  ds_read_b64_tr_b16 v[86:87], v29 offset:512
  v_mfma_f32_16x16x32_bf16 v[140:143], v[116:119], v[100:103], v[140:143]
  ds_read_b128 v[72:75], v27 offset:0
  ds_read_b128 v[76:79], v27 offset:2048
  v_mfma_f32_16x16x32_bf16 v[128:131], v[120:123], v[104:107], v[128:131]
  ds_read_b64_tr_b16 v[88:89], v28 offset:4096
  ds_read_b64_tr_b16 v[90:91], v28 offset:4608
  v_mfma_f32_16x16x32_bf16 v[136:139], v[120:123], v[108:111], v[136:139]
  ds_read_b64_tr_b16 v[92:93], v29 offset:4096
  ds_read_b64_tr_b16 v[94:95], v29 offset:4608
  v_mfma_f32_16x16x32_bf16 v[132:135], v[124:127], v[104:107], v[132:135]
  v_mfma_f32_16x16x32_bf16 v[140:143], v[124:127], v[108:111], v[140:143]
  s_waitcnt lgkmcnt(0)
  s_barrier
  v_add_u32 v26, 0x1c000, v20
  v_add_u32 v27, 0x1c000, v21
  v_add_u32 v28, 0x1c000, v22
  v_add_u32 v29, 0x1c000, v23
  v_mfma_f32_16x16x32_bf16 v[128:131], v[80:83], v[64:67], v[128:131]
  ds_read_b128 v[96:99], v26 offset:0
  ds_read_b128 v[100:103], v26 offset:2048
  v_mfma_f32_16x16x32_bf16 v[136:139], v[80:83], v[68:71], v[136:139]
  ds_read_b64_tr_b16 v[112:113], v28 offset:0
  ds_read_b64_tr_b16 v[114:115], v28 offset:512
  v_mfma_f32_16x16x32_bf16 v[132:135], v[84:87], v[64:67], v[132:135]
  ds_read_b64_tr_b16 v[116:117], v29 offset:0
  ds_read_b64_tr_b16 v[118:119], v29 offset:512
  v_mfma_f32_16x16x32_bf16 v[140:143], v[84:87], v[68:71], v[140:143]
  ds_read_b128 v[104:107], v27 offset:0
  ds_read_b128 v[108:111], v27 offset:2048
  v_mfma_f32_16x16x32_bf16 v[128:131], v[88:91], v[72:75], v[128:131]
  ds_read_b64_tr_b16 v[120:121], v28 offset:4096
  ds_read_b64_tr_b16 v[122:123], v28 offset:4608
  v_mfma_f32_16x16x32_bf16 v[136:139], v[88:91], v[76:79], v[136:139]
  ds_read_b64_tr_b16 v[124:125], v29 offset:4096
  ds_read_b64_tr_b16 v[126:127], v29 offset:4608
  v_mfma_f32_16x16x32_bf16 v[132:135], v[92:95], v[72:75], v[132:135]
  v_mfma_f32_16x16x32_bf16 v[140:143], v[92:95], v[76:79], v[140:143]
  buffer_load_dwordx2 v[32:33], v17, s[16:19], 0 offen offset:0
  buffer_load_dwordx2 v[34:35], v17, s[16:19], 0 offen offset:32
  buffer_load_dwordx2 v[36:37], v17, s[16:19], s35 offen offset:0
  buffer_load_dwordx2 v[38:39], v17, s[16:19], s35 offen offset:32
  s_waitcnt lgkmcnt(0)
  s_barrier
  v_add_u32 v26, 0x20000, v20
  v_add_u32 v27, 0x20000, v21
  v_add_u32 v28, 0x20000, v22
  v_add_u32 v29, 0x20000, v23
  v_mfma_f32_16x16x32_bf16 v[128:131], v[112:115], v[96:99], v[128:131]
  ds_read_b128 v[64:67], v26 offset:0
  ds_read_b128 v[68:71], v26 offset:2048
  v_mfma_f32_16x16x32_bf16 v[136:139], v[112:115], v[100:103], v[136:139]
  ds_read_b64_tr_b16 v[80:81], v28 offset:0
  ds_read_b64_tr_b16 v[82:83], v28 offset:512
  v_mfma_f32_16x16x32_bf16 v[132:135], v[116:119], v[96:99], v[132:135]
  ds_read_b64_tr_b16 v[84:85], v29 offset:0
  ds_read_b64_tr_b16 v[86:87], v29 offset:512
  v_mfma_f32_16x16x32_bf16 v[140:143], v[116:119], v[100:103], v[140:143]
  ds_read_b128 v[72:75], v27 offset:0
  ds_read_b128 v[76:79], v27 offset:2048
  v_mfma_f32_16x16x32_bf16 v[128:131], v[120:123], v[104:107], v[128:131]
  ds_read_b64_tr_b16 v[88:89], v28 offset:4096
  ds_read_b64_tr_b16 v[90:91], v28 offset:4608
  v_mfma_f32_16x16x32_bf16 v[136:139], v[120:123], v[108:111], v[136:139]
  ds_read_b64_tr_b16 v[92:93], v29 offset:4096
  ds_read_b64_tr_b16 v[94:95], v29 offset:4608
  v_mfma_f32_16x16x32_bf16 v[132:135], v[124:127], v[104:107], v[132:135]
  v_mfma_f32_16x16x32_bf16 v[140:143], v[124:127], v[108:111], v[140:143]
  s_waitcnt lgkmcnt(0)
  s_barrier
  v_add_u32 v26, 0x24000, v20
  v_add_u32 v27, 0x24000, v21
  v_add_u32 v28, 0x24000, v22
  v_add_u32 v29, 0x24000, v23
  v_mfma_f32_16x16x32_bf16 v[128:131], v[80:83], v[64:67], v[128:131]
  ds_read_b128 v[96:99], v26 offset:0
  ds_read_b128 v[100:103], v26 offset:2048
  v_mfma_f32_16x16x32_bf16 v[136:139], v[80:83], v[68:71], v[136:139]
  ds_read_b64_tr_b16 v[112:113], v28 offset:0
  ds_read_b64_tr_b16 v[114:115], v28 offset:512
  v_mfma_f32_16x16x32_bf16 v[132:135], v[84:87], v[64:67], v[132:135]
  ds_read_b64_tr_b16 v[116:117], v29 offset:0
  ds_read_b64_tr_b16 v[118:119], v29 offset:512
  v_mfma_f32_16x16x32_bf16 v[140:143], v[84:87], v[68:71], v[140:143]
  ds_read_b128 v[104:107], v27 offset:0
  ds_read_b128 v[108:111], v27 offset:2048
  v_mfma_f32_16x16x32_bf16 v[128:131], v[88:91], v[72:75], v[128:131]
  ds_read_b64_tr_b16 v[120:121], v28 offset:4096
  ds_read_b64_tr_b16 v[122:123], v28 offset:4608
  v_mfma_f32_16x16x32_bf16 v[136:139], v[88:91], v[76:79], v[136:139]
  ds_read_b64_tr_b16 v[124:125], v29 offset:4096
  ds_read_b64_tr_b16 v[126:127], v29 offset:4608
  v_mfma_f32_16x16x32_bf16 v[132:135], v[92:95], v[72:75], v[132:135]
  v_mfma_f32_16x16x32_bf16 v[140:143], v[92:95], v[76:79], v[140:143]
  s_waitcnt lgkmcnt(0)
  s_barrier
  v_mfma_f32_16x16x32_bf16 v[128:131], v[112:115], v[96:99], v[128:131]
  ds_read_b128 v[64:67], v20 offset:0
  ds_read_b128 v[68:71], v20 offset:2048
  v_mfma_f32_16x16x32_bf16 v[136:139], v[112:115], v[100:103], v[136:139]
  ds_read_b64_tr_b16 v[80:81], v22 offset:0
  ds_read_b64_tr_b16 v[82:83], v22 offset:512
  v_mfma_f32_16x16x32_bf16 v[132:135], v[116:119], v[96:99], v[132:135]
  ds_read_b64_tr_b16 v[84:85], v23 offset:0
  ds_read_b64_tr_b16 v[86:87], v23 offset:512
  v_mfma_f32_16x16x32_bf16 v[140:143], v[116:119], v[100:103], v[140:143]
  ds_read_b128 v[72:75], v21 offset:0
  ds_read_b128 v[76:79], v21 offset:2048
  v_mfma_f32_16x16x32_bf16 v[128:131], v[120:123], v[104:107], v[128:131]
  ds_read_b64_tr_b16 v[88:89], v22 offset:4096
  ds_read_b64_tr_b16 v[90:91], v22 offset:4608
  v_mfma_f32_16x16x32_bf16 v[136:139], v[120:123], v[108:111], v[136:139]
  ds_read_b64_tr_b16 v[92:93], v23 offset:4096
  ds_read_b64_tr_b16 v[94:95], v23 offset:4608
  v_mfma_f32_16x16x32_bf16 v[132:135], v[124:127], v[104:107], v[132:135]
  v_mfma_f32_16x16x32_bf16 v[140:143], v[124:127], v[108:111], v[140:143]
  s_waitcnt lgkmcnt(0)
  v_mfma_f32_16x16x32_bf16 v[128:131], v[80:83], v[64:67], v[128:131]
  v_mfma_f32_16x16x32_bf16 v[136:139], v[80:83], v[68:71], v[136:139]
  v_mfma_f32_16x16x32_bf16 v[132:135], v[84:87], v[64:67], v[132:135]
  v_mfma_f32_16x16x32_bf16 v[140:143], v[84:87], v[68:71], v[140:143]
  v_mfma_f32_16x16x32_bf16 v[128:131], v[88:91], v[72:75], v[128:131]
  v_mfma_f32_16x16x32_bf16 v[136:139], v[88:91], v[76:79], v[136:139]
  v_mfma_f32_16x16x32_bf16 v[132:135], v[92:95], v[72:75], v[132:135]
  v_mfma_f32_16x16x32_bf16 v[140:143], v[92:95], v[76:79], v[140:143]
  s_waitcnt vmcnt(0)
  s_nop 7
  v_cvt_pk_bf16_f32 v8, v128, v129
  v_cvt_pk_bf16_f32 v9, v130, v131
  v_lshlrev_b32 v4, 16, v32
  v_and_b32 v5, 0xffff0000, v32
  v_lshlrev_b32 v6, 16, v33
  v_and_b32 v7, 0xffff0000, v33
  v_lshlrev_b32 v128, 16, v8
  v_and_b32 v129, 0xffff0000, v8
  v_lshlrev_b32 v130, 16, v9
  v_and_b32 v131, 0xffff0000, v9
  v_pk_add_f32 v[128:129], v[128:129], v[4:5]
  v_pk_add_f32 v[130:131], v[130:131], v[6:7]
  v_cvt_pk_bf16_f32 v32, v128, v129
  v_cvt_pk_bf16_f32 v33, v130, v131
  buffer_store_dwordx2 v[32:33], v16, s[12:15], 0 offen offset:0
  v_cvt_pk_bf16_f32 v8, v132, v133
  v_cvt_pk_bf16_f32 v9, v134, v135
  v_lshlrev_b32 v4, 16, v34
  v_and_b32 v5, 0xffff0000, v34
  v_lshlrev_b32 v6, 16, v35
  v_and_b32 v7, 0xffff0000, v35
  v_lshlrev_b32 v132, 16, v8
  v_and_b32 v133, 0xffff0000, v8
  v_lshlrev_b32 v134, 16, v9
  v_and_b32 v135, 0xffff0000, v9
  v_pk_add_f32 v[132:133], v[132:133], v[4:5]
  v_pk_add_f32 v[134:135], v[134:135], v[6:7]
  v_cvt_pk_bf16_f32 v34, v132, v133
  v_cvt_pk_bf16_f32 v35, v134, v135
  buffer_store_dwordx2 v[34:35], v16, s[12:15], 0 offen offset:32
  v_cvt_pk_bf16_f32 v8, v136, v137
  v_cvt_pk_bf16_f32 v9, v138, v139
  v_lshlrev_b32 v4, 16, v36
  v_and_b32 v5, 0xffff0000, v36
  v_lshlrev_b32 v6, 16, v37
  v_and_b32 v7, 0xffff0000, v37
  v_lshlrev_b32 v136, 16, v8
  v_and_b32 v137, 0xffff0000, v8
  v_lshlrev_b32 v138, 16, v9
  v_and_b32 v139, 0xffff0000, v9
  v_pk_add_f32 v[136:137], v[136:137], v[4:5]
  v_pk_add_f32 v[138:139], v[138:139], v[6:7]
  v_cvt_pk_bf16_f32 v36, v136, v137
  v_cvt_pk_bf16_f32 v37, v138, v139
  buffer_store_dwordx2 v[36:37], v16, s[12:15], s36 offen offset:0
  v_cvt_pk_bf16_f32 v8, v140, v141
  v_cvt_pk_bf16_f32 v9, v142, v143
  v_lshlrev_b32 v4, 16, v38
  v_and_b32 v5, 0xffff0000, v38
  v_lshlrev_b32 v6, 16, v39
  v_and_b32 v7, 0xffff0000, v39
  v_lshlrev_b32 v140, 16, v8
  v_and_b32 v141, 0xffff0000, v8
  v_lshlrev_b32 v142, 16, v9
  v_and_b32 v143, 0xffff0000, v9
  v_pk_add_f32 v[140:141], v[140:141], v[4:5]
  v_pk_add_f32 v[142:143], v[142:143], v[6:7]
  v_cvt_pk_bf16_f32 v38, v140, v141
  v_cvt_pk_bf16_f32 v39, v142, v143
  buffer_store_dwordx2 v[38:39], v16, s[12:15], s36 offen offset:32
  s_branch .Lend_k5a_kernel
.Lloader_k5a_kernel_1:
  s_sub_u32 s26, s26, 4
  v_lshrrev_b32 v4, 3, v1
  v_and_b32 v5, 7, v1
  s_lshl_b32 s31, s26, 4
  s_mov_b32 s32, 1408
  s_lshl_b32 s34, s24, 6
  v_add_u32 v6, s31, v4
  v_bfe_u32 v7, v6, 1, 3
  v_xor_b32 v7, v7, v5
  v_add_u32 v6, s34, v6
  v_mul_lo_u32 v6, v6, s32
  v_lshl_add_u32 v8, v7, 4, v6
  v_add_u32 v6, s31, v4
  v_add_u32 v6, 8, v6
  v_bfe_u32 v7, v6, 1, 3
  v_xor_b32 v7, v7, v5
  v_add_u32 v6, s34, v6
  v_mul_lo_u32 v6, v6, s32
  v_lshl_add_u32 v9, v7, 4, v6
  s_mov_b32 s32, 1024
  v_add_u32 v6, s31, v4
  v_bfe_u32 v7, v6, 1, 1
  v_bfe_u32 v13, v6, 3, 1
  v_lshl_add_u32 v7, v13, 1, v7
  v_lshrrev_b32 v13, 1, v5
  v_xor_b32 v7, v7, v13
  v_add_u32 v7, s33, v7
  v_lshlrev_b32 v7, 4, v7
  v_and_b32 v13, 1, v5
  v_lshl_add_u32 v7, v13, 3, v7
  v_lshlrev_b32 v7, 1, v7
  v_mul_lo_u32 v6, v6, s32
  v_add_u32 v10, v6, v7
  v_add_u32 v6, s31, v4
  v_add_u32 v6, 8, v6
  v_bfe_u32 v7, v6, 1, 1
  v_bfe_u32 v13, v6, 3, 1
  v_lshl_add_u32 v7, v13, 1, v7
  v_lshrrev_b32 v13, 1, v5
  v_xor_b32 v7, v7, v13
  v_add_u32 v7, s33, v7
  v_lshlrev_b32 v7, 4, v7
  v_and_b32 v13, 1, v5
  v_lshl_add_u32 v7, v13, 3, v7
  v_lshlrev_b32 v7, 1, v7
  v_mul_lo_u32 v6, v6, s32
  v_add_u32 v11, v6, v7
  s_lshl_b32 s29, s26, 11
  s_mul_i32 s30, s26, 2048
  s_add_u32 s30, s30, 8192
  s_waitcnt lgkmcnt(0)
  s_add_u32 s4, s4, 0x1000000
  s_addc_u32 s5, s5, 0
  s_mov_b32 s6, 0x2c0000
  s_mov_b32 s7, 0x00020000
  s_mov_b32 s10, 0xac000
  s_mov_b32 s11, 0x00020000
  s_mov_b32 s31, 0
  s_mov_b32 s32, 0
  s_add_u32 m0, s29, 0
  s_nop 0
  buffer_load_dwordx4 v8, s[4:7], s31 offen lds
  s_add_u32 m0, s29, 1024
  s_nop 0
  buffer_load_dwordx4 v9, s[4:7], s31 offen lds
  s_add_u32 m0, s30, 0
  s_nop 0
  buffer_load_dwordx4 v10, s[8:11], s32 offen lds
  s_add_u32 m0, s30, 1024
  s_nop 0
  buffer_load_dwordx4 v11, s[8:11], s32 offen lds
  s_mov_b32 s31, 128
  s_mov_b32 s32, 65536
  s_add_u32 m0, s29, 16384
  s_nop 0
  buffer_load_dwordx4 v8, s[4:7], s31 offen lds
  s_add_u32 m0, s29, 17408
  s_nop 0
  buffer_load_dwordx4 v9, s[4:7], s31 offen lds
  s_add_u32 m0, s30, 16384
  s_nop 0
  buffer_load_dwordx4 v10, s[8:11], s32 offen lds
  s_add_u32 m0, s30, 17408
  s_nop 0
  buffer_load_dwordx4 v11, s[8:11], s32 offen lds
  s_mov_b32 s31, 256
  s_mov_b32 s32, 131072
  s_add_u32 m0, s29, 32768
  s_nop 0
  buffer_load_dwordx4 v8, s[4:7], s31 offen lds
  s_add_u32 m0, s29, 33792
  s_nop 0
  buffer_load_dwordx4 v9, s[4:7], s31 offen lds
  s_add_u32 m0, s30, 32768
  s_nop 0
  buffer_load_dwordx4 v10, s[8:11], s32 offen lds
  s_add_u32 m0, s30, 33792
  s_nop 0
  buffer_load_dwordx4 v11, s[8:11], s32 offen lds
  s_mov_b32 s31, 384
  s_mov_b32 s32, 196608
  s_add_u32 m0, s29, 49152
  s_nop 0
  buffer_load_dwordx4 v8, s[4:7], s31 offen lds
  s_add_u32 m0, s29, 50176
  s_nop 0
  buffer_load_dwordx4 v9, s[4:7], s31 offen lds
  s_add_u32 m0, s30, 49152
  s_nop 0
  buffer_load_dwordx4 v10, s[8:11], s32 offen lds
  s_add_u32 m0, s30, 50176
  s_nop 0
  buffer_load_dwordx4 v11, s[8:11], s32 offen lds
  s_waitcnt vmcnt(12)
  s_barrier
  s_mov_b32 s31, 512
  s_mov_b32 s32, 262144
  s_add_u32 m0, s29, 65536
  s_nop 0
  buffer_load_dwordx4 v8, s[4:7], s31 offen lds
  s_add_u32 m0, s29, 66560
  s_nop 0
  buffer_load_dwordx4 v9, s[4:7], s31 offen lds
  s_add_u32 m0, s30, 65536
  s_nop 0
  buffer_load_dwordx4 v10, s[8:11], s32 offen lds
  s_add_u32 m0, s30, 66560
  s_nop 0
  buffer_load_dwordx4 v11, s[8:11], s32 offen lds
  s_mov_b32 s31, 640
  s_mov_b32 s32, 327680
  s_add_u32 m0, s29, 81920
  s_nop 0
  buffer_load_dwordx4 v8, s[4:7], s31 offen lds
  s_add_u32 m0, s29, 82944
  s_nop 0
  buffer_load_dwordx4 v9, s[4:7], s31 offen lds
  s_add_u32 m0, s30, 81920
  s_nop 0
  buffer_load_dwordx4 v10, s[8:11], s32 offen lds
  s_add_u32 m0, s30, 82944
  s_nop 0
  buffer_load_dwordx4 v11, s[8:11], s32 offen lds
  s_waitcnt vmcnt(16)
  s_barrier
  s_mov_b32 s31, 768
  s_mov_b32 s32, 393216
  s_add_u32 m0, s29, 98304
  s_nop 0
  buffer_load_dwordx4 v8, s[4:7], s31 offen lds
  s_add_u32 m0, s29, 99328
  s_nop 0
  buffer_load_dwordx4 v9, s[4:7], s31 offen lds
  s_add_u32 m0, s30, 98304
  s_nop 0
  buffer_load_dwordx4 v10, s[8:11], s32 offen lds
  s_add_u32 m0, s30, 99328
  s_nop 0
  buffer_load_dwordx4 v11, s[8:11], s32 offen lds
  s_mov_b32 s31, 896
  s_mov_b32 s32, 458752
  s_add_u32 m0, s29, 114688
  s_nop 0
  buffer_load_dwordx4 v8, s[4:7], s31 offen lds
  s_add_u32 m0, s29, 115712
  s_nop 0
  buffer_load_dwordx4 v9, s[4:7], s31 offen lds
  s_add_u32 m0, s30, 114688
  s_nop 0
  buffer_load_dwordx4 v10, s[8:11], s32 offen lds
  s_add_u32 m0, s30, 115712
  s_nop 0
  buffer_load_dwordx4 v11, s[8:11], s32 offen lds
  s_waitcnt vmcnt(20)
  s_barrier
  s_mov_b32 s31, 1024
  s_mov_b32 s32, 524288
  s_add_u32 m0, s29, 131072
  s_nop 0
  buffer_load_dwordx4 v8, s[4:7], s31 offen lds
  s_add_u32 m0, s29, 132096
  s_nop 0
  buffer_load_dwordx4 v9, s[4:7], s31 offen lds
  s_add_u32 m0, s30, 131072
  s_nop 0
  buffer_load_dwordx4 v10, s[8:11], s32 offen lds
  s_add_u32 m0, s30, 132096
  s_nop 0
  buffer_load_dwordx4 v11, s[8:11], s32 offen lds
  s_mov_b32 s31, 1152
  s_mov_b32 s32, 589824
  s_add_u32 m0, s29, 147456
  s_nop 0
  buffer_load_dwordx4 v8, s[4:7], s31 offen lds
  s_add_u32 m0, s29, 148480
  s_nop 0
  buffer_load_dwordx4 v9, s[4:7], s31 offen lds
  s_add_u32 m0, s30, 147456
  s_nop 0
  buffer_load_dwordx4 v10, s[8:11], s32 offen lds
  s_add_u32 m0, s30, 148480
  s_nop 0
  buffer_load_dwordx4 v11, s[8:11], s32 offen lds
  s_waitcnt vmcnt(24)
  s_barrier
  s_mov_b32 s31, 1280
  s_mov_b32 s32, 655360
  s_add_u32 m0, s29, 0
  s_nop 0
  buffer_load_dwordx4 v8, s[4:7], s31 offen lds
  s_add_u32 m0, s29, 1024
  s_nop 0
  buffer_load_dwordx4 v9, s[4:7], s31 offen lds
  s_add_u32 m0, s30, 0
  s_nop 0
  buffer_load_dwordx4 v10, s[8:11], s32 offen lds
  s_add_u32 m0, s30, 1024
  s_nop 0
  buffer_load_dwordx4 v11, s[8:11], s32 offen lds
  s_waitcnt vmcnt(24)
  s_barrier
  s_waitcnt vmcnt(20)
  s_barrier
  s_waitcnt vmcnt(16)
  s_barrier
  s_waitcnt vmcnt(12)
  s_barrier
  s_waitcnt vmcnt(8)
  s_barrier
  s_waitcnt vmcnt(4)
  s_barrier
  s_waitcnt vmcnt(0)
  s_barrier
.Lend_k5a_kernel:
  s_endpgm

.globl k5b_kernel
.p2align 8
.type k5b_kernel,@function
k5b_kernel:
  s_cmp_ge_u32 s2, 256
  s_cbranch_scc1 .Lend_k5b_kernel
  s_load_dwordx2 s[4:5], s[0:1], 80
  s_load_dwordx2 s[8:9], s[0:1], 56
  s_load_dwordx2 s[12:13], s[0:1], 64
  s_load_dwordx2 s[16:17], s[0:1], 80
  s_and_b32 s24, s2, 7
  s_lshl_b32 s24, s24, 2
  s_lshr_b32 s25, s2, 3
  s_and_b32 s25, s25, 3
  s_add_u32 s24, s24, s25
  s_lshr_b32 s25, s2, 5
  v_and_b32 v1, 63, v0
  v_lshrrev_b32 v4, 6, v0
  v_and_b32 v2, 15, v0
  v_readfirstlane_b32 s26, v4
  v_bfe_u32 v3, v0, 4, 2
  s_lshl_b32 s33, s25, 2
  s_cmp_ge_u32 s26, 4
  s_cbranch_scc1 .Lloader_k5b_kernel_1
  s_and_b32 s27, s26, 1
  s_lshr_b32 s28, s26, 1
  s_lshl_b32 s31, s24, 6
  s_lshl_b32 s32, s27, 5
  s_add_u32 s31, s31, s32
  v_add_u32 v4, s31, v2
  s_mul_i32 s34, s28, 2
  s_add_u32 s34, s34, s33
  s_lshl_b32 s34, s34, 5
  s_mov_b32 s32, 1024
  v_mul_lo_u32 v16, v4, s32
  v_lshl_add_u32 v16, v3, 3, v16
  v_add_u32 v16, s34, v16
  s_mov_b32 s32, 1024
  v_mul_lo_u32 v17, v4, s32
  v_lshl_add_u32 v17, v3, 3, v17
  v_add_u32 v17, s34, v17
  v_lshlrev_b32 v18, 1, v4
  s_mov_b32 s35, 16384
  s_mov_b32 s36, 16384
  s_lshl_b32 s31, s27, 12
  v_lshrrev_b32 v4, 1, v2
  v_xor_b32 v5, v3, v4
  v_and_b32 v5, 3, v5
  v_and_b32 v4, 4, v4
  v_xor_b32 v6, 0, v4
  v_or_b32 v6, v6, v5
  v_lshlrev_b32 v6, 4, v6
  v_lshl_add_u32 v6, v2, 7, v6
  v_add_u32 v20, s31, v6
  v_xor_b32 v6, 4, v4
  v_or_b32 v6, v6, v5
  v_lshlrev_b32 v6, 4, v6
  v_lshl_add_u32 v6, v2, 7, v6
  v_add_u32 v21, s31, v6
  v_lshrrev_b32 v4, 2, v2
  v_lshl_add_u32 v4, v3, 3, v4
  v_mul_u32_u24 v4, 128, v4
  v_and_b32 v5, 3, v2
  v_lshl_add_u32 v4, v5, 3, v4
  v_add_u32 v4, 0x2000, v4
  v_and_b32 v6, 1, v3
  s_mul_i32 s31, s28, 2
  v_bfe_u32 v5, v2, 3, 1
  v_lshl_add_u32 v5, v6, 1, v5
  s_add_u32 s32, s31, 0
  v_xor_b32 v7, s32, v5
  v_lshl_add_u32 v22, v7, 5, v4
  s_add_u32 s32, s31, 1
  v_xor_b32 v7, s32, v5
  v_lshl_add_u32 v23, v7, 5, v4
  v_mov_b32 v128, 0
  v_mov_b32 v129, 0
  v_mov_b32 v130, 0
  v_mov_b32 v131, 0
  v_mov_b32 v132, 0
  v_mov_b32 v133, 0
  v_mov_b32 v134, 0
  v_mov_b32 v135, 0
  v_mov_b32 v136, 0
  v_mov_b32 v137, 0
  v_mov_b32 v138, 0
  v_mov_b32 v139, 0
  v_mov_b32 v140, 0
  v_mov_b32 v141, 0
  v_mov_b32 v142, 0
  v_mov_b32 v143, 0
  s_waitcnt lgkmcnt(0)
  s_mov_b32 s14, 0x200000
  s_mov_b32 s15, 0x00020000
  s_add_u32 s16, s16, 0x200000
  s_addc_u32 s17, s17, 0
  s_mov_b32 s18, 0x200000
  s_mov_b32 s19, 0x00020000
  s_barrier
  ds_read_b128 v[64:67], v20 offset:0
  ds_read_b128 v[68:71], v20 offset:2048
  ds_read_b64_tr_b16 v[80:81], v22 offset:0
  ds_read_b64_tr_b16 v[82:83], v22 offset:512
  ds_read_b64_tr_b16 v[84:85], v23 offset:0
  ds_read_b64_tr_b16 v[86:87], v23 offset:512
  ds_read_b128 v[72:75], v21 offset:0
  ds_read_b128 v[76:79], v21 offset:2048
  ds_read_b64_tr_b16 v[88:89], v22 offset:4096
  ds_read_b64_tr_b16 v[90:91], v22 offset:4608
  ds_read_b64_tr_b16 v[92:93], v23 offset:4096
  ds_read_b64_tr_b16 v[94:95], v23 offset:4608
  s_waitcnt lgkmcnt(0)
  s_barrier
  v_add_u32 v26, 0x4000, v20
  v_add_u32 v27, 0x4000, v21
  v_add_u32 v28, 0x4000, v22
  v_add_u32 v29, 0x4000, v23
  v_mfma_f32_16x16x32_bf16 v[128:131], v[80:83], v[64:67], v[128:131]
  ds_read_b128 v[96:99], v26 offset:0
  ds_read_b128 v[100:103], v26 offset:2048
  v_mfma_f32_16x16x32_bf16 v[136:139], v[80:83], v[68:71], v[136:139]
  ds_read_b64_tr_b16 v[112:113], v28 offset:0
  ds_read_b64_tr_b16 v[114:115], v28 offset:512
  v_mfma_f32_16x16x32_bf16 v[132:135], v[84:87], v[64:67], v[132:135]
  ds_read_b64_tr_b16 v[116:117], v29 offset:0
  ds_read_b64_tr_b16 v[118:119], v29 offset:512
  v_mfma_f32_16x16x32_bf16 v[140:143], v[84:87], v[68:71], v[140:143]
  ds_read_b128 v[104:107], v27 offset:0
  ds_read_b128 v[108:111], v27 offset:2048
  v_mfma_f32_16x16x32_bf16 v[128:131], v[88:91], v[72:75], v[128:131]
  ds_read_b64_tr_b16 v[120:121], v28 offset:4096
  ds_read_b64_tr_b16 v[122:123], v28 offset:4608
  v_mfma_f32_16x16x32_bf16 v[136:139], v[88:91], v[76:79], v[136:139]
  ds_read_b64_tr_b16 v[124:125], v29 offset:4096
  ds_read_b64_tr_b16 v[126:127], v29 offset:4608
  v_mfma_f32_16x16x32_bf16 v[132:135], v[92:95], v[72:75], v[132:135]
  v_mfma_f32_16x16x32_bf16 v[140:143], v[92:95], v[76:79], v[140:143]
  s_waitcnt lgkmcnt(0)
  s_barrier
  v_add_u32 v26, 0x8000, v20
  v_add_u32 v27, 0x8000, v21
  v_add_u32 v28, 0x8000, v22
  v_add_u32 v29, 0x8000, v23
  v_mfma_f32_16x16x32_bf16 v[128:131], v[112:115], v[96:99], v[128:131]
  ds_read_b128 v[64:67], v26 offset:0
  ds_read_b128 v[68:71], v26 offset:2048
  v_mfma_f32_16x16x32_bf16 v[136:139], v[112:115], v[100:103], v[136:139]
  ds_read_b64_tr_b16 v[80:81], v28 offset:0
  ds_read_b64_tr_b16 v[82:83], v28 offset:512
  v_mfma_f32_16x16x32_bf16 v[132:135], v[116:119], v[96:99], v[132:135]
  ds_read_b64_tr_b16 v[84:85], v29 offset:0
  ds_read_b64_tr_b16 v[86:87], v29 offset:512
  v_mfma_f32_16x16x32_bf16 v[140:143], v[116:119], v[100:103], v[140:143]
  ds_read_b128 v[72:75], v27 offset:0
  ds_read_b128 v[76:79], v27 offset:2048
  v_mfma_f32_16x16x32_bf16 v[128:131], v[120:123], v[104:107], v[128:131]
  ds_read_b64_tr_b16 v[88:89], v28 offset:4096
  ds_read_b64_tr_b16 v[90:91], v28 offset:4608
  v_mfma_f32_16x16x32_bf16 v[136:139], v[120:123], v[108:111], v[136:139]
  ds_read_b64_tr_b16 v[92:93], v29 offset:4096
  ds_read_b64_tr_b16 v[94:95], v29 offset:4608
  v_mfma_f32_16x16x32_bf16 v[132:135], v[124:127], v[104:107], v[132:135]
  v_mfma_f32_16x16x32_bf16 v[140:143], v[124:127], v[108:111], v[140:143]
  s_waitcnt lgkmcnt(0)
  s_barrier
  v_add_u32 v26, 0xc000, v20
  v_add_u32 v27, 0xc000, v21
  v_add_u32 v28, 0xc000, v22
  v_add_u32 v29, 0xc000, v23
  v_mfma_f32_16x16x32_bf16 v[128:131], v[80:83], v[64:67], v[128:131]
  ds_read_b128 v[96:99], v26 offset:0
  ds_read_b128 v[100:103], v26 offset:2048
  v_mfma_f32_16x16x32_bf16 v[136:139], v[80:83], v[68:71], v[136:139]
  ds_read_b64_tr_b16 v[112:113], v28 offset:0
  ds_read_b64_tr_b16 v[114:115], v28 offset:512
  v_mfma_f32_16x16x32_bf16 v[132:135], v[84:87], v[64:67], v[132:135]
  ds_read_b64_tr_b16 v[116:117], v29 offset:0
  ds_read_b64_tr_b16 v[118:119], v29 offset:512
  v_mfma_f32_16x16x32_bf16 v[140:143], v[84:87], v[68:71], v[140:143]
  ds_read_b128 v[104:107], v27 offset:0
  ds_read_b128 v[108:111], v27 offset:2048
  v_mfma_f32_16x16x32_bf16 v[128:131], v[88:91], v[72:75], v[128:131]
  ds_read_b64_tr_b16 v[120:121], v28 offset:4096
  ds_read_b64_tr_b16 v[122:123], v28 offset:4608
  v_mfma_f32_16x16x32_bf16 v[136:139], v[88:91], v[76:79], v[136:139]
  ds_read_b64_tr_b16 v[124:125], v29 offset:4096
  ds_read_b64_tr_b16 v[126:127], v29 offset:4608
  v_mfma_f32_16x16x32_bf16 v[132:135], v[92:95], v[72:75], v[132:135]
  v_mfma_f32_16x16x32_bf16 v[140:143], v[92:95], v[76:79], v[140:143]
  s_waitcnt lgkmcnt(0)
  s_barrier
  v_add_u32 v26, 0x10000, v20
  v_add_u32 v27, 0x10000, v21
  v_add_u32 v28, 0x10000, v22
  v_add_u32 v29, 0x10000, v23
  v_mfma_f32_16x16x32_bf16 v[128:131], v[112:115], v[96:99], v[128:131]
  ds_read_b128 v[64:67], v26 offset:0
  ds_read_b128 v[68:71], v26 offset:2048
  v_mfma_f32_16x16x32_bf16 v[136:139], v[112:115], v[100:103], v[136:139]
  ds_read_b64_tr_b16 v[80:81], v28 offset:0
  ds_read_b64_tr_b16 v[82:83], v28 offset:512
  v_mfma_f32_16x16x32_bf16 v[132:135], v[116:119], v[96:99], v[132:135]
  ds_read_b64_tr_b16 v[84:85], v29 offset:0
  ds_read_b64_tr_b16 v[86:87], v29 offset:512
  v_mfma_f32_16x16x32_bf16 v[140:143], v[116:119], v[100:103], v[140:143]
  ds_read_b128 v[72:75], v27 offset:0
  ds_read_b128 v[76:79], v27 offset:2048
  v_mfma_f32_16x16x32_bf16 v[128:131], v[120:123], v[104:107], v[128:131]
  ds_read_b64_tr_b16 v[88:89], v28 offset:4096
  ds_read_b64_tr_b16 v[90:91], v28 offset:4608
  v_mfma_f32_16x16x32_bf16 v[136:139], v[120:123], v[108:111], v[136:139]
  ds_read_b64_tr_b16 v[92:93], v29 offset:4096
  ds_read_b64_tr_b16 v[94:95], v29 offset:4608
  v_mfma_f32_16x16x32_bf16 v[132:135], v[124:127], v[104:107], v[132:135]
  v_mfma_f32_16x16x32_bf16 v[140:143], v[124:127], v[108:111], v[140:143]
  s_waitcnt lgkmcnt(0)
  s_barrier
  v_add_u32 v26, 0x14000, v20
  v_add_u32 v27, 0x14000, v21
  v_add_u32 v28, 0x14000, v22
  v_add_u32 v29, 0x14000, v23
  v_mfma_f32_16x16x32_bf16 v[128:131], v[80:83], v[64:67], v[128:131]
  ds_read_b128 v[96:99], v26 offset:0
  ds_read_b128 v[100:103], v26 offset:2048
  v_mfma_f32_16x16x32_bf16 v[136:139], v[80:83], v[68:71], v[136:139]
  ds_read_b64_tr_b16 v[112:113], v28 offset:0
  ds_read_b64_tr_b16 v[114:115], v28 offset:512
  v_mfma_f32_16x16x32_bf16 v[132:135], v[84:87], v[64:67], v[132:135]
  ds_read_b64_tr_b16 v[116:117], v29 offset:0
  ds_read_b64_tr_b16 v[118:119], v29 offset:512
  v_mfma_f32_16x16x32_bf16 v[140:143], v[84:87], v[68:71], v[140:143]
  ds_read_b128 v[104:107], v27 offset:0
  ds_read_b128 v[108:111], v27 offset:2048
  v_mfma_f32_16x16x32_bf16 v[128:131], v[88:91], v[72:75], v[128:131]
  ds_read_b64_tr_b16 v[120:121], v28 offset:4096
  ds_read_b64_tr_b16 v[122:123], v28 offset:4608
  v_mfma_f32_16x16x32_bf16 v[136:139], v[88:91], v[76:79], v[136:139]
  ds_read_b64_tr_b16 v[124:125], v29 offset:4096
  ds_read_b64_tr_b16 v[126:127], v29 offset:4608
  v_mfma_f32_16x16x32_bf16 v[132:135], v[92:95], v[72:75], v[132:135]
  v_mfma_f32_16x16x32_bf16 v[140:143], v[92:95], v[76:79], v[140:143]
  s_waitcnt lgkmcnt(0)
  s_barrier
  v_add_u32 v26, 0x18000, v20
  v_add_u32 v27, 0x18000, v21
  v_add_u32 v28, 0x18000, v22
  v_add_u32 v29, 0x18000, v23
  v_mfma_f32_16x16x32_bf16 v[128:131], v[112:115], v[96:99], v[128:131]
  ds_read_b128 v[64:67], v26 offset:0
  ds_read_b128 v[68:71], v26 offset:2048
  v_mfma_f32_16x16x32_bf16 v[136:139], v[112:115], v[100:103], v[136:139]
  ds_read_b64_tr_b16 v[80:81], v28 offset:0
  ds_read_b64_tr_b16 v[82:83], v28 offset:512
  v_mfma_f32_16x16x32_bf16 v[132:135], v[116:119], v[96:99], v[132:135]
  ds_read_b64_tr_b16 v[84:85], v29 offset:0
  ds_read_b64_tr_b16 v[86:87], v29 offset:512
  v_mfma_f32_16x16x32_bf16 v[140:143], v[116:119], v[100:103], v[140:143]
  ds_read_b128 v[72:75], v27 offset:0
  ds_read_b128 v[76:79], v27 offset:2048
  v_mfma_f32_16x16x32_bf16 v[128:131], v[120:123], v[104:107], v[128:131]
  ds_read_b64_tr_b16 v[88:89], v28 offset:4096
  ds_read_b64_tr_b16 v[90:91], v28 offset:4608
  v_mfma_f32_16x16x32_bf16 v[136:139], v[120:123], v[108:111], v[136:139]
  ds_read_b64_tr_b16 v[92:93], v29 offset:4096
  ds_read_b64_tr_b16 v[94:95], v29 offset:4608
  v_mfma_f32_16x16x32_bf16 v[132:135], v[124:127], v[104:107], v[132:135]
  v_mfma_f32_16x16x32_bf16 v[140:143], v[124:127], v[108:111], v[140:143]
  s_waitcnt lgkmcnt(0)
  s_barrier
  v_add_u32 v26, 0x1c000, v20
  v_add_u32 v27, 0x1c000, v21
  v_add_u32 v28, 0x1c000, v22
  v_add_u32 v29, 0x1c000, v23
  v_mfma_f32_16x16x32_bf16 v[128:131], v[80:83], v[64:67], v[128:131]
  ds_read_b128 v[96:99], v26 offset:0
  ds_read_b128 v[100:103], v26 offset:2048
  v_mfma_f32_16x16x32_bf16 v[136:139], v[80:83], v[68:71], v[136:139]
  ds_read_b64_tr_b16 v[112:113], v28 offset:0
  ds_read_b64_tr_b16 v[114:115], v28 offset:512
  v_mfma_f32_16x16x32_bf16 v[132:135], v[84:87], v[64:67], v[132:135]
  ds_read_b64_tr_b16 v[116:117], v29 offset:0
  ds_read_b64_tr_b16 v[118:119], v29 offset:512
  v_mfma_f32_16x16x32_bf16 v[140:143], v[84:87], v[68:71], v[140:143]
  ds_read_b128 v[104:107], v27 offset:0
  ds_read_b128 v[108:111], v27 offset:2048
  v_mfma_f32_16x16x32_bf16 v[128:131], v[88:91], v[72:75], v[128:131]
  ds_read_b64_tr_b16 v[120:121], v28 offset:4096
  ds_read_b64_tr_b16 v[122:123], v28 offset:4608
  v_mfma_f32_16x16x32_bf16 v[136:139], v[88:91], v[76:79], v[136:139]
  ds_read_b64_tr_b16 v[124:125], v29 offset:4096
  ds_read_b64_tr_b16 v[126:127], v29 offset:4608
  v_mfma_f32_16x16x32_bf16 v[132:135], v[92:95], v[72:75], v[132:135]
  v_mfma_f32_16x16x32_bf16 v[140:143], v[92:95], v[76:79], v[140:143]
  buffer_load_dwordx2 v[32:33], v17, s[16:19], 0 offen offset:0
  buffer_load_dwordx2 v[34:35], v17, s[16:19], 0 offen offset:32
  buffer_load_dwordx2 v[36:37], v17, s[16:19], s35 offen offset:0
  buffer_load_dwordx2 v[38:39], v17, s[16:19], s35 offen offset:32
  s_waitcnt lgkmcnt(0)
  s_barrier
  v_add_u32 v26, 0x20000, v20
  v_add_u32 v27, 0x20000, v21
  v_add_u32 v28, 0x20000, v22
  v_add_u32 v29, 0x20000, v23
  v_mfma_f32_16x16x32_bf16 v[128:131], v[112:115], v[96:99], v[128:131]
  ds_read_b128 v[64:67], v26 offset:0
  ds_read_b128 v[68:71], v26 offset:2048
  v_mfma_f32_16x16x32_bf16 v[136:139], v[112:115], v[100:103], v[136:139]
  ds_read_b64_tr_b16 v[80:81], v28 offset:0
  ds_read_b64_tr_b16 v[82:83], v28 offset:512
  v_mfma_f32_16x16x32_bf16 v[132:135], v[116:119], v[96:99], v[132:135]
  ds_read_b64_tr_b16 v[84:85], v29 offset:0
  ds_read_b64_tr_b16 v[86:87], v29 offset:512
  v_mfma_f32_16x16x32_bf16 v[140:143], v[116:119], v[100:103], v[140:143]
  ds_read_b128 v[72:75], v27 offset:0
  ds_read_b128 v[76:79], v27 offset:2048
  v_mfma_f32_16x16x32_bf16 v[128:131], v[120:123], v[104:107], v[128:131]
  ds_read_b64_tr_b16 v[88:89], v28 offset:4096
  ds_read_b64_tr_b16 v[90:91], v28 offset:4608
  v_mfma_f32_16x16x32_bf16 v[136:139], v[120:123], v[108:111], v[136:139]
  ds_read_b64_tr_b16 v[92:93], v29 offset:4096
  ds_read_b64_tr_b16 v[94:95], v29 offset:4608
  v_mfma_f32_16x16x32_bf16 v[132:135], v[124:127], v[104:107], v[132:135]
  v_mfma_f32_16x16x32_bf16 v[140:143], v[124:127], v[108:111], v[140:143]
  s_waitcnt lgkmcnt(0)
  s_barrier
  v_add_u32 v26, 0x24000, v20
  v_add_u32 v27, 0x24000, v21
  v_add_u32 v28, 0x24000, v22
  v_add_u32 v29, 0x24000, v23
  v_mfma_f32_16x16x32_bf16 v[128:131], v[80:83], v[64:67], v[128:131]
  ds_read_b128 v[96:99], v26 offset:0
  ds_read_b128 v[100:103], v26 offset:2048
  v_mfma_f32_16x16x32_bf16 v[136:139], v[80:83], v[68:71], v[136:139]
  ds_read_b64_tr_b16 v[112:113], v28 offset:0
  ds_read_b64_tr_b16 v[114:115], v28 offset:512
  v_mfma_f32_16x16x32_bf16 v[132:135], v[84:87], v[64:67], v[132:135]
  ds_read_b64_tr_b16 v[116:117], v29 offset:0
  ds_read_b64_tr_b16 v[118:119], v29 offset:512
  v_mfma_f32_16x16x32_bf16 v[140:143], v[84:87], v[68:71], v[140:143]
  ds_read_b128 v[104:107], v27 offset:0
  ds_read_b128 v[108:111], v27 offset:2048
  v_mfma_f32_16x16x32_bf16 v[128:131], v[88:91], v[72:75], v[128:131]
  ds_read_b64_tr_b16 v[120:121], v28 offset:4096
  ds_read_b64_tr_b16 v[122:123], v28 offset:4608
  v_mfma_f32_16x16x32_bf16 v[136:139], v[88:91], v[76:79], v[136:139]
  ds_read_b64_tr_b16 v[124:125], v29 offset:4096
  ds_read_b64_tr_b16 v[126:127], v29 offset:4608
  v_mfma_f32_16x16x32_bf16 v[132:135], v[92:95], v[72:75], v[132:135]
  v_mfma_f32_16x16x32_bf16 v[140:143], v[92:95], v[76:79], v[140:143]
  s_waitcnt lgkmcnt(0)
  s_barrier
  v_mfma_f32_16x16x32_bf16 v[128:131], v[112:115], v[96:99], v[128:131]
  ds_read_b128 v[64:67], v20 offset:0
  ds_read_b128 v[68:71], v20 offset:2048
  v_mfma_f32_16x16x32_bf16 v[136:139], v[112:115], v[100:103], v[136:139]
  ds_read_b64_tr_b16 v[80:81], v22 offset:0
  ds_read_b64_tr_b16 v[82:83], v22 offset:512
  v_mfma_f32_16x16x32_bf16 v[132:135], v[116:119], v[96:99], v[132:135]
  ds_read_b64_tr_b16 v[84:85], v23 offset:0
  ds_read_b64_tr_b16 v[86:87], v23 offset:512
  v_mfma_f32_16x16x32_bf16 v[140:143], v[116:119], v[100:103], v[140:143]
  ds_read_b128 v[72:75], v21 offset:0
  ds_read_b128 v[76:79], v21 offset:2048
  v_mfma_f32_16x16x32_bf16 v[128:131], v[120:123], v[104:107], v[128:131]
  ds_read_b64_tr_b16 v[88:89], v22 offset:4096
  ds_read_b64_tr_b16 v[90:91], v22 offset:4608
  v_mfma_f32_16x16x32_bf16 v[136:139], v[120:123], v[108:111], v[136:139]
  ds_read_b64_tr_b16 v[92:93], v23 offset:4096
  ds_read_b64_tr_b16 v[94:95], v23 offset:4608
  v_mfma_f32_16x16x32_bf16 v[132:135], v[124:127], v[104:107], v[132:135]
  v_mfma_f32_16x16x32_bf16 v[140:143], v[124:127], v[108:111], v[140:143]
  s_waitcnt lgkmcnt(0)
  v_mfma_f32_16x16x32_bf16 v[128:131], v[80:83], v[64:67], v[128:131]
  v_mfma_f32_16x16x32_bf16 v[136:139], v[80:83], v[68:71], v[136:139]
  v_mfma_f32_16x16x32_bf16 v[132:135], v[84:87], v[64:67], v[132:135]
  v_mfma_f32_16x16x32_bf16 v[140:143], v[84:87], v[68:71], v[140:143]
  v_mfma_f32_16x16x32_bf16 v[128:131], v[88:91], v[72:75], v[128:131]
  v_mfma_f32_16x16x32_bf16 v[136:139], v[88:91], v[76:79], v[136:139]
  v_mfma_f32_16x16x32_bf16 v[132:135], v[92:95], v[72:75], v[132:135]
  v_mfma_f32_16x16x32_bf16 v[140:143], v[92:95], v[76:79], v[140:143]
  s_waitcnt vmcnt(0)
  s_nop 7
  v_cvt_pk_bf16_f32 v8, v128, v129
  v_cvt_pk_bf16_f32 v9, v130, v131
  v_lshlrev_b32 v4, 16, v32
  v_and_b32 v5, 0xffff0000, v32
  v_lshlrev_b32 v6, 16, v33
  v_and_b32 v7, 0xffff0000, v33
  v_lshlrev_b32 v128, 16, v8
  v_and_b32 v129, 0xffff0000, v8
  v_lshlrev_b32 v130, 16, v9
  v_and_b32 v131, 0xffff0000, v9
  v_pk_add_f32 v[128:129], v[128:129], v[4:5]
  v_pk_add_f32 v[130:131], v[130:131], v[6:7]
  v_cvt_pk_bf16_f32 v32, v128, v129
  v_cvt_pk_bf16_f32 v33, v130, v131
  buffer_store_dwordx2 v[32:33], v16, s[12:15], 0 offen offset:0
  v_cvt_pk_bf16_f32 v8, v132, v133
  v_cvt_pk_bf16_f32 v9, v134, v135
  v_lshlrev_b32 v4, 16, v34
  v_and_b32 v5, 0xffff0000, v34
  v_lshlrev_b32 v6, 16, v35
  v_and_b32 v7, 0xffff0000, v35
  v_lshlrev_b32 v132, 16, v8
  v_and_b32 v133, 0xffff0000, v8
  v_lshlrev_b32 v134, 16, v9
  v_and_b32 v135, 0xffff0000, v9
  v_pk_add_f32 v[132:133], v[132:133], v[4:5]
  v_pk_add_f32 v[134:135], v[134:135], v[6:7]
  v_cvt_pk_bf16_f32 v34, v132, v133
  v_cvt_pk_bf16_f32 v35, v134, v135
  buffer_store_dwordx2 v[34:35], v16, s[12:15], 0 offen offset:32
  v_cvt_pk_bf16_f32 v8, v136, v137
  v_cvt_pk_bf16_f32 v9, v138, v139
  v_lshlrev_b32 v4, 16, v36
  v_and_b32 v5, 0xffff0000, v36
  v_lshlrev_b32 v6, 16, v37
  v_and_b32 v7, 0xffff0000, v37
  v_lshlrev_b32 v136, 16, v8
  v_and_b32 v137, 0xffff0000, v8
  v_lshlrev_b32 v138, 16, v9
  v_and_b32 v139, 0xffff0000, v9
  v_pk_add_f32 v[136:137], v[136:137], v[4:5]
  v_pk_add_f32 v[138:139], v[138:139], v[6:7]
  v_cvt_pk_bf16_f32 v36, v136, v137
  v_cvt_pk_bf16_f32 v37, v138, v139
  buffer_store_dwordx2 v[36:37], v16, s[12:15], s36 offen offset:0
  v_cvt_pk_bf16_f32 v8, v140, v141
  v_cvt_pk_bf16_f32 v9, v142, v143
  v_lshlrev_b32 v4, 16, v38
  v_and_b32 v5, 0xffff0000, v38
  v_lshlrev_b32 v6, 16, v39
  v_and_b32 v7, 0xffff0000, v39
  v_lshlrev_b32 v140, 16, v8
  v_and_b32 v141, 0xffff0000, v8
  v_lshlrev_b32 v142, 16, v9
  v_and_b32 v143, 0xffff0000, v9
  v_pk_add_f32 v[140:141], v[140:141], v[4:5]
  v_pk_add_f32 v[142:143], v[142:143], v[6:7]
  v_cvt_pk_bf16_f32 v38, v140, v141
  v_cvt_pk_bf16_f32 v39, v142, v143
  buffer_store_dwordx2 v[38:39], v16, s[12:15], s36 offen offset:32
  s_branch .Lend_k5b_kernel
.Lloader_k5b_kernel_1:
  s_sub_u32 s26, s26, 4
  v_lshrrev_b32 v4, 3, v1
  v_and_b32 v5, 7, v1
  s_lshl_b32 s31, s26, 4
  s_mov_b32 s32, 1408
  s_lshl_b32 s34, s24, 6
  v_add_u32 v6, s31, v4
  v_bfe_u32 v7, v6, 1, 3
  v_xor_b32 v7, v7, v5
  v_add_u32 v6, s34, v6
  v_mul_lo_u32 v6, v6, s32
  v_lshl_add_u32 v8, v7, 4, v6
  v_add_u32 v6, s31, v4
  v_add_u32 v6, 8, v6
  v_bfe_u32 v7, v6, 1, 3
  v_xor_b32 v7, v7, v5
  v_add_u32 v6, s34, v6
  v_mul_lo_u32 v6, v6, s32
  v_lshl_add_u32 v9, v7, 4, v6
  s_mov_b32 s32, 1024
  v_add_u32 v6, s31, v4
  v_bfe_u32 v7, v6, 1, 1
  v_bfe_u32 v13, v6, 3, 1
  v_lshl_add_u32 v7, v13, 1, v7
  v_lshrrev_b32 v13, 1, v5
  v_xor_b32 v7, v7, v13
  v_add_u32 v7, s33, v7
  v_lshlrev_b32 v7, 4, v7
  v_and_b32 v13, 1, v5
  v_lshl_add_u32 v7, v13, 3, v7
  v_lshlrev_b32 v7, 1, v7
  v_mul_lo_u32 v6, v6, s32
  v_add_u32 v10, v6, v7
  v_add_u32 v6, s31, v4
  v_add_u32 v6, 8, v6
  v_bfe_u32 v7, v6, 1, 1
  v_bfe_u32 v13, v6, 3, 1
  v_lshl_add_u32 v7, v13, 1, v7
  v_lshrrev_b32 v13, 1, v5
  v_xor_b32 v7, v7, v13
  v_add_u32 v7, s33, v7
  v_lshlrev_b32 v7, 4, v7
  v_and_b32 v13, 1, v5
  v_lshl_add_u32 v7, v13, 3, v7
  v_lshlrev_b32 v7, 1, v7
  v_mul_lo_u32 v6, v6, s32
  v_add_u32 v11, v6, v7
  s_lshl_b32 s29, s26, 11
  s_mul_i32 s30, s26, 2048
  s_add_u32 s30, s30, 8192
  s_waitcnt lgkmcnt(0)
  s_add_u32 s4, s4, 0x1000000
  s_addc_u32 s5, s5, 0
  s_mov_b32 s6, 0x2c0000
  s_mov_b32 s7, 0x00020000
  s_mov_b32 s10, 0xac000
  s_mov_b32 s11, 0x00020000
  s_mov_b32 s31, 0
  s_mov_b32 s32, 0
  s_add_u32 m0, s29, 0
  s_nop 0
  buffer_load_dwordx4 v8, s[4:7], s31 offen lds
  s_add_u32 m0, s29, 1024
  s_nop 0
  buffer_load_dwordx4 v9, s[4:7], s31 offen lds
  s_add_u32 m0, s30, 0
  s_nop 0
  buffer_load_dwordx4 v10, s[8:11], s32 offen lds
  s_add_u32 m0, s30, 1024
  s_nop 0
  buffer_load_dwordx4 v11, s[8:11], s32 offen lds
  s_mov_b32 s31, 128
  s_mov_b32 s32, 65536
  s_add_u32 m0, s29, 16384
  s_nop 0
  buffer_load_dwordx4 v8, s[4:7], s31 offen lds
  s_add_u32 m0, s29, 17408
  s_nop 0
  buffer_load_dwordx4 v9, s[4:7], s31 offen lds
  s_add_u32 m0, s30, 16384
  s_nop 0
  buffer_load_dwordx4 v10, s[8:11], s32 offen lds
  s_add_u32 m0, s30, 17408
  s_nop 0
  buffer_load_dwordx4 v11, s[8:11], s32 offen lds
  s_mov_b32 s31, 256
  s_mov_b32 s32, 131072
  s_add_u32 m0, s29, 32768
  s_nop 0
  buffer_load_dwordx4 v8, s[4:7], s31 offen lds
  s_add_u32 m0, s29, 33792
  s_nop 0
  buffer_load_dwordx4 v9, s[4:7], s31 offen lds
  s_add_u32 m0, s30, 32768
  s_nop 0
  buffer_load_dwordx4 v10, s[8:11], s32 offen lds
  s_add_u32 m0, s30, 33792
  s_nop 0
  buffer_load_dwordx4 v11, s[8:11], s32 offen lds
  s_mov_b32 s31, 384
  s_mov_b32 s32, 196608
  s_add_u32 m0, s29, 49152
  s_nop 0
  buffer_load_dwordx4 v8, s[4:7], s31 offen lds
  s_add_u32 m0, s29, 50176
  s_nop 0
  buffer_load_dwordx4 v9, s[4:7], s31 offen lds
  s_add_u32 m0, s30, 49152
  s_nop 0
  buffer_load_dwordx4 v10, s[8:11], s32 offen lds
  s_add_u32 m0, s30, 50176
  s_nop 0
  buffer_load_dwordx4 v11, s[8:11], s32 offen lds
  s_waitcnt vmcnt(12)
  s_barrier
  s_mov_b32 s31, 512
  s_mov_b32 s32, 262144
  s_add_u32 m0, s29, 65536
  s_nop 0
  buffer_load_dwordx4 v8, s[4:7], s31 offen lds
  s_add_u32 m0, s29, 66560
  s_nop 0
  buffer_load_dwordx4 v9, s[4:7], s31 offen lds
  s_add_u32 m0, s30, 65536
  s_nop 0
  buffer_load_dwordx4 v10, s[8:11], s32 offen lds
  s_add_u32 m0, s30, 66560
  s_nop 0
  buffer_load_dwordx4 v11, s[8:11], s32 offen lds
  s_mov_b32 s31, 640
  s_mov_b32 s32, 327680
  s_add_u32 m0, s29, 81920
  s_nop 0
  buffer_load_dwordx4 v8, s[4:7], s31 offen lds
  s_add_u32 m0, s29, 82944
  s_nop 0
  buffer_load_dwordx4 v9, s[4:7], s31 offen lds
  s_add_u32 m0, s30, 81920
  s_nop 0
  buffer_load_dwordx4 v10, s[8:11], s32 offen lds
  s_add_u32 m0, s30, 82944
  s_nop 0
  buffer_load_dwordx4 v11, s[8:11], s32 offen lds
  s_waitcnt vmcnt(16)
  s_barrier
  s_mov_b32 s31, 768
  s_mov_b32 s32, 393216
  s_add_u32 m0, s29, 98304
  s_nop 0
  buffer_load_dwordx4 v8, s[4:7], s31 offen lds
  s_add_u32 m0, s29, 99328
  s_nop 0
  buffer_load_dwordx4 v9, s[4:7], s31 offen lds
  s_add_u32 m0, s30, 98304
  s_nop 0
  buffer_load_dwordx4 v10, s[8:11], s32 offen lds
  s_add_u32 m0, s30, 99328
  s_nop 0
  buffer_load_dwordx4 v11, s[8:11], s32 offen lds
  s_mov_b32 s31, 896
  s_mov_b32 s32, 458752
  s_add_u32 m0, s29, 114688
  s_nop 0
  buffer_load_dwordx4 v8, s[4:7], s31 offen lds
  s_add_u32 m0, s29, 115712
  s_nop 0
  buffer_load_dwordx4 v9, s[4:7], s31 offen lds
  s_add_u32 m0, s30, 114688
  s_nop 0
  buffer_load_dwordx4 v10, s[8:11], s32 offen lds
  s_add_u32 m0, s30, 115712
  s_nop 0
  buffer_load_dwordx4 v11, s[8:11], s32 offen lds
  s_waitcnt vmcnt(20)
  s_barrier
  s_mov_b32 s31, 1024
  s_mov_b32 s32, 524288
  s_add_u32 m0, s29, 131072
  s_nop 0
  buffer_load_dwordx4 v8, s[4:7], s31 offen lds
  s_add_u32 m0, s29, 132096
  s_nop 0
  buffer_load_dwordx4 v9, s[4:7], s31 offen lds
  s_add_u32 m0, s30, 131072
  s_nop 0
  buffer_load_dwordx4 v10, s[8:11], s32 offen lds
  s_add_u32 m0, s30, 132096
  s_nop 0
  buffer_load_dwordx4 v11, s[8:11], s32 offen lds
  s_mov_b32 s31, 1152
  s_mov_b32 s32, 589824
  s_add_u32 m0, s29, 147456
  s_nop 0
  buffer_load_dwordx4 v8, s[4:7], s31 offen lds
  s_add_u32 m0, s29, 148480
  s_nop 0
  buffer_load_dwordx4 v9, s[4:7], s31 offen lds
  s_add_u32 m0, s30, 147456
  s_nop 0
  buffer_load_dwordx4 v10, s[8:11], s32 offen lds
  s_add_u32 m0, s30, 148480
  s_nop 0
  buffer_load_dwordx4 v11, s[8:11], s32 offen lds
  s_waitcnt vmcnt(24)
  s_barrier
  s_mov_b32 s31, 1280
  s_mov_b32 s32, 655360
  s_add_u32 m0, s29, 0
  s_nop 0
  buffer_load_dwordx4 v8, s[4:7], s31 offen lds
  s_add_u32 m0, s29, 1024
  s_nop 0
  buffer_load_dwordx4 v9, s[4:7], s31 offen lds
  s_add_u32 m0, s30, 0
  s_nop 0
  buffer_load_dwordx4 v10, s[8:11], s32 offen lds
  s_add_u32 m0, s30, 1024
  s_nop 0
  buffer_load_dwordx4 v11, s[8:11], s32 offen lds
  s_waitcnt vmcnt(24)
  s_barrier
  s_waitcnt vmcnt(20)
  s_barrier
  s_waitcnt vmcnt(16)
  s_barrier
  s_waitcnt vmcnt(12)
  s_barrier
  s_waitcnt vmcnt(8)
  s_barrier
  s_waitcnt vmcnt(4)
  s_barrier
  s_waitcnt vmcnt(0)
  s_barrier
.Lend_k5b_kernel:
  s_endpgm

.Ltext_end:
.section .rodata,"a"
.p2align 6
.amdhsa_kernel k1a_kernel
  .amdhsa_next_free_vgpr 120
  .amdhsa_next_free_sgpr 100
  .amdhsa_accum_offset 120
  .amdhsa_group_segment_fixed_size 0
  .amdhsa_kernarg_size 88
  .amdhsa_user_sgpr_count 2
  .amdhsa_user_sgpr_kernarg_segment_ptr 1
  .amdhsa_system_sgpr_workgroup_id_x 1
.end_amdhsa_kernel

.p2align 6
.amdhsa_kernel k1b_kernel
  .amdhsa_next_free_vgpr 120
  .amdhsa_next_free_sgpr 100
  .amdhsa_accum_offset 120
  .amdhsa_group_segment_fixed_size 0
  .amdhsa_kernarg_size 88
  .amdhsa_user_sgpr_count 2
  .amdhsa_user_sgpr_kernarg_segment_ptr 1
  .amdhsa_system_sgpr_workgroup_id_x 1
.end_amdhsa_kernel

.p2align 6
.amdhsa_kernel k2a_kernel
  .amdhsa_next_free_vgpr 144
  .amdhsa_next_free_sgpr 100
  .amdhsa_accum_offset 144
  .amdhsa_group_segment_fixed_size 0
  .amdhsa_kernarg_size 88
  .amdhsa_user_sgpr_count 2
  .amdhsa_user_sgpr_kernarg_segment_ptr 1
  .amdhsa_system_sgpr_workgroup_id_x 1
.end_amdhsa_kernel

.p2align 6
.amdhsa_kernel k2b_kernel
  .amdhsa_next_free_vgpr 144
  .amdhsa_next_free_sgpr 100
  .amdhsa_accum_offset 144
  .amdhsa_group_segment_fixed_size 0
  .amdhsa_kernarg_size 88
  .amdhsa_user_sgpr_count 2
  .amdhsa_user_sgpr_kernarg_segment_ptr 1
  .amdhsa_system_sgpr_workgroup_id_x 1
.end_amdhsa_kernel

.p2align 6
.amdhsa_kernel k3_kernel
  .amdhsa_next_free_vgpr 120
  .amdhsa_next_free_sgpr 100
  .amdhsa_accum_offset 120
  .amdhsa_group_segment_fixed_size 0
  .amdhsa_kernarg_size 88
  .amdhsa_user_sgpr_count 2
  .amdhsa_user_sgpr_kernarg_segment_ptr 1
  .amdhsa_system_sgpr_workgroup_id_x 1
.end_amdhsa_kernel

.p2align 6
.amdhsa_kernel k3b_kernel
  .amdhsa_next_free_vgpr 72
  .amdhsa_next_free_sgpr 100
  .amdhsa_accum_offset 72
  .amdhsa_group_segment_fixed_size 0
  .amdhsa_kernarg_size 88
  .amdhsa_user_sgpr_count 2
  .amdhsa_user_sgpr_kernarg_segment_ptr 1
  .amdhsa_system_sgpr_workgroup_id_x 1
.end_amdhsa_kernel

.p2align 6
.amdhsa_kernel k4_kernel
  .amdhsa_next_free_vgpr 168
  .amdhsa_next_free_sgpr 100
  .amdhsa_accum_offset 168
  .amdhsa_group_segment_fixed_size 0
  .amdhsa_kernarg_size 88
  .amdhsa_user_sgpr_count 2
  .amdhsa_user_sgpr_kernarg_segment_ptr 1
  .amdhsa_system_sgpr_workgroup_id_x 1
.end_amdhsa_kernel

.p2align 6
.amdhsa_kernel k5a_kernel
  .amdhsa_next_free_vgpr 144
  .amdhsa_next_free_sgpr 100
  .amdhsa_accum_offset 144
  .amdhsa_group_segment_fixed_size 0
  .amdhsa_kernarg_size 88
  .amdhsa_user_sgpr_count 2
  .amdhsa_user_sgpr_kernarg_segment_ptr 1
  .amdhsa_system_sgpr_workgroup_id_x 1
.end_amdhsa_kernel

.p2align 6
.amdhsa_kernel k5b_kernel
  .amdhsa_next_free_vgpr 144
  .amdhsa_next_free_sgpr 100
  .amdhsa_accum_offset 144
  .amdhsa_group_segment_fixed_size 0
  .amdhsa_kernarg_size 88
  .amdhsa_user_sgpr_count 2
  .amdhsa_user_sgpr_kernarg_segment_ptr 1
  .amdhsa_system_sgpr_workgroup_id_x 1
.end_amdhsa_kernel
```
